```python
import torch

def _softmax(x, axis=-1):
    return torch.softmax(x, dim=axis)
def _gelu(x):
    return torch.nn.functional.gelu(x, approximate="tanh")
def _silu(x):
    return torch.nn.functional.silu(x)
def _sigmoid(x):
    return torch.sigmoid(x)
def _layernorm(x, axis=-1, eps=1e-5):
    m = x.mean(dim=axis, keepdim=True)
    v = x.var(dim=axis, keepdim=True, unbiased=False)
    return (x - m) / torch.sqrt(v + eps)
def _scatter_add(tgt, idx, src, axis=0):
    return tgt.clone().index_add_(axis, idx, src)
def _segment_sum(src, seg, n):
    out = torch.zeros((n,) + src.shape[1:], dtype=src.dtype)
    return out.index_add_(0, seg, src)
def _pad(x, pw):
    flat = tuple(v for pair in reversed(pw) for v in pair)
    return torch.nn.functional.pad(x, flat)

kernel_name = 'interleave_layers__linear_attn_block__mixer_s_mlp__prompt'

def setup_inputs():

    _w = (lambda a: (lambda t: t.to(torch.bfloat16) if t.is_floating_point() else t)(torch.as_tensor(a)))
    def _A_setup():
        B, S, D = 1, 2048, 512
        return {
            "x": _w((lambda *s: torch.randn(*s, dtype=torch.bfloat16) * 0.05)(B, S, D)),
            "wqkv": _w((lambda *s: torch.randn(*s, dtype=torch.bfloat16) * 0.1)(D, 3 * D)),
            "wo": _w((lambda *s: torch.randn(*s, dtype=torch.bfloat16) * 0.1)(D, D)),
        }
    _A_in = _A_setup()

    def _B_setup():
        B, S, D, F = 1, 2048, 512, 1792
        return {
            "x":  _w((lambda *s: torch.randn(*s, dtype=torch.bfloat16) * 0.05)(B, S, D)),
            "w1": _w((lambda *s: torch.randn(*s, dtype=torch.bfloat16) * 3.2)(D, D) * (D ** -0.5)),
            "w2": _w((lambda *s: torch.randn(*s, dtype=torch.bfloat16) * 3.2)(D, D) * (D ** -0.5)),
            "w3": _w((lambda *s: torch.randn(*s, dtype=torch.bfloat16) * 3.2)(D, F) * (D ** -0.5)),
            "w4": _w((lambda *s: torch.randn(*s, dtype=torch.bfloat16) * 3.2)(F, D) * (F ** -0.5)),
        }
    _B_in = _B_setup()

    return {
        "A_x": _A_in["x"],
        "A_wqkv": _A_in["wqkv"],
        "A_wo": _A_in["wo"],
        "B_x": _B_in["x"],
        "B_w1": _B_in["w1"],
        "B_w2": _B_in["w2"],
        "B_w3": _B_in["w3"],
        "B_w4": _B_in["w4"],
    }

def reference(A_x, A_wqkv, A_wo, B_x, B_w1, B_w2, B_w3, B_w4):
    def _A_ref(x, wqkv, wo):
        B, S, D = x.shape
        H = 32; Dh = D // H
        qkv = (lambda x, *d: x.permute(*d))((x @ wqkv).reshape(B, S, 3, H, Dh), 2, 0, 3, 1, 4)
        q, k, v = qkv[0], qkv[1], qkv[2]
        phi = lambda t: torch.where(t > 0, t + 1, torch.exp(t)) + 1e-6
        pq, pk = phi(q), phi(k)
        kv = torch.einsum("bhsd,bhse->bhde", pk, v)
        z = torch.einsum("bhsd->bhd", pk)
        num = torch.einsum("bhqd,bhde->bhqe", pq, kv)
        den = torch.einsum("bhqd,bhd->bhq", pq, z)[..., None] + 1e-6
        o = num / den
        return (lambda x, *d: x.permute(*d))(o, 0, 2, 1, 3).reshape(B, S, D) @ wo

    def _B_ref(x, w1, w2, w3, w4):
        B, S, D = x.shape
        h = _gelu(_layernorm(x, axis=-1) @ w1)
        c = D // 4
        g0 = _pad(h[:, :, 0*c:1*c], ((0, 0), (1, 0), (0, 0)))[:, :S, :]
        g1 = _pad(h[:, :, 1*c:2*c], ((0, 0), (0, 1), (0, 0)))[:, 1:, :]
        g2 = _pad(h[:, :, 2*c:3*c], ((0, 0), (2, 0), (0, 0)))[:, :S, :]
        g3 = _pad(h[:, :, 3*c:   ], ((0, 0), (0, 2), (0, 0)))[:, 2:, :]
        hs = torch.concatenate([g0, g1, g2, g3], axis=-1) @ w2
        x1 = x + hs
        h2 = _gelu(_layernorm(x1, axis=-1) @ w3) @ w4
        return x1 + h2

    x = A_x
    x = x + _A_ref(_layernorm(x, axis=-1), A_wqkv, A_wo)
    x = x + _B_ref(_layernorm(x, axis=-1), B_w1, B_w2, B_w3, B_w4)
    x = x + _A_ref(_layernorm(x, axis=-1), A_wqkv, A_wo)
    x = x + _B_ref(_layernorm(x, axis=-1), B_w1, B_w2, B_w3, B_w4)
    return x
```

```asm
; @launch kernel=prep_kernel grid=(512,1,1) block=(256,1,1) lds=16384
; @launch kernel=main_kernel grid=(256,1,1) block=(256,1,1) lds=135168
.amdgcn_target "amdgcn-amd-amdhsa--gfx950"
.text
.globl prep_kernel
.p2align 8
.type prep_kernel,@function
prep_kernel:
  s_cmp_ge_u32 s2, 512
  s_cbranch_scc1 P_done
  s_load_dwordx2 s[4:5], s[0:1], 0
  s_load_dwordx4 s[8:11], s[0:1], 8
  s_load_dwordx4 s[12:15], s[0:1], 32
  s_load_dwordx4 s[16:19], s[0:1], 48
  s_load_dwordx2 s[20:21], s[0:1], 80
  v_and_b32 v1, 63, v0
  v_lshrrev_b32 v2, 6, v0
  s_nop 0
  v_readfirstlane_b32 s22, v2
  s_lshl_b32 s23, s2, 2
  s_add_u32 s23, s23, s22
  v_lshlrev_b32 v3, 4, v1
  s_waitcnt lgkmcnt(0)
  s_mov_b32 s24, s20
  s_mov_b32 s25, s21
  s_mov_b32 s26, 268435456
  s_mov_b32 s27, 0x00020000
  s_mov_b32 s28, s4
  s_mov_b32 s29, s5
  s_mov_b32 s30, 2097152
  s_mov_b32 s31, 0x00020000
  s_lshr_b32 s70, s2, 3
  s_lshl_b32 s70, s70, 2
  s_add_u32 s70, s70, s22
  s_cmp_ge_u32 s70, (M_end-main_kernel)/1024
  s_cbranch_scc1 P_c_1
  s_getpc_b64 s[72:73]
P_pc:
  s_add_u32 s72, s72, main_kernel-P_pc
  s_addc_u32 s73, s73, 0
  s_lshl_b32 s70, s70, 10
  s_add_u32 s72, s72, s70
  s_addc_u32 s73, s73, 0
  global_load_dwordx4 v[48:51], v3, s[72:73]
P_c_1:
  s_lshr_b32 s40, s23, 6
  s_and_b32 s41, s23, 63
  s_and_b32 s42, s41, 7
  s_lshr_b32 s43, s41, 3
  v_lshrrev_b32 v4, 3, v1
  v_and_b32 v5, 7, v1
  v_lshlrev_b32 v6, 10, v4
  v_lshlrev_b32 v7, 4, v5
  v_add_u32 v6, v6, v7
  s_lshl_b32 s44, s40, 16
  s_lshl_b32 s45, s42, 13
  s_add_u32 s44, s44, s45
  s_lshl_b32 s45, s43, 7
  s_add_u32 s44, s44, s45
  buffer_load_dwordx4 v[8:11], v6, s[28:31], s44 offen
  v_lshlrev_b32 v12, 10, v5
  v_lshlrev_b32 v13, 4, v4
  v_add_u32 v12, v12, v13
  s_lshl_b32 s46, s40, 21
  s_add_u32 s46, s46, 16777216
  s_lshl_b32 s45, s43, 13
  s_add_u32 s46, s46, s45
  s_lshl_b32 s45, s42, 7
  s_add_u32 s46, s46, s45
  s_cmp_ge_u32 s23, 1664
  s_cbranch_scc1 P_now
  s_cmp_lt_u32 s23, 384
  s_cbranch_scc0 P_s1
  s_mov_b32 s48, s8
  s_mov_b32 s49, s9
  s_mov_b32 s50, 3072
  s_mov_b32 s51, 1572864
  s_and_b32 s52, s23, 15
  s_lshr_b32 s53, s23, 4
  s_lshr_b32 s61, s53, 3
  s_and_b32 s62, s53, 7
  s_lshl_b32 s55, s52, 1
  s_add_u32 s55, s55, s61
  s_sub_u32 s55, s55, 1
  s_add_u32 s63, s52, 32
  s_cmp_eq_u32 s61, 0
  s_cselect_b32 s55, s63, s55
  s_lshl_b32 s54, s62, 2
  s_add_u32 s60, s54, 0
  s_mul_i32 s60, s60, 216
  s_add_u32 s60, s60, s55
  s_lshl_b32 s56, s60, 10
  s_add_u32 s60, s54, 1
  s_mul_i32 s60, s60, 216
  s_add_u32 s60, s60, s55
  s_lshl_b32 s57, s60, 10
  s_add_u32 s60, s54, 2
  s_mul_i32 s60, s60, 216
  s_add_u32 s60, s60, s55
  s_lshl_b32 s58, s60, 10
  s_add_u32 s60, s54, 3
  s_mul_i32 s60, s60, 216
  s_add_u32 s60, s60, s55
  s_lshl_b32 s59, s60, 10
  s_mov_b32 s76, s56
  s_mov_b32 s77, s57
  s_mov_b32 s78, s58
  s_mov_b32 s79, s59
  s_branch P_go
P_s1:
  s_cmp_lt_u32 s23, 512
  s_cbranch_scc0 P_s2
  s_mov_b32 s48, s10
  s_mov_b32 s49, s11
  s_mov_b32 s50, 1024
  s_mov_b32 s51, 524288
  s_sub_u32 s47, s23, 384
  s_and_b32 s52, s47, 15
  s_lshr_b32 s53, s47, 4
  s_lshl_b32 s54, s53, 2
  s_add_u32 s55, s52, 48
  s_add_u32 s60, s54, 0
  s_mul_i32 s60, s60, 216
  s_add_u32 s60, s60, s55
  s_lshl_b32 s56, s60, 10
  s_add_u32 s60, s54, 1
  s_mul_i32 s60, s60, 216
  s_add_u32 s60, s60, s55
  s_lshl_b32 s57, s60, 10
  s_add_u32 s60, s54, 2
  s_mul_i32 s60, s60, 216
  s_add_u32 s60, s60, s55
  s_lshl_b32 s58, s60, 10
  s_add_u32 s60, s54, 3
  s_mul_i32 s60, s60, 216
  s_add_u32 s60, s60, s55
  s_lshl_b32 s59, s60, 10
  s_mov_b32 s76, s56
  s_mov_b32 s77, s57
  s_mov_b32 s78, s58
  s_mov_b32 s79, s59
  s_branch P_go
P_s2:
  s_cmp_lt_u32 s23, 640
  s_cbranch_scc0 P_s3
  s_mov_b32 s48, s12
  s_mov_b32 s49, s13
  s_mov_b32 s50, 1024
  s_mov_b32 s51, 524288
  s_sub_u32 s47, s23, 512
  s_and_b32 s52, s47, 15
  s_lshr_b32 s53, s47, 4
  s_lshl_b32 s54, s53, 2
  s_add_u32 s55, s52, 64
  s_add_u32 s60, s54, 0
  s_mul_i32 s60, s60, 216
  s_add_u32 s60, s60, s55
  s_lshl_b32 s56, s60, 10
  s_add_u32 s60, s54, 1
  s_mul_i32 s60, s60, 216
  s_add_u32 s60, s60, s55
  s_lshl_b32 s57, s60, 10
  s_add_u32 s60, s54, 2
  s_mul_i32 s60, s60, 216
  s_add_u32 s60, s60, s55
  s_lshl_b32 s58, s60, 10
  s_add_u32 s60, s54, 3
  s_mul_i32 s60, s60, 216
  s_add_u32 s60, s60, s55
  s_lshl_b32 s59, s60, 10
  s_mov_b32 s76, s56
  s_mov_b32 s77, s57
  s_mov_b32 s78, s58
  s_mov_b32 s79, s59
  s_branch P_go
P_s3:
  s_cmp_lt_u32 s23, 768
  s_cbranch_scc0 P_s4
  s_mov_b32 s48, s14
  s_mov_b32 s49, s15
  s_mov_b32 s50, 1024
  s_mov_b32 s51, 524288
  s_sub_u32 s47, s23, 640
  s_and_b32 s52, s47, 15
  s_lshr_b32 s53, s47, 4
  s_lshl_b32 s54, s53, 2
  s_add_u32 s55, s52, 80
  s_add_u32 s60, s54, 0
  s_mul_i32 s60, s60, 216
  s_add_u32 s60, s60, s55
  s_lshl_b32 s56, s60, 10
  s_add_u32 s60, s54, 1
  s_mul_i32 s60, s60, 216
  s_add_u32 s60, s60, s55
  s_lshl_b32 s57, s60, 10
  s_add_u32 s60, s54, 2
  s_mul_i32 s60, s60, 216
  s_add_u32 s60, s60, s55
  s_lshl_b32 s58, s60, 10
  s_add_u32 s60, s54, 3
  s_mul_i32 s60, s60, 216
  s_add_u32 s60, s60, s55
  s_lshl_b32 s59, s60, 10
  s_mov_b32 s76, s56
  s_mov_b32 s77, s57
  s_mov_b32 s78, s58
  s_mov_b32 s79, s59
  s_branch P_go
P_s4:
  s_cmp_lt_u32 s23, 1216
  s_cbranch_scc0 P_s5
  s_mov_b32 s48, s16
  s_mov_b32 s49, s17
  s_mov_b32 s50, 3584
  s_mov_b32 s51, 1835008
  s_sub_u32 s47, s23, 768
  s_and_b32 s52, s47, 15
  s_lshr_b32 s53, s47, 4
  s_lshl_b32 s60, s53, 2
  s_add_u32 s60, s60, 0
  s_mul_i32 s61, s60, 4682
  s_lshr_b32 s61, s61, 16
  s_mul_i32 s62, s61, 14
  s_sub_u32 s62, s60, s62
  s_and_b32 s63, s62, 3
  s_lshr_b32 s64, s62, 2
  s_lshl_b32 s65, s52, 1
  s_cmp_eq_u32 s64, 1
  s_cselect_b32 s71, 1, 0
  s_cmp_eq_u32 s64, 2
  s_cselect_b32 s71, 32, s71
  s_cmp_eq_u32 s64, 3
  s_cselect_b32 s71, 33, s71
  s_add_u32 s65, s65, s71
  s_add_u32 s65, s65, 96
  s_sub_u32 s72, s62, 12
  s_lshl_b32 s72, s72, 1
  s_cmp_ge_u32 s62, 12
  s_cselect_b32 s63, s72, s63
  s_lshl_b32 s61, s61, 2
  s_add_u32 s61, s61, s63
  s_mul_i32 s61, s61, 216
  s_add_u32 s61, s61, s65
  s_lshl_b32 s56, s61, 10
  s_add_u32 s72, s56, 221184
  s_cmp_ge_u32 s62, 12
  s_cselect_b32 s76, s72, s56
  s_lshl_b32 s60, s53, 2
  s_add_u32 s60, s60, 1
  s_mul_i32 s61, s60, 4682
  s_lshr_b32 s61, s61, 16
  s_mul_i32 s62, s61, 14
  s_sub_u32 s62, s60, s62
  s_and_b32 s63, s62, 3
  s_lshr_b32 s64, s62, 2
  s_lshl_b32 s65, s52, 1
  s_cmp_eq_u32 s64, 1
  s_cselect_b32 s71, 1, 0
  s_cmp_eq_u32 s64, 2
  s_cselect_b32 s71, 32, s71
  s_cmp_eq_u32 s64, 3
  s_cselect_b32 s71, 33, s71
  s_add_u32 s65, s65, s71
  s_add_u32 s65, s65, 96
  s_sub_u32 s72, s62, 12
  s_lshl_b32 s72, s72, 1
  s_cmp_ge_u32 s62, 12
  s_cselect_b32 s63, s72, s63
  s_lshl_b32 s61, s61, 2
  s_add_u32 s61, s61, s63
  s_mul_i32 s61, s61, 216
  s_add_u32 s61, s61, s65
  s_lshl_b32 s57, s61, 10
  s_add_u32 s72, s57, 221184
  s_cmp_ge_u32 s62, 12
  s_cselect_b32 s77, s72, s57
  s_lshl_b32 s60, s53, 2
  s_add_u32 s60, s60, 2
  s_mul_i32 s61, s60, 4682
  s_lshr_b32 s61, s61, 16
  s_mul_i32 s62, s61, 14
  s_sub_u32 s62, s60, s62
  s_and_b32 s63, s62, 3
  s_lshr_b32 s64, s62, 2
  s_lshl_b32 s65, s52, 1
  s_cmp_eq_u32 s64, 1
  s_cselect_b32 s71, 1, 0
  s_cmp_eq_u32 s64, 2
  s_cselect_b32 s71, 32, s71
  s_cmp_eq_u32 s64, 3
  s_cselect_b32 s71, 33, s71
  s_add_u32 s65, s65, s71
  s_add_u32 s65, s65, 96
  s_sub_u32 s72, s62, 12
  s_lshl_b32 s72, s72, 1
  s_cmp_ge_u32 s62, 12
  s_cselect_b32 s63, s72, s63
  s_lshl_b32 s61, s61, 2
  s_add_u32 s61, s61, s63
  s_mul_i32 s61, s61, 216
  s_add_u32 s61, s61, s65
  s_lshl_b32 s58, s61, 10
  s_add_u32 s72, s58, 221184
  s_cmp_ge_u32 s62, 12
  s_cselect_b32 s78, s72, s58
  s_lshl_b32 s60, s53, 2
  s_add_u32 s60, s60, 3
  s_mul_i32 s61, s60, 4682
  s_lshr_b32 s61, s61, 16
  s_mul_i32 s62, s61, 14
  s_sub_u32 s62, s60, s62
  s_and_b32 s63, s62, 3
  s_lshr_b32 s64, s62, 2
  s_lshl_b32 s65, s52, 1
  s_cmp_eq_u32 s64, 1
  s_cselect_b32 s71, 1, 0
  s_cmp_eq_u32 s64, 2
  s_cselect_b32 s71, 32, s71
  s_cmp_eq_u32 s64, 3
  s_cselect_b32 s71, 33, s71
  s_add_u32 s65, s65, s71
  s_add_u32 s65, s65, 96
  s_sub_u32 s72, s62, 12
  s_lshl_b32 s72, s72, 1
  s_cmp_ge_u32 s62, 12
  s_cselect_b32 s63, s72, s63
  s_lshl_b32 s61, s61, 2
  s_add_u32 s61, s61, s63
  s_mul_i32 s61, s61, 216
  s_add_u32 s61, s61, s65
  s_lshl_b32 s59, s61, 10
  s_add_u32 s72, s59, 221184
  s_cmp_ge_u32 s62, 12
  s_cselect_b32 s79, s72, s59
  s_branch P_go
P_s5:
  s_mov_b32 s48, s18
  s_mov_b32 s49, s19
  s_mov_b32 s50, 1024
  s_mov_b32 s51, 1835008
  s_sub_u32 s47, s23, 1216
  s_lshr_b32 s52, s47, 3
  s_and_b32 s53, s47, 7
  s_mul_i32 s61, s52, 9363
  s_lshr_b32 s61, s61, 16
  s_mul_i32 s62, s61, 7
  s_sub_u32 s62, s52, s62
  s_sub_u32 s63, s61, s53
  s_and_b32 s63, s63, 7
  s_mul_i32 s63, s63, 7
  s_add_u32 s64, s63, s62
  s_and_b32 s65, s64, 1
  s_lshr_b32 s64, s64, 1
  s_lshl_b32 s64, s64, 1
  s_add_u32 s64, s64, 160
  s_lshl_b32 s61, s53, 2
  s_cmp_eq_u32 s65, 0
  s_cselect_b32 s60, 0, 2
  s_cselect_b32 s72, 0, 1
  s_add_u32 s60, s60, s61
  s_mul_i32 s60, s60, 216
  s_add_u32 s60, s60, s64
  s_add_u32 s60, s60, s72
  s_lshl_b32 s56, s60, 10
  s_cmp_eq_u32 s65, 0
  s_cselect_b32 s60, 1, 3
  s_cselect_b32 s72, 0, 1
  s_add_u32 s60, s60, s61
  s_mul_i32 s60, s60, 216
  s_add_u32 s60, s60, s64
  s_add_u32 s60, s60, s72
  s_lshl_b32 s57, s60, 10
  s_cmp_eq_u32 s65, 1
  s_cselect_b32 s60, 2, 0
  s_cselect_b32 s72, 0, 1
  s_add_u32 s60, s60, s61
  s_mul_i32 s60, s60, 216
  s_add_u32 s60, s60, s64
  s_add_u32 s60, s60, s72
  s_lshl_b32 s58, s60, 10
  s_cmp_eq_u32 s65, 1
  s_cselect_b32 s60, 3, 1
  s_cselect_b32 s72, 0, 1
  s_add_u32 s60, s60, s61
  s_mul_i32 s60, s60, 216
  s_add_u32 s60, s60, s64
  s_add_u32 s60, s60, s72
  s_lshl_b32 s59, s60, 10
  s_mov_b32 s76, s56
  s_mov_b32 s77, s57
  s_mov_b32 s78, s58
  s_mov_b32 s79, s59
P_go:
  s_mov_b32 s66, s50
  s_mov_b32 s50, s51
  s_mov_b32 s51, 0x00020000
  v_mul_lo_u32 v14, v4, s66
  v_add_u32 v14, v14, v7
  s_mul_i32 s67, s52, s66
  s_lshl_b32 s67, s67, 5
  s_lshl_b32 s68, s53, 7
  s_add_u32 s67, s67, s68
  s_lshl_b32 s68, s66, 3
  s_lshl_b32 s69, s22, 12
  s_mov_b32 m0, s69
  s_nop 0
  buffer_load_dwordx4 v14, s[48:51], s67 offen lds
  s_add_u32 s67, s67, s68
  s_add_u32 m0, m0, 1024
  s_nop 0
  buffer_load_dwordx4 v14, s[48:51], s67 offen lds
  s_add_u32 s67, s67, s68
  s_add_u32 m0, m0, 1024
  s_nop 0
  buffer_load_dwordx4 v14, s[48:51], s67 offen lds
  s_add_u32 s67, s67, s68
  s_add_u32 m0, m0, 1024
  s_nop 0
  buffer_load_dwordx4 v14, s[48:51], s67 offen lds
  v_lshrrev_b32 v15, 4, v1
  v_lshlrev_b32 v15, 3, v15
  v_lshrrev_b32 v16, 2, v1
  v_and_b32 v16, 3, v16
  v_add_u32 v15, v15, v16
  v_lshlrev_b32 v15, 7, v15
  v_and_b32 v16, 3, v1
  v_lshlrev_b32 v16, 3, v16
  v_add_u32 v15, v15, v16
  v_add_u32 v15, s69, v15
  s_cmp_ge_u32 s23, 1928
  s_cbranch_scc1 P_nof_2
  s_add_u32 s70, s23, 0
  s_lshl_b32 s70, s70, 10
  s_add_u32 s70, s70, 262144
  v_mov_b32 v40, -1
  s_cmp_lg_u32 s70, 2099200
  s_cbranch_scc1 P_h_4
  v_cmp_gt_u32 vcc, 32, v1
  s_nop 1
  v_cndmask_b32_e64 v40, v40, 0, vcc
P_h_4:
  s_cmp_lg_u32 s70, 2162688
  s_cbranch_scc1 P_h_5
  v_cmp_le_u32 vcc, 32, v1
  s_nop 1
  v_cndmask_b32_e64 v40, v40, 0, vcc
P_h_5:
  s_cmp_lg_u32 s70, 2100224
  s_cbranch_scc1 P_h_6
  v_cmp_gt_u32 vcc, 32, v1
  s_nop 1
  v_cndmask_b32_e64 v40, v40, 0, vcc
P_h_6:
  s_cmp_lg_u32 s70, 2163712
  s_cbranch_scc1 P_h_7
  v_cmp_le_u32 vcc, 32, v1
  s_nop 1
  v_cndmask_b32_e64 v40, v40, 0, vcc
P_h_7:
  s_cmp_lg_u32 s70, 2168832
  s_cbranch_scc1 P_h_8
  v_cmp_gt_u32 vcc, 32, v1
  s_nop 1
  v_cndmask_b32_e64 v40, v40, 0, vcc
P_h_8:
  s_cmp_lg_u32 s70, 2232320
  s_cbranch_scc1 P_h_9
  v_cmp_le_u32 vcc, 32, v1
  s_nop 1
  v_cndmask_b32_e64 v40, v40, 0, vcc
P_h_9:
  s_cmp_lg_u32 s70, 2169856
  s_cbranch_scc1 P_h_10
  v_cmp_gt_u32 vcc, 32, v1
  s_nop 1
  v_cndmask_b32_e64 v40, v40, 0, vcc
P_h_10:
  s_cmp_lg_u32 s70, 2233344
  s_cbranch_scc1 P_h_11
  v_cmp_le_u32 vcc, 32, v1
  s_nop 1
  v_cndmask_b32_e64 v40, v40, 0, vcc
P_h_11:
  v_mov_b32 v41, v40
  v_mov_b32 v42, v40
  v_mov_b32 v43, v40
  buffer_store_dwordx4 v[40:43], v3, s[24:27], s70 offen
  s_nop 1
P_nof_2:
  s_cmp_ge_u32 s23, 256
  s_cbranch_scc1 P_fend_3
  s_lshl_b32 s70, s23, 10
  v_mov_b32 v44, 0
  v_mov_b32 v45, 0
  v_mov_b32 v46, 0
  v_mov_b32 v47, 0
  buffer_store_dwordx4 v[44:47], v3, s[24:27], s70 offen
P_fend_3:
  s_waitcnt vmcnt(1)
  buffer_store_dwordx4 v[8:11], v12, s[24:27], s46 offen
  ds_read_b64_tr_b16 v[20:21], v15 offset:0
  ds_read_b64_tr_b16 v[22:23], v15 offset:512
  ds_read_b64_tr_b16 v[24:25], v15 offset:32
  ds_read_b64_tr_b16 v[26:27], v15 offset:544
  ds_read_b64_tr_b16 v[28:29], v15 offset:64
  ds_read_b64_tr_b16 v[30:31], v15 offset:576
  ds_read_b64_tr_b16 v[32:33], v15 offset:96
  ds_read_b64_tr_b16 v[34:35], v15 offset:608
  s_waitcnt lgkmcnt(0)
  s_add_u32 s56, s56, 4194304
  buffer_store_dwordx4 v[20:23], v3, s[24:27], s56 offen
  s_add_u32 s76, s76, 4194304
  s_cmp_eq_u32 s76, s56
  s_cbranch_scc1 P_d2_12
  buffer_store_dwordx4 v[20:23], v3, s[24:27], s76 offen
P_d2_12:
  s_add_u32 s57, s57, 4194304
  buffer_store_dwordx4 v[24:27], v3, s[24:27], s57 offen
  s_add_u32 s77, s77, 4194304
  s_cmp_eq_u32 s77, s57
  s_cbranch_scc1 P_d2_13
  buffer_store_dwordx4 v[24:27], v3, s[24:27], s77 offen
P_d2_13:
  s_add_u32 s58, s58, 4194304
  buffer_store_dwordx4 v[28:31], v3, s[24:27], s58 offen
  s_add_u32 s78, s78, 4194304
  s_cmp_eq_u32 s78, s58
  s_cbranch_scc1 P_d2_14
  buffer_store_dwordx4 v[28:31], v3, s[24:27], s78 offen
P_d2_14:
  s_add_u32 s59, s59, 4194304
  buffer_store_dwordx4 v[32:35], v3, s[24:27], s59 offen
  s_add_u32 s79, s79, 4194304
  s_cmp_eq_u32 s79, s59
  s_cbranch_scc1 P_d2_15
  buffer_store_dwordx4 v[32:35], v3, s[24:27], s79 offen
P_d2_15:
  s_branch P_done
P_now:
  s_cmp_ge_u32 s23, 1928
  s_cbranch_scc1 P_nof_16
  s_add_u32 s70, s23, 0
  s_lshl_b32 s70, s70, 10
  s_add_u32 s70, s70, 262144
  v_mov_b32 v40, -1
  s_cmp_lg_u32 s70, 2099200
  s_cbranch_scc1 P_h_18
  v_cmp_gt_u32 vcc, 32, v1
  s_nop 1
  v_cndmask_b32_e64 v40, v40, 0, vcc
P_h_18:
  s_cmp_lg_u32 s70, 2162688
  s_cbranch_scc1 P_h_19
  v_cmp_le_u32 vcc, 32, v1
  s_nop 1
  v_cndmask_b32_e64 v40, v40, 0, vcc
P_h_19:
  s_cmp_lg_u32 s70, 2100224
  s_cbranch_scc1 P_h_20
  v_cmp_gt_u32 vcc, 32, v1
  s_nop 1
  v_cndmask_b32_e64 v40, v40, 0, vcc
P_h_20:
  s_cmp_lg_u32 s70, 2163712
  s_cbranch_scc1 P_h_21
  v_cmp_le_u32 vcc, 32, v1
  s_nop 1
  v_cndmask_b32_e64 v40, v40, 0, vcc
P_h_21:
  s_cmp_lg_u32 s70, 2168832
  s_cbranch_scc1 P_h_22
  v_cmp_gt_u32 vcc, 32, v1
  s_nop 1
  v_cndmask_b32_e64 v40, v40, 0, vcc
P_h_22:
  s_cmp_lg_u32 s70, 2232320
  s_cbranch_scc1 P_h_23
  v_cmp_le_u32 vcc, 32, v1
  s_nop 1
  v_cndmask_b32_e64 v40, v40, 0, vcc
P_h_23:
  s_cmp_lg_u32 s70, 2169856
  s_cbranch_scc1 P_h_24
  v_cmp_gt_u32 vcc, 32, v1
  s_nop 1
  v_cndmask_b32_e64 v40, v40, 0, vcc
P_h_24:
  s_cmp_lg_u32 s70, 2233344
  s_cbranch_scc1 P_h_25
  v_cmp_le_u32 vcc, 32, v1
  s_nop 1
  v_cndmask_b32_e64 v40, v40, 0, vcc
P_h_25:
  v_mov_b32 v41, v40
  v_mov_b32 v42, v40
  v_mov_b32 v43, v40
  buffer_store_dwordx4 v[40:43], v3, s[24:27], s70 offen
  s_nop 1
P_nof_16:
  s_cmp_ge_u32 s23, 256
  s_cbranch_scc1 P_fend_17
  s_lshl_b32 s70, s23, 10
  v_mov_b32 v44, 0
  v_mov_b32 v45, 0
  v_mov_b32 v46, 0
  v_mov_b32 v47, 0
  buffer_store_dwordx4 v[44:47], v3, s[24:27], s70 offen
P_fend_17:
  s_waitcnt vmcnt(0)
  buffer_store_dwordx4 v[8:11], v12, s[24:27], s46 offen
P_done:
  s_endpgm
.globl main_kernel
.p2align 8
.type main_kernel,@function
main_kernel:
  s_cmp_ge_u32 s2, 256
  s_cbranch_scc1 M_done
  s_load_dwordx2 s[8:9], s[0:1], 0
  s_load_dwordx2 s[10:11], s[0:1], 64
  s_load_dwordx2 s[38:39], s[0:1], 80
  v_and_b32 v1, 63, v0
  v_lshrrev_b32 v2, 6, v0
  s_nop 0
  v_readfirstlane_b32 s22, v2
  s_and_b32 s37, s2, 7
  s_lshr_b32 s26, s2, 3
  s_lshr_b32 s36, s26, 3
  s_and_b32 s21, s26, 7
  s_lshl_b32 s20, s37, 2
  s_add_u32 s20, s20, s36
  v_lshlrev_b32 v2, 4, v1
  v_lshlrev_b32 v3, 2, v1
  s_lshl_b32 s24, s20, 21
  s_add_u32 s24, s24, 16777216
  s_lshl_b32 s26, s21, 2
  s_add_u32 s26, s26, s22
  s_mul_i32 s34, s26, 221184
  s_add_u32 s34, s34, 4194304
  s_mov_b32 s25, s34
  s_waitcnt lgkmcnt(0)
  s_mov_b32 s4, s38
  s_mov_b32 s5, s39
  s_mov_b32 s6, 268435456
  s_mov_b32 s7, 0x00020000
  s_add_u32 s72, s24, 0
  s_lshl_b32 s26, s22, 12
  s_add_u32 s72, s72, s26
  s_mov_b32 s73, s26
  s_add_u32 m0, s73, 0
  s_nop 0
  buffer_load_dwordx4 v2, s[4:7], s72 offen offset:0 sc1 lds
  buffer_load_dwordx4 v2, s[4:7], s72 offen offset:1024 sc1 lds
  buffer_load_dwordx4 v2, s[4:7], s72 offen offset:2048 sc1 lds
  buffer_load_dwordx4 v2, s[4:7], s72 offen offset:3072 sc1 lds
  buffer_load_dwordx4 a[0:3], v2, s[4:7], s25 offen offset:0
  buffer_load_dwordx4 a[4:7], v2, s[4:7], s25 offen offset:1024
  buffer_load_dwordx4 a[8:11], v2, s[4:7], s25 offen offset:2048
  buffer_load_dwordx4 a[12:15], v2, s[4:7], s25 offen offset:3072
  s_add_u32 s72, s72, 16384
  s_add_u32 m0, s73, 16384
  s_nop 0
  buffer_load_dwordx4 v2, s[4:7], s72 offen offset:0 sc1 lds
  buffer_load_dwordx4 v2, s[4:7], s72 offen offset:1024 sc1 lds
  buffer_load_dwordx4 v2, s[4:7], s72 offen offset:2048 sc1 lds
  buffer_load_dwordx4 v2, s[4:7], s72 offen offset:3072 sc1 lds
  s_add_u32 s25, s25, 4096
  buffer_load_dwordx4 a[16:19], v2, s[4:7], s25 offen offset:0
  buffer_load_dwordx4 a[20:23], v2, s[4:7], s25 offen offset:1024
  buffer_load_dwordx4 a[24:27], v2, s[4:7], s25 offen offset:2048
  buffer_load_dwordx4 a[28:31], v2, s[4:7], s25 offen offset:3072
  s_mov_b32 s12, s8
  s_mov_b32 s13, s9
  s_mov_b32 s14, 2097152
  s_mov_b32 s15, 0x00020000
  s_mov_b32 s16, s10
  s_mov_b32 s17, s11
  s_mov_b32 s18, 2097152
  s_mov_b32 s19, 0x00020000
  s_getreg_b32 s35, hwreg(HW_REG_XCC_ID)
  s_and_b32 s35, s35, 15
  s_add_u32 s35, s35, 1
  v_mov_b32 v254, 1
  s_cmp_lg_u32 s22, 0
  s_cbranch_scc1 NX_1
  s_lshl_b32 s26, s2, 2
  s_add_u32 s26, s26, 237568
  v_mov_b32 v176, s35
  s_mov_b64 exec, 1
  buffer_store_dword v176, off, s[4:7], s26 sc1
  s_mov_b64 exec, -1
NX_1:
  s_mul_i32 s38, s21, 28672
  s_mul_i32 s33, s20, 7168
  s_and_b32 s27, s21, 1
  s_lshl_b32 s27, s27, 6
  s_lshr_b32 s28, s21, 1
  s_lshl_b32 s28, s28, 4
  s_add_u32 s27, s27, s28
  s_lshl_b32 s28, s22, 2
  s_add_u32 s27, s27, s28
  s_add_u32 s68, s27, s33
  s_lshr_b32 s27, s22, 1
  s_lshl_b32 s27, s27, 6
  s_add_u32 s28, s27, s33
  s_add_u32 s76, s4, s28
  s_addc_u32 s77, s5, 0
  s_xor_b32 s27, s27, 64
  s_add_u32 s28, s27, s33
  s_add_u32 s78, s4, s28
  s_addc_u32 s79, s5, 0
  s_lshl_b32 s69, s21, 13
  s_lshl_b32 s27, s22, 11
  s_add_u32 s69, s69, s27
  s_add_u32 s3, s69, s24
  v_and_b32 v196, 15, v1
  v_lshrrev_b32 v197, 4, v1
  s_add_u32 s26, s22, 0
  s_and_b32 s26, s26, 3
  s_lshl_b32 s27, s26, 8
  v_lshlrev_b32 v198, 10, v197
  v_lshlrev_b32 v199, 4, v196
  v_add3_u32 v4, v198, v199, s27
  v_mul_u32_u24 v198, 1280, v197
  v_add3_u32 v8, v198, v199, s27
  s_add_u32 s28, s27, 131072
  v_add_u32 v14, s28, v199
  s_lshl_b32 s28, s26, 6
  s_add_u32 s28, s28, 132096
  v_lshlrev_b32 v198, 4, v197
  v_add_u32 v18, s28, v198
  s_lshl_b32 s28, s26, 14
  v_lshlrev_b32 v198, 10, v196
  v_lshlrev_b32 v199, 3, v197
  v_add3_u32 v200, v198, v199, s28
  s_add_u32 s26, s22, 1
  s_and_b32 s26, s26, 3
  s_lshl_b32 s27, s26, 8
  v_lshlrev_b32 v198, 10, v197
  v_lshlrev_b32 v199, 4, v196
  v_add3_u32 v5, v198, v199, s27
  v_mul_u32_u24 v198, 1280, v197
  v_add3_u32 v9, v198, v199, s27
  s_add_u32 s28, s27, 131072
  v_add_u32 v15, s28, v199
  s_lshl_b32 s28, s26, 6
  s_add_u32 s28, s28, 132096
  v_lshlrev_b32 v198, 4, v197
  v_add_u32 v19, s28, v198
  s_lshl_b32 s28, s26, 14
  v_lshlrev_b32 v198, 10, v196
  v_lshlrev_b32 v199, 3, v197
  v_add3_u32 v201, v198, v199, s28
  s_add_u32 s26, s22, 2
  s_and_b32 s26, s26, 3
  s_lshl_b32 s27, s26, 8
  v_lshlrev_b32 v198, 10, v197
  v_lshlrev_b32 v199, 4, v196
  v_add3_u32 v6, v198, v199, s27
  v_mul_u32_u24 v198, 1280, v197
  v_add3_u32 v10, v198, v199, s27
  s_add_u32 s28, s27, 131072
  v_add_u32 v16, s28, v199
  s_lshl_b32 s28, s26, 6
  s_add_u32 s28, s28, 132096
  v_lshlrev_b32 v198, 4, v197
  v_add_u32 v20, s28, v198
  s_lshl_b32 s28, s26, 14
  v_lshlrev_b32 v198, 10, v196
  v_lshlrev_b32 v199, 3, v197
  v_add3_u32 v202, v198, v199, s28
  s_add_u32 s26, s22, 3
  s_and_b32 s26, s26, 3
  s_lshl_b32 s27, s26, 8
  v_lshlrev_b32 v198, 10, v197
  v_lshlrev_b32 v199, 4, v196
  v_add3_u32 v7, v198, v199, s27
  v_mul_u32_u24 v198, 1280, v197
  v_add3_u32 v11, v198, v199, s27
  s_add_u32 s28, s27, 131072
  v_add_u32 v17, s28, v199
  s_lshl_b32 s28, s26, 6
  s_add_u32 s28, s28, 132096
  v_lshlrev_b32 v198, 4, v197
  v_add_u32 v21, s28, v198
  s_lshl_b32 s28, s26, 14
  v_lshlrev_b32 v198, 10, v196
  v_lshlrev_b32 v199, 3, v197
  v_add3_u32 v203, v198, v199, s28
  s_lshl_b32 s26, s20, 16
  s_lshl_b32 s27, s21, 7
  s_add_u32 s26, s26, s27
  s_lshl_b32 s27, s22, 5
  s_add_u32 s26, s26, s27
  buffer_load_dwordx2 v[184:185], v200, s[12:15], s26 offen
  buffer_load_dwordx2 v[186:187], v201, s[12:15], s26 offen
  buffer_load_dwordx2 v[188:189], v202, s[12:15], s26 offen
  buffer_load_dwordx2 v[190:191], v203, s[12:15], s26 offen
  v_and_b32 v198, 1, v197
  v_add_u32 v198, s22, v198
  v_lshrrev_b32 v199, 1, v197
  v_lshlrev_b32 v199, 10, v199
  v_lshlrev_b32 v212, 4, v196
  v_add_u32 v213, 0, v198
  v_and_b32 v213, 3, v213
  v_lshlrev_b32 v213, 8, v213
  v_add3_u32 v12, v199, v212, v213
  v_add_u32 v213, 2, v198
  v_and_b32 v213, 3, v213
  v_lshlrev_b32 v213, 8, v213
  v_add3_u32 v13, v199, v212, v213
  s_and_b32 s26, s22, 1
  s_lshl_b32 s26, s26, 1
  s_add_u32 s26, s26, s22
  s_and_b32 s26, s26, 3
  s_lshl_b32 s26, s26, 8
  s_add_u32 s27, s22, 1
  s_and_b32 s27, s27, 3
  s_lshl_b32 s27, s27, 8
  v_lshlrev_b32 v213, 10, v197
  v_add3_u32 v237, v213, v212, s26
  s_add_u32 s28, s26, 131072
  v_add_u32 v238, s28, v212
  v_and_b32 v213, 1, v197
  v_cmp_eq_u32 vcc, 1, v213
  v_mov_b32 v213, s26
  v_mov_b32 v214, s27
  v_cndmask_b32 v213, v213, v214, vcc
  v_add3_u32 v239, v199, v212, v213
  s_and_b32 s26, s21, 2
  s_lshl_b32 s27, s21, 3
  s_lshl_b32 s28, s22, 1
  s_add_u32 s27, s27, s28
  s_lshl_b32 s27, s27, 5
  v_and_b32 v213, 1023, v12
  v_lshrrev_b32 v213, 4, v213
  v_lshrrev_b32 v214, 10, v12
  v_lshlrev_b32 v214, 5, v214
  s_cmp_eq_u32 s26, 0
  s_cbranch_scc0 HL_2
  v_cmp_le_u32 s[48:49], 62, v213
  v_subrev_u32 v213, 62, v213
  s_branch HL_3
HL_2:
  v_cmp_gt_u32 s[48:49], 2, v213
HL_3:
  v_lshlrev_b32 v213, 4, v213
  v_add3_u32 v22, v213, v214, s27
  v_and_b32 v213, 1023, v13
  v_lshrrev_b32 v213, 4, v213
  v_lshrrev_b32 v214, 10, v13
  v_lshlrev_b32 v214, 5, v214
  s_cmp_eq_u32 s26, 0
  s_cbranch_scc0 HL_4
  v_cmp_le_u32 s[50:51], 62, v213
  v_subrev_u32 v213, 62, v213
  s_branch HL_5
HL_4:
  v_cmp_gt_u32 s[50:51], 2, v213
HL_5:
  v_lshlrev_b32 v213, 4, v213
  v_add3_u32 v23, v213, v214, s27
  s_add_u32 s27, s20, 2
  s_cmp_eq_u32 s26, 0
  s_cselect_b32 s27, s27, s20
  s_lshl_b32 s62, s27, 11
  s_add_u32 s62, s62, 2097152
  s_add_u32 s27, s20, 1
  s_lshl_b32 s63, s27, 11
  s_add_u32 s63, s63, 2097152
  s_lshl_b32 s26, s37, 3
  s_add_u32 s26, s26, s21
  s_lshl_b32 s26, s26, 2
  s_add_u32 s26, s26, s22
  s_mul_i32 s64, s26, 5120
  s_add_u32 s64, s64, 262144
  s_lshl_b32 s26, s21, 2
  s_add_u32 s26, s26, s22
  s_lshl_b32 s66, s26, 13
  s_add_u32 s66, s66, 1572864
  s_lshl_b32 s26, s37, 10
  s_add_u32 s65, s66, s26
  s_mov_b32 s40, 0x22222222
  s_mov_b32 s41, 0x22222222
  s_mov_b32 s42, 0x44444444
  s_mov_b32 s43, 0x44444444
  s_mov_b32 s44, 0x88888888
  s_mov_b32 s45, 0x88888888
  s_mov_b32 s46, 0x00f0000f
  s_mov_b32 s47, 0xf0000f00
  s_lshr_b32 s26, s22, 1
  s_lshl_b32 s26, s26, 4
  s_lshl_b32 s52, 0xffff, s26
  s_mov_b32 s53, 0
  s_mov_b32 s54, -1
  s_mov_b32 s55, 0
  s_mov_b32 s59, 0x358637bd
  s_mov_b32 s60, 0x3b000000
  s_mov_b32 s61, 0x3727c5ac
  v_mov_b32 v24, 0x3f803f80
  v_mov_b32 v25, 0x3f803f80
  v_mov_b32 v26, 0x3f803f80
  v_mov_b32 v27, 0x3f803f80
  v_mov_b32 v28, 0xc0135761
  v_mov_b32 v29, 0xbdd2d3e8
  v_mov_b32 v30, 0x3fb8aa3b
  v_mov_b32 v31, 0x358637bd
  v_lshlrev_b32 v252, 5, v1
  s_lshl_b32 s26, s37, 2
  s_add_u32 s67, s26, 237568
  v_lshlrev_b32 v251, 7, v1
  s_waitcnt vmcnt(0)
  v_lshlrev_b32 v32, 16, v184
  v_and_b32 v33, 0xffff0000, v184
  v_lshlrev_b32 v34, 16, v185
  v_and_b32 v35, 0xffff0000, v185
  v_lshlrev_b32 v36, 16, v186
  v_and_b32 v37, 0xffff0000, v186
  v_lshlrev_b32 v38, 16, v187
  v_and_b32 v39, 0xffff0000, v187
  v_lshlrev_b32 v40, 16, v188
  v_and_b32 v41, 0xffff0000, v188
  v_lshlrev_b32 v42, 16, v189
  v_and_b32 v43, 0xffff0000, v189
  v_lshlrev_b32 v44, 16, v190
  v_and_b32 v45, 0xffff0000, v190
  v_lshlrev_b32 v46, 16, v191
  v_and_b32 v47, 0xffff0000, v191
  s_barrier
  ds_read_b128 v[188:191], v4 offset:0
  ds_read_b128 v[192:195], v5 offset:0
  ds_read_b128 v[196:199], v6 offset:0
  ds_read_b128 v[200:203], v7 offset:0
  ds_read_b128 v[204:207], v4 offset:4096
  ds_read_b128 v[208:211], v5 offset:4096
  ds_read_b128 v[212:215], v6 offset:4096
  ds_read_b128 v[216:219], v7 offset:4096
  s_waitcnt lgkmcnt(4)
  v_mfma_f32_16x16x32_bf16 v[104:107], v[188:191], a[0:3], 0
  ds_read_b128 v[220:223], v4 offset:8192
  v_mfma_f32_16x16x32_bf16 v[108:111], v[192:195], a[0:3], 0
  ds_read_b128 v[224:227], v5 offset:8192
  v_mfma_f32_16x16x32_bf16 v[112:115], v[196:199], a[0:3], 0
  ds_read_b128 v[228:231], v6 offset:8192
  v_mfma_f32_16x16x32_bf16 v[116:119], v[200:203], a[0:3], 0
  ds_read_b128 v[232:235], v7 offset:8192
  s_add_u32 s25, s25, 4096
  buffer_load_dwordx4 a[32:35], v2, s[4:7], s25 offen offset:0
  v_mfma_f32_16x16x32_bf16 v[120:123], v[188:191], a[4:7], 0
  v_mfma_f32_16x16x32_bf16 v[124:127], v[192:195], a[4:7], 0
  v_mfma_f32_16x16x32_bf16 v[128:131], v[196:199], a[4:7], 0
  v_mfma_f32_16x16x32_bf16 v[132:135], v[200:203], a[4:7], 0
  buffer_load_dwordx4 a[36:39], v2, s[4:7], s25 offen offset:1024
  v_mfma_f32_16x16x32_bf16 v[152:155], v[24:27], v[188:191], 0
  v_mfma_f32_16x16x32_bf16 v[156:159], v[188:191], v[188:191], 0
  v_mfma_f32_16x16x32_bf16 v[76:79], v[24:27], a[0:3], 0
  v_mfma_f32_16x16x32_bf16 v[80:83], v[24:27], a[4:7], 0
  s_add_u32 s72, s72, 16384
  s_add_u32 m0, s73, 32768
  s_nop 0
  buffer_load_dwordx4 v2, s[4:7], s72 offen offset:0 sc1 lds
  s_waitcnt lgkmcnt(4)
  v_mfma_f32_16x16x32_bf16 v[104:107], v[204:207], a[8:11], v[104:107]
  ds_read_b128 v[188:191], v4 offset:12288
  v_mfma_f32_16x16x32_bf16 v[108:111], v[208:211], a[8:11], v[108:111]
  ds_read_b128 v[192:195], v5 offset:12288
  v_mfma_f32_16x16x32_bf16 v[112:115], v[212:215], a[8:11], v[112:115]
  ds_read_b128 v[196:199], v6 offset:12288
  v_mfma_f32_16x16x32_bf16 v[116:119], v[216:219], a[8:11], v[116:119]
  ds_read_b128 v[200:203], v7 offset:12288
  buffer_load_dwordx4 a[40:43], v2, s[4:7], s25 offen offset:2048
  v_mfma_f32_16x16x32_bf16 v[120:123], v[204:207], a[12:15], v[120:123]
  v_mfma_f32_16x16x32_bf16 v[124:127], v[208:211], a[12:15], v[124:127]
  v_mfma_f32_16x16x32_bf16 v[128:131], v[212:215], a[12:15], v[128:131]
  v_mfma_f32_16x16x32_bf16 v[132:135], v[216:219], a[12:15], v[132:135]
  buffer_load_dwordx4 a[44:47], v2, s[4:7], s25 offen offset:3072
  v_mfma_f32_16x16x32_bf16 v[152:155], v[24:27], v[204:207], v[152:155]
  v_mfma_f32_16x16x32_bf16 v[156:159], v[204:207], v[204:207], v[156:159]
  v_mfma_f32_16x16x32_bf16 v[76:79], v[24:27], a[8:11], v[76:79]
  v_mfma_f32_16x16x32_bf16 v[80:83], v[24:27], a[12:15], v[80:83]
  buffer_load_dwordx4 v2, s[4:7], s72 offen offset:1024 sc1 lds
  s_barrier
  s_waitcnt lgkmcnt(4)
  v_mfma_f32_16x16x32_bf16 v[104:107], v[220:223], a[16:19], v[104:107]
  ds_read_b128 v[204:207], v4 offset:16384
  v_mfma_f32_16x16x32_bf16 v[108:111], v[224:227], a[16:19], v[108:111]
  ds_read_b128 v[208:211], v5 offset:16384
  v_mfma_f32_16x16x32_bf16 v[112:115], v[228:231], a[16:19], v[112:115]
  ds_read_b128 v[212:215], v6 offset:16384
  v_mfma_f32_16x16x32_bf16 v[116:119], v[232:235], a[16:19], v[116:119]
  ds_read_b128 v[216:219], v7 offset:16384
  s_add_u32 s25, s25, 4096
  buffer_load_dwordx4 a[48:51], v2, s[4:7], s25 offen offset:0
  v_mfma_f32_16x16x32_bf16 v[120:123], v[220:223], a[20:23], v[120:123]
  v_mfma_f32_16x16x32_bf16 v[124:127], v[224:227], a[20:23], v[124:127]
  v_mfma_f32_16x16x32_bf16 v[128:131], v[228:231], a[20:23], v[128:131]
  v_mfma_f32_16x16x32_bf16 v[132:135], v[232:235], a[20:23], v[132:135]
  buffer_load_dwordx4 a[52:55], v2, s[4:7], s25 offen offset:1024
  v_mfma_f32_16x16x32_bf16 v[152:155], v[24:27], v[220:223], v[152:155]
  v_mfma_f32_16x16x32_bf16 v[156:159], v[220:223], v[220:223], v[156:159]
  v_mfma_f32_16x16x32_bf16 v[76:79], v[24:27], a[16:19], v[76:79]
  v_mfma_f32_16x16x32_bf16 v[80:83], v[24:27], a[20:23], v[80:83]
  buffer_load_dwordx4 v2, s[4:7], s72 offen offset:2048 sc1 lds
  s_waitcnt lgkmcnt(4)
  v_mfma_f32_16x16x32_bf16 v[104:107], v[188:191], a[24:27], v[104:107]
  ds_read_b128 v[220:223], v4 offset:20480
  v_mfma_f32_16x16x32_bf16 v[108:111], v[192:195], a[24:27], v[108:111]
  ds_read_b128 v[224:227], v5 offset:20480
  v_mfma_f32_16x16x32_bf16 v[112:115], v[196:199], a[24:27], v[112:115]
  ds_read_b128 v[228:231], v6 offset:20480
  v_mfma_f32_16x16x32_bf16 v[116:119], v[200:203], a[24:27], v[116:119]
  ds_read_b128 v[232:235], v7 offset:20480
  buffer_load_dwordx4 a[56:59], v2, s[4:7], s25 offen offset:2048
  v_mfma_f32_16x16x32_bf16 v[120:123], v[188:191], a[28:31], v[120:123]
  v_mfma_f32_16x16x32_bf16 v[124:127], v[192:195], a[28:31], v[124:127]
  v_mfma_f32_16x16x32_bf16 v[128:131], v[196:199], a[28:31], v[128:131]
  v_mfma_f32_16x16x32_bf16 v[132:135], v[200:203], a[28:31], v[132:135]
  buffer_load_dwordx4 a[60:63], v2, s[4:7], s25 offen offset:3072
  v_mfma_f32_16x16x32_bf16 v[152:155], v[24:27], v[188:191], v[152:155]
  v_mfma_f32_16x16x32_bf16 v[156:159], v[188:191], v[188:191], v[156:159]
  v_mfma_f32_16x16x32_bf16 v[76:79], v[24:27], a[24:27], v[76:79]
  v_mfma_f32_16x16x32_bf16 v[80:83], v[24:27], a[28:31], v[80:83]
  buffer_load_dwordx4 v2, s[4:7], s72 offen offset:3072 sc1 lds
  s_waitcnt vmcnt(10) lgkmcnt(4)
  v_mfma_f32_16x16x32_bf16 v[104:107], v[204:207], a[32:35], v[104:107]
  ds_read_b128 v[188:191], v4 offset:24576
  v_mfma_f32_16x16x32_bf16 v[108:111], v[208:211], a[32:35], v[108:111]
  ds_read_b128 v[192:195], v5 offset:24576
  v_mfma_f32_16x16x32_bf16 v[112:115], v[212:215], a[32:35], v[112:115]
  ds_read_b128 v[196:199], v6 offset:24576
  v_mfma_f32_16x16x32_bf16 v[116:119], v[216:219], a[32:35], v[116:119]
  ds_read_b128 v[200:203], v7 offset:24576
  s_add_u32 s25, s25, 4096
  buffer_load_dwordx4 a[64:67], v2, s[4:7], s25 offen offset:0
  v_mfma_f32_16x16x32_bf16 v[120:123], v[204:207], a[36:39], v[120:123]
  v_mfma_f32_16x16x32_bf16 v[124:127], v[208:211], a[36:39], v[124:127]
  v_mfma_f32_16x16x32_bf16 v[128:131], v[212:215], a[36:39], v[128:131]
  v_mfma_f32_16x16x32_bf16 v[132:135], v[216:219], a[36:39], v[132:135]
  buffer_load_dwordx4 a[68:71], v2, s[4:7], s25 offen offset:1024
  v_mfma_f32_16x16x32_bf16 v[152:155], v[24:27], v[204:207], v[152:155]
  v_mfma_f32_16x16x32_bf16 v[156:159], v[204:207], v[204:207], v[156:159]
  v_mfma_f32_16x16x32_bf16 v[76:79], v[24:27], a[32:35], v[76:79]
  v_mfma_f32_16x16x32_bf16 v[80:83], v[24:27], a[36:39], v[80:83]
  s_add_u32 s72, s72, 16384
  s_add_u32 m0, s73, 49152
  s_nop 0
  buffer_load_dwordx4 v2, s[4:7], s72 offen offset:0 sc1 lds
  s_waitcnt vmcnt(10) lgkmcnt(4)
  v_mfma_f32_16x16x32_bf16 v[104:107], v[220:223], a[40:43], v[104:107]
  ds_read_b128 v[204:207], v4 offset:28672
  v_mfma_f32_16x16x32_bf16 v[108:111], v[224:227], a[40:43], v[108:111]
  ds_read_b128 v[208:211], v5 offset:28672
  v_mfma_f32_16x16x32_bf16 v[112:115], v[228:231], a[40:43], v[112:115]
  ds_read_b128 v[212:215], v6 offset:28672
  v_mfma_f32_16x16x32_bf16 v[116:119], v[232:235], a[40:43], v[116:119]
  ds_read_b128 v[216:219], v7 offset:28672
  buffer_load_dwordx4 a[72:75], v2, s[4:7], s25 offen offset:2048
  v_mfma_f32_16x16x32_bf16 v[120:123], v[220:223], a[44:47], v[120:123]
  v_mfma_f32_16x16x32_bf16 v[124:127], v[224:227], a[44:47], v[124:127]
  v_mfma_f32_16x16x32_bf16 v[128:131], v[228:231], a[44:47], v[128:131]
  v_mfma_f32_16x16x32_bf16 v[132:135], v[232:235], a[44:47], v[132:135]
  buffer_load_dwordx4 a[76:79], v2, s[4:7], s25 offen offset:3072
  v_mfma_f32_16x16x32_bf16 v[152:155], v[24:27], v[220:223], v[152:155]
  v_mfma_f32_16x16x32_bf16 v[156:159], v[220:223], v[220:223], v[156:159]
  v_mfma_f32_16x16x32_bf16 v[76:79], v[24:27], a[40:43], v[76:79]
  v_mfma_f32_16x16x32_bf16 v[80:83], v[24:27], a[44:47], v[80:83]
  buffer_load_dwordx4 v2, s[4:7], s72 offen offset:1024 sc1 lds
  s_waitcnt vmcnt(6)
  s_barrier
  s_waitcnt lgkmcnt(4)
  v_mfma_f32_16x16x32_bf16 v[104:107], v[188:191], a[48:51], v[104:107]
  ds_read_b128 v[220:223], v4 offset:32768
  v_mfma_f32_16x16x32_bf16 v[108:111], v[192:195], a[48:51], v[108:111]
  ds_read_b128 v[224:227], v5 offset:32768
  v_mfma_f32_16x16x32_bf16 v[112:115], v[196:199], a[48:51], v[112:115]
  ds_read_b128 v[228:231], v6 offset:32768
  v_mfma_f32_16x16x32_bf16 v[116:119], v[200:203], a[48:51], v[116:119]
  ds_read_b128 v[232:235], v7 offset:32768
  s_add_u32 s25, s25, 4096
  buffer_load_dwordx4 a[80:83], v2, s[4:7], s25 offen offset:0
  v_mfma_f32_16x16x32_bf16 v[120:123], v[188:191], a[52:55], v[120:123]
  v_mfma_f32_16x16x32_bf16 v[124:127], v[192:195], a[52:55], v[124:127]
  v_mfma_f32_16x16x32_bf16 v[128:131], v[196:199], a[52:55], v[128:131]
  v_mfma_f32_16x16x32_bf16 v[132:135], v[200:203], a[52:55], v[132:135]
  buffer_load_dwordx4 a[84:87], v2, s[4:7], s25 offen offset:1024
  v_mfma_f32_16x16x32_bf16 v[152:155], v[24:27], v[188:191], v[152:155]
  v_mfma_f32_16x16x32_bf16 v[156:159], v[188:191], v[188:191], v[156:159]
  v_mfma_f32_16x16x32_bf16 v[76:79], v[24:27], a[48:51], v[76:79]
  v_mfma_f32_16x16x32_bf16 v[80:83], v[24:27], a[52:55], v[80:83]
  buffer_load_dwordx4 v2, s[4:7], s72 offen offset:2048 sc1 lds
  s_waitcnt lgkmcnt(4)
  v_mfma_f32_16x16x32_bf16 v[104:107], v[204:207], a[56:59], v[104:107]
  ds_read_b128 v[188:191], v4 offset:36864
  v_mfma_f32_16x16x32_bf16 v[108:111], v[208:211], a[56:59], v[108:111]
  ds_read_b128 v[192:195], v5 offset:36864
  v_mfma_f32_16x16x32_bf16 v[112:115], v[212:215], a[56:59], v[112:115]
  ds_read_b128 v[196:199], v6 offset:36864
  v_mfma_f32_16x16x32_bf16 v[116:119], v[216:219], a[56:59], v[116:119]
  ds_read_b128 v[200:203], v7 offset:36864
  buffer_load_dwordx4 a[88:91], v2, s[4:7], s25 offen offset:2048
  v_mfma_f32_16x16x32_bf16 v[120:123], v[204:207], a[60:63], v[120:123]
  v_mfma_f32_16x16x32_bf16 v[124:127], v[208:211], a[60:63], v[124:127]
  v_mfma_f32_16x16x32_bf16 v[128:131], v[212:215], a[60:63], v[128:131]
  v_mfma_f32_16x16x32_bf16 v[132:135], v[216:219], a[60:63], v[132:135]
  buffer_load_dwordx4 a[92:95], v2, s[4:7], s25 offen offset:3072
  v_mfma_f32_16x16x32_bf16 v[152:155], v[24:27], v[204:207], v[152:155]
  v_mfma_f32_16x16x32_bf16 v[156:159], v[204:207], v[204:207], v[156:159]
  v_mfma_f32_16x16x32_bf16 v[76:79], v[24:27], a[56:59], v[76:79]
  v_mfma_f32_16x16x32_bf16 v[80:83], v[24:27], a[60:63], v[80:83]
  buffer_load_dwordx4 v2, s[4:7], s72 offen offset:3072 sc1 lds
  s_waitcnt vmcnt(10) lgkmcnt(4)
  v_mfma_f32_16x16x32_bf16 v[104:107], v[220:223], a[64:67], v[104:107]
  ds_read_b128 v[204:207], v4 offset:40960
  v_mfma_f32_16x16x32_bf16 v[108:111], v[224:227], a[64:67], v[108:111]
  ds_read_b128 v[208:211], v5 offset:40960
  v_mfma_f32_16x16x32_bf16 v[112:115], v[228:231], a[64:67], v[112:115]
  ds_read_b128 v[212:215], v6 offset:40960
  v_mfma_f32_16x16x32_bf16 v[116:119], v[232:235], a[64:67], v[116:119]
  ds_read_b128 v[216:219], v7 offset:40960
  s_add_u32 s25, s25, 4096
  buffer_load_dwordx4 a[96:99], v2, s[4:7], s25 offen offset:0
  v_mfma_f32_16x16x32_bf16 v[120:123], v[220:223], a[68:71], v[120:123]
  v_mfma_f32_16x16x32_bf16 v[124:127], v[224:227], a[68:71], v[124:127]
  v_mfma_f32_16x16x32_bf16 v[128:131], v[228:231], a[68:71], v[128:131]
  v_mfma_f32_16x16x32_bf16 v[132:135], v[232:235], a[68:71], v[132:135]
  buffer_load_dwordx4 a[100:103], v2, s[4:7], s25 offen offset:1024
  v_mfma_f32_16x16x32_bf16 v[152:155], v[24:27], v[220:223], v[152:155]
  v_mfma_f32_16x16x32_bf16 v[156:159], v[220:223], v[220:223], v[156:159]
  v_mfma_f32_16x16x32_bf16 v[76:79], v[24:27], a[64:67], v[76:79]
  v_mfma_f32_16x16x32_bf16 v[80:83], v[24:27], a[68:71], v[80:83]
  buffer_load_dwordx4 a[104:107], v2, s[4:7], s25 offen offset:2048
  s_waitcnt vmcnt(10) lgkmcnt(4)
  v_mfma_f32_16x16x32_bf16 v[104:107], v[188:191], a[72:75], v[104:107]
  ds_read_b128 v[220:223], v4 offset:45056
  v_mfma_f32_16x16x32_bf16 v[108:111], v[192:195], a[72:75], v[108:111]
  ds_read_b128 v[224:227], v5 offset:45056
  v_mfma_f32_16x16x32_bf16 v[112:115], v[196:199], a[72:75], v[112:115]
  ds_read_b128 v[228:231], v6 offset:45056
  v_mfma_f32_16x16x32_bf16 v[116:119], v[200:203], a[72:75], v[116:119]
  ds_read_b128 v[232:235], v7 offset:45056
  buffer_load_dwordx4 a[108:111], v2, s[4:7], s25 offen offset:3072
  v_mfma_f32_16x16x32_bf16 v[120:123], v[188:191], a[76:79], v[120:123]
  v_mfma_f32_16x16x32_bf16 v[124:127], v[192:195], a[76:79], v[124:127]
  v_mfma_f32_16x16x32_bf16 v[128:131], v[196:199], a[76:79], v[128:131]
  v_mfma_f32_16x16x32_bf16 v[132:135], v[200:203], a[76:79], v[132:135]
  s_add_u32 s25, s25, 4096
  buffer_load_dwordx4 a[112:115], v2, s[4:7], s25 offen offset:0
  v_mfma_f32_16x16x32_bf16 v[152:155], v[24:27], v[188:191], v[152:155]
  v_mfma_f32_16x16x32_bf16 v[156:159], v[188:191], v[188:191], v[156:159]
  v_mfma_f32_16x16x32_bf16 v[76:79], v[24:27], a[72:75], v[76:79]
  v_mfma_f32_16x16x32_bf16 v[80:83], v[24:27], a[76:79], v[80:83]
  buffer_load_dwordx4 a[116:119], v2, s[4:7], s25 offen offset:1024
  s_mov_b32 exec_lo, -1
  s_mov_b32 exec_hi, 0
  buffer_load_dword v255, v252, s[4:7], s67 offen sc1
  s_mov_b64 exec, -1
  s_waitcnt vmcnt(7)
  s_barrier
  s_waitcnt lgkmcnt(4)
  v_mfma_f32_16x16x32_bf16 v[104:107], v[204:207], a[80:83], v[104:107]
  ds_read_b128 v[188:191], v4 offset:49152
  v_mfma_f32_16x16x32_bf16 v[108:111], v[208:211], a[80:83], v[108:111]
  ds_read_b128 v[192:195], v5 offset:49152
  v_mfma_f32_16x16x32_bf16 v[112:115], v[212:215], a[80:83], v[112:115]
  ds_read_b128 v[196:199], v6 offset:49152
  v_mfma_f32_16x16x32_bf16 v[116:119], v[216:219], a[80:83], v[116:119]
  ds_read_b128 v[200:203], v7 offset:49152
  s_mul_i32 s26, s36, 1280
  s_add_u32 s26, s26, s64
  s_add_u32 s26, s26, 0
  buffer_load_dwordx4 v[48:51], v2, s[4:7], s26 offen
  buffer_load_dword v48, v3, s[4:7], s26 offen offset:1024
  v_mfma_f32_16x16x32_bf16 v[120:123], v[204:207], a[84:87], v[120:123]
  v_mfma_f32_16x16x32_bf16 v[124:127], v[208:211], a[84:87], v[124:127]
  v_mfma_f32_16x16x32_bf16 v[128:131], v[212:215], a[84:87], v[128:131]
  v_mfma_f32_16x16x32_bf16 v[132:135], v[216:219], a[84:87], v[132:135]
  buffer_load_dwordx4 a[120:123], v2, s[4:7], s25 offen offset:2048
  v_mfma_f32_16x16x32_bf16 v[152:155], v[24:27], v[204:207], v[152:155]
  v_mfma_f32_16x16x32_bf16 v[156:159], v[204:207], v[204:207], v[156:159]
  v_mfma_f32_16x16x32_bf16 v[76:79], v[24:27], a[80:83], v[76:79]
  v_mfma_f32_16x16x32_bf16 v[80:83], v[24:27], a[84:87], v[80:83]
  buffer_load_dwordx4 a[124:127], v2, s[4:7], s25 offen offset:3072
  s_waitcnt lgkmcnt(4)
  v_mfma_f32_16x16x32_bf16 v[104:107], v[220:223], a[88:91], v[104:107]
  ds_read_b128 v[204:207], v4 offset:53248
  v_mfma_f32_16x16x32_bf16 v[108:111], v[224:227], a[88:91], v[108:111]
  ds_read_b128 v[208:211], v5 offset:53248
  v_mfma_f32_16x16x32_bf16 v[112:115], v[228:231], a[88:91], v[112:115]
  ds_read_b128 v[212:215], v6 offset:53248
  v_mfma_f32_16x16x32_bf16 v[116:119], v[232:235], a[88:91], v[116:119]
  ds_read_b128 v[216:219], v7 offset:53248
  s_add_u32 s25, s25, 4096
  buffer_load_dwordx4 a[128:131], v2, s[4:7], s25 offen offset:0
  v_mfma_f32_16x16x32_bf16 v[120:123], v[220:223], a[92:95], v[120:123]
  v_mfma_f32_16x16x32_bf16 v[124:127], v[224:227], a[92:95], v[124:127]
  v_mfma_f32_16x16x32_bf16 v[128:131], v[228:231], a[92:95], v[128:131]
  v_mfma_f32_16x16x32_bf16 v[132:135], v[232:235], a[92:95], v[132:135]
  buffer_load_dwordx4 a[132:135], v2, s[4:7], s25 offen offset:1024
  v_mfma_f32_16x16x32_bf16 v[152:155], v[24:27], v[220:223], v[152:155]
  v_mfma_f32_16x16x32_bf16 v[156:159], v[220:223], v[220:223], v[156:159]
  v_mfma_f32_16x16x32_bf16 v[76:79], v[24:27], a[88:91], v[76:79]
  v_mfma_f32_16x16x32_bf16 v[80:83], v[24:27], a[92:95], v[80:83]
  buffer_load_dwordx4 a[136:139], v2, s[4:7], s25 offen offset:2048
  s_waitcnt vmcnt(12) lgkmcnt(4)
  v_mfma_f32_16x16x32_bf16 v[104:107], v[188:191], a[96:99], v[104:107]
  ds_read_b128 v[220:223], v4 offset:57344
  v_mfma_f32_16x16x32_bf16 v[108:111], v[192:195], a[96:99], v[108:111]
  ds_read_b128 v[224:227], v5 offset:57344
  v_mfma_f32_16x16x32_bf16 v[112:115], v[196:199], a[96:99], v[112:115]
  ds_read_b128 v[228:231], v6 offset:57344
  v_mfma_f32_16x16x32_bf16 v[116:119], v[200:203], a[96:99], v[116:119]
  ds_read_b128 v[232:235], v7 offset:57344
  buffer_load_dwordx4 a[140:143], v2, s[4:7], s25 offen offset:3072
  v_mfma_f32_16x16x32_bf16 v[120:123], v[188:191], a[100:103], v[120:123]
  v_mfma_f32_16x16x32_bf16 v[124:127], v[192:195], a[100:103], v[124:127]
  v_mfma_f32_16x16x32_bf16 v[128:131], v[196:199], a[100:103], v[128:131]
  v_mfma_f32_16x16x32_bf16 v[132:135], v[200:203], a[100:103], v[132:135]
  s_add_u32 s25, s25, 4096
  buffer_load_dwordx4 a[144:147], v2, s[4:7], s25 offen offset:0
  v_mfma_f32_16x16x32_bf16 v[152:155], v[24:27], v[188:191], v[152:155]
  v_mfma_f32_16x16x32_bf16 v[156:159], v[188:191], v[188:191], v[156:159]
  v_mfma_f32_16x16x32_bf16 v[76:79], v[24:27], a[96:99], v[76:79]
  v_mfma_f32_16x16x32_bf16 v[80:83], v[24:27], a[100:103], v[80:83]
  buffer_load_dwordx4 a[148:151], v2, s[4:7], s25 offen offset:1024
  s_waitcnt vmcnt(13) lgkmcnt(4)
  v_mfma_f32_16x16x32_bf16 v[104:107], v[204:207], a[104:107], v[104:107]
  ds_read_b128 v[188:191], v4 offset:61440
  v_mfma_f32_16x16x32_bf16 v[108:111], v[208:211], a[104:107], v[108:111]
  ds_read_b128 v[192:195], v5 offset:61440
  v_mfma_f32_16x16x32_bf16 v[112:115], v[212:215], a[104:107], v[112:115]
  ds_read_b128 v[196:199], v6 offset:61440
  v_mfma_f32_16x16x32_bf16 v[116:119], v[216:219], a[104:107], v[116:119]
  ds_read_b128 v[200:203], v7 offset:61440
  buffer_load_dwordx4 a[152:155], v2, s[4:7], s25 offen offset:2048
  v_mfma_f32_16x16x32_bf16 v[120:123], v[204:207], a[108:111], v[120:123]
  v_mfma_f32_16x16x32_bf16 v[124:127], v[208:211], a[108:111], v[124:127]
  v_mfma_f32_16x16x32_bf16 v[128:131], v[212:215], a[108:111], v[128:131]
  v_mfma_f32_16x16x32_bf16 v[132:135], v[216:219], a[108:111], v[132:135]
  buffer_load_dwordx4 a[156:159], v2, s[4:7], s25 offen offset:3072
  v_mfma_f32_16x16x32_bf16 v[152:155], v[24:27], v[204:207], v[152:155]
  v_mfma_f32_16x16x32_bf16 v[156:159], v[204:207], v[204:207], v[156:159]
  v_mfma_f32_16x16x32_bf16 v[76:79], v[24:27], a[104:107], v[76:79]
  v_mfma_f32_16x16x32_bf16 v[80:83], v[24:27], a[108:111], v[80:83]
  s_add_u32 s25, s25, 4096
  buffer_load_dwordx4 a[160:163], v2, s[4:7], s25 offen offset:0
  s_waitcnt vmcnt(14) lgkmcnt(4)
  v_mfma_f32_16x16x32_bf16 v[104:107], v[220:223], a[112:115], v[104:107]
  v_mfma_f32_16x16x32_bf16 v[108:111], v[224:227], a[112:115], v[108:111]
  v_mfma_f32_16x16x32_bf16 v[112:115], v[228:231], a[112:115], v[112:115]
  v_mfma_f32_16x16x32_bf16 v[116:119], v[232:235], a[112:115], v[116:119]
  buffer_load_dwordx4 a[164:167], v2, s[4:7], s25 offen offset:1024
  v_mfma_f32_16x16x32_bf16 v[120:123], v[220:223], a[116:119], v[120:123]
  v_mfma_f32_16x16x32_bf16 v[124:127], v[224:227], a[116:119], v[124:127]
  v_mfma_f32_16x16x32_bf16 v[128:131], v[228:231], a[116:119], v[128:131]
  v_mfma_f32_16x16x32_bf16 v[132:135], v[232:235], a[116:119], v[132:135]
  buffer_load_dwordx4 a[168:171], v2, s[4:7], s25 offen offset:2048
  v_mfma_f32_16x16x32_bf16 v[152:155], v[24:27], v[220:223], v[152:155]
  v_mfma_f32_16x16x32_bf16 v[156:159], v[220:223], v[220:223], v[156:159]
  v_mfma_f32_16x16x32_bf16 v[76:79], v[24:27], a[112:115], v[76:79]
  v_mfma_f32_16x16x32_bf16 v[80:83], v[24:27], a[116:119], v[80:83]
  buffer_load_dwordx4 a[172:175], v2, s[4:7], s25 offen offset:3072
  s_waitcnt vmcnt(12) lgkmcnt(0)
  v_mfma_f32_16x16x32_bf16 v[104:107], v[188:191], a[120:123], v[104:107]
  v_mfma_f32_16x16x32_bf16 v[108:111], v[192:195], a[120:123], v[108:111]
  v_mfma_f32_16x16x32_bf16 v[112:115], v[196:199], a[120:123], v[112:115]
  v_mfma_f32_16x16x32_bf16 v[116:119], v[200:203], a[120:123], v[116:119]
  s_add_u32 s25, s25, 4096
  buffer_load_dwordx4 a[176:179], v2, s[4:7], s25 offen offset:0
  v_mfma_f32_16x16x32_bf16 v[120:123], v[188:191], a[124:127], v[120:123]
  v_mfma_f32_16x16x32_bf16 v[124:127], v[192:195], a[124:127], v[124:127]
  v_mfma_f32_16x16x32_bf16 v[128:131], v[196:199], a[124:127], v[128:131]
  v_mfma_f32_16x16x32_bf16 v[132:135], v[200:203], a[124:127], v[132:135]
  buffer_load_dwordx4 a[180:183], v2, s[4:7], s25 offen offset:1024
  v_mfma_f32_16x16x32_bf16 v[152:155], v[24:27], v[188:191], v[152:155]
  v_mfma_f32_16x16x32_bf16 v[156:159], v[188:191], v[188:191], v[156:159]
  v_mfma_f32_16x16x32_bf16 v[76:79], v[24:27], a[120:123], v[76:79]
  v_mfma_f32_16x16x32_bf16 v[80:83], v[24:27], a[124:127], v[80:83]
  buffer_load_dwordx4 a[184:187], v2, s[4:7], s25 offen offset:2048
  v_and_b32 v232, 15, v1
  v_lshrrev_b32 v233, 4, v1
  v_lshlrev_b32 v233, 2, v233
  v_sub_u32 v232, v232, v233
  v_cmp_eq_u32 vcc, 0, v232
  v_mov_b32 v233, 0x3f80
  s_nop 0
  v_cndmask_b32 v234, 0, v233, vcc
  v_cmp_eq_u32 vcc, 1, v232
  v_mov_b32 v233, 0x3f800000
  s_nop 0
  v_cndmask_b32 v233, 0, v233, vcc
  v_or_b32 v78, v233, v234
  v_cmp_eq_u32 vcc, 2, v232
  v_mov_b32 v233, 0x3f80
  s_nop 0
  v_cndmask_b32 v234, 0, v233, vcc
  v_cmp_eq_u32 vcc, 3, v232
  v_mov_b32 v233, 0x3f800000
  s_nop 0
  v_cndmask_b32 v233, 0, v233, vcc
  v_or_b32 v79, v233, v234
  v_cndmask_b32_e64 v224, v156, v157, s[40:41]
  v_mul_f32 v225, s60, v152
  v_cndmask_b32_e64 v224, v224, v158, s[42:43]
  v_cndmask_b32_e64 v224, v224, v159, s[44:45]
  v_mul_f32 v224, s60, v224
  v_fma_f32 v224, -v225, v225, v224
  v_max_f32 v224, 0, v224
  v_add_f32 v226, s61, v224
  v_rsq_f32 v230, v226
  v_subrev_u32 v232, 131072, v14
  v_mul_f32 v231, v230, v225
  v_lshrrev_b32 v232, 2, v232
  v_add_u32 v232, 132096, v232
  v_mov_b32 v228, v230
  v_mov_b32 v229, v231
  s_mov_b64 exec, s[46:47]
  ds_write_b128 v14, v[228:231]
  ds_write_b32 v232, v228
  ds_write_b32 v232, v229 offset:256
  s_mov_b64 exec, -1
  s_waitcnt lgkmcnt(0)
  s_barrier
  ds_read_b128 v[176:179], v18
  ds_read_b128 v[192:195], v18 offset:256
  ds_read_b128 v[180:183], v19
  ds_read_b128 v[196:199], v19 offset:256
  ds_read_b128 v[184:187], v20
  ds_read_b128 v[200:203], v20 offset:256
  ds_read_b128 v[188:191], v21
  ds_read_b128 v[204:207], v21 offset:256
  s_waitcnt lgkmcnt(0)
  v_pk_mul_f32 v[224:225], v[192:193], v[76:77] op_sel_hi:[1,0]
  v_pk_mul_f32 v[226:227], v[194:195], v[76:77] op_sel_hi:[1,0]
  v_pk_mul_f32 v[228:229], v[196:197], v[76:77] op_sel_hi:[1,0]
  v_pk_mul_f32 v[230:231], v[198:199], v[76:77] op_sel_hi:[1,0]
  v_pk_fma_f32 v[104:105], v[176:177], v[104:105], v[224:225] neg_lo:[0,0,1] neg_hi:[0,0,1]
  v_pk_fma_f32 v[106:107], v[178:179], v[106:107], v[226:227] neg_lo:[0,0,1] neg_hi:[0,0,1]
  v_pk_fma_f32 v[108:109], v[180:181], v[108:109], v[228:229] neg_lo:[0,0,1] neg_hi:[0,0,1]
  v_pk_fma_f32 v[110:111], v[182:183], v[110:111], v[230:231] neg_lo:[0,0,1] neg_hi:[0,0,1]
  v_pk_mul_f32 v[224:225], v[200:201], v[76:77] op_sel_hi:[1,0]
  v_pk_mul_f32 v[226:227], v[202:203], v[76:77] op_sel_hi:[1,0]
  v_pk_mul_f32 v[228:229], v[204:205], v[76:77] op_sel_hi:[1,0]
  v_pk_mul_f32 v[230:231], v[206:207], v[76:77] op_sel_hi:[1,0]
  v_pk_fma_f32 v[112:113], v[184:185], v[112:113], v[224:225] neg_lo:[0,0,1] neg_hi:[0,0,1]
  v_pk_fma_f32 v[114:115], v[186:187], v[114:115], v[226:227] neg_lo:[0,0,1] neg_hi:[0,0,1]
  buffer_load_dwordx4 a[188:191], v2, s[4:7], s25 offen offset:3072
  v_pk_fma_f32 v[116:117], v[188:189], v[116:117], v[228:229] neg_lo:[0,0,1] neg_hi:[0,0,1]
  v_pk_fma_f32 v[118:119], v[190:191], v[118:119], v[230:231] neg_lo:[0,0,1] neg_hi:[0,0,1]
  v_pk_mul_f32 v[224:225], v[192:193], v[80:81] op_sel_hi:[1,0]
  v_pk_mul_f32 v[226:227], v[194:195], v[80:81] op_sel_hi:[1,0]
  v_pk_mul_f32 v[228:229], v[196:197], v[80:81] op_sel_hi:[1,0]
  v_pk_mul_f32 v[230:231], v[198:199], v[80:81] op_sel_hi:[1,0]
  v_pk_fma_f32 v[120:121], v[176:177], v[120:121], v[224:225] neg_lo:[0,0,1] neg_hi:[0,0,1]
  v_pk_fma_f32 v[122:123], v[178:179], v[122:123], v[226:227] neg_lo:[0,0,1] neg_hi:[0,0,1]
  v_pk_fma_f32 v[124:125], v[180:181], v[124:125], v[228:229] neg_lo:[0,0,1] neg_hi:[0,0,1]
  v_pk_fma_f32 v[126:127], v[182:183], v[126:127], v[230:231] neg_lo:[0,0,1] neg_hi:[0,0,1]
  v_pk_mul_f32 v[224:225], v[200:201], v[80:81] op_sel_hi:[1,0]
  v_pk_mul_f32 v[226:227], v[202:203], v[80:81] op_sel_hi:[1,0]
  v_pk_mul_f32 v[228:229], v[204:205], v[80:81] op_sel_hi:[1,0]
  v_pk_mul_f32 v[230:231], v[206:207], v[80:81] op_sel_hi:[1,0]
  s_add_u32 s25, s25, 4096
  buffer_load_dwordx4 a[192:195], v2, s[4:7], s25 offen offset:0
  v_pk_fma_f32 v[128:129], v[184:185], v[128:129], v[224:225] neg_lo:[0,0,1] neg_hi:[0,0,1]
  v_pk_fma_f32 v[130:131], v[186:187], v[130:131], v[226:227] neg_lo:[0,0,1] neg_hi:[0,0,1]
  v_pk_fma_f32 v[132:133], v[188:189], v[132:133], v[228:229] neg_lo:[0,0,1] neg_hi:[0,0,1]
  v_pk_fma_f32 v[134:135], v[190:191], v[134:135], v[230:231] neg_lo:[0,0,1] neg_hi:[0,0,1]
  v_pk_mul_f32 v[224:225], v[104:105], v[30:31] op_sel_hi:[1,0]
  v_pk_mul_f32 v[226:227], v[106:107], v[30:31] op_sel_hi:[1,0]
  v_pk_mul_f32 v[228:229], v[108:109], v[30:31] op_sel_hi:[1,0]
  v_pk_mul_f32 v[230:231], v[110:111], v[30:31] op_sel_hi:[1,0]
  v_exp_f32_e64 v224, v224 clamp
  v_exp_f32_e64 v225, v225 clamp
  v_exp_f32_e64 v226, v226 clamp
  v_exp_f32_e64 v227, v227 clamp
  buffer_load_dwordx4 a[196:199], v2, s[4:7], s25 offen offset:1024
  v_exp_f32_e64 v228, v228 clamp
  v_exp_f32_e64 v229, v229 clamp
  v_exp_f32_e64 v230, v230 clamp
  v_exp_f32_e64 v231, v231 clamp
  v_max_f32 v104, 0, v104
  v_max_f32 v105, 0, v105
  v_max_f32 v106, 0, v106
  v_max_f32 v107, 0, v107
  v_max_f32 v108, 0, v108
  v_max_f32 v109, 0, v109
  v_max_f32 v110, 0, v110
  buffer_load_dwordx4 a[200:203], v2, s[4:7], s25 offen offset:2048
  v_max_f32 v111, 0, v111
  v_pk_add_f32 v[224:225], v[224:225], v[30:31] op_sel:[0,1] op_sel_hi:[1,1]
  v_pk_add_f32 v[226:227], v[226:227], v[30:31] op_sel:[0,1] op_sel_hi:[1,1]
  v_pk_add_f32 v[228:229], v[228:229], v[30:31] op_sel:[0,1] op_sel_hi:[1,1]
  v_pk_add_f32 v[230:231], v[230:231], v[30:31] op_sel:[0,1] op_sel_hi:[1,1]
  v_pk_add_f32 v[104:105], v[104:105], v[224:225]
  v_pk_add_f32 v[106:107], v[106:107], v[226:227]
  v_pk_add_f32 v[108:109], v[108:109], v[228:229]
  v_pk_add_f32 v[110:111], v[110:111], v[230:231]
  v_pk_mul_f32 v[224:225], v[112:113], v[30:31] op_sel_hi:[1,0]
  v_pk_mul_f32 v[226:227], v[114:115], v[30:31] op_sel_hi:[1,0]
  v_pk_mul_f32 v[228:229], v[116:117], v[30:31] op_sel_hi:[1,0]
  v_pk_mul_f32 v[230:231], v[118:119], v[30:31] op_sel_hi:[1,0]
  v_exp_f32_e64 v224, v224 clamp
  buffer_load_dwordx4 a[204:207], v2, s[4:7], s25 offen offset:3072
  v_exp_f32_e64 v225, v225 clamp
  v_exp_f32_e64 v226, v226 clamp
  v_exp_f32_e64 v227, v227 clamp
  v_exp_f32_e64 v228, v228 clamp
  v_exp_f32_e64 v229, v229 clamp
  v_exp_f32_e64 v230, v230 clamp
  v_exp_f32_e64 v231, v231 clamp
  v_max_f32 v112, 0, v112
  s_add_u32 s25, s25, 4096
  buffer_load_dwordx4 a[208:211], v2, s[4:7], s25 offen offset:0
  v_max_f32 v113, 0, v113
  v_max_f32 v114, 0, v114
  v_max_f32 v115, 0, v115
  v_max_f32 v116, 0, v116
  v_max_f32 v117, 0, v117
  v_max_f32 v118, 0, v118
  v_max_f32 v119, 0, v119
  v_pk_add_f32 v[224:225], v[224:225], v[30:31] op_sel:[0,1] op_sel_hi:[1,1]
  v_pk_add_f32 v[226:227], v[226:227], v[30:31] op_sel:[0,1] op_sel_hi:[1,1]
  v_pk_add_f32 v[228:229], v[228:229], v[30:31] op_sel:[0,1] op_sel_hi:[1,1]
  v_pk_add_f32 v[230:231], v[230:231], v[30:31] op_sel:[0,1] op_sel_hi:[1,1]
  v_pk_add_f32 v[112:113], v[112:113], v[224:225]
  v_pk_add_f32 v[114:115], v[114:115], v[226:227]
  v_pk_add_f32 v[116:117], v[116:117], v[228:229]
  buffer_load_dwordx4 a[212:215], v2, s[4:7], s25 offen offset:1024
  v_pk_add_f32 v[118:119], v[118:119], v[230:231]
  v_cvt_pk_bf16_f32 v176, v104, v105
  v_cvt_pk_bf16_f32 v177, v106, v107
  v_cvt_pk_bf16_f32 v184, v120, v121
  v_cvt_pk_bf16_f32 v185, v122, v123
  v_cvt_pk_bf16_f32 v178, v108, v109
  v_cvt_pk_bf16_f32 v179, v110, v111
  v_cvt_pk_bf16_f32 v186, v124, v125
  v_cvt_pk_bf16_f32 v187, v126, v127
  v_cvt_pk_bf16_f32 v180, v112, v113
  v_cvt_pk_bf16_f32 v181, v114, v115
  v_cvt_pk_bf16_f32 v188, v128, v129
  v_cvt_pk_bf16_f32 v189, v130, v131
  v_cvt_pk_bf16_f32 v182, v116, v117
  v_cvt_pk_bf16_f32 v183, v118, v119
  v_cvt_pk_bf16_f32 v190, v132, v133
  v_cvt_pk_bf16_f32 v191, v134, v135
  v_mfma_f32_16x16x32_bf16 v[192:195], v[176:179], v[184:187], 0
  v_mfma_f32_16x16x32_bf16 v[196:199], v[176:179], v[24:27], 0
  v_mfma_f32_16x16x32_bf16 v[192:195], v[180:183], v[188:191], v[192:195]
  v_mfma_f32_16x16x32_bf16 v[196:199], v[180:183], v[24:27], v[196:199]
  buffer_load_dwordx4 a[216:219], v2, s[4:7], s25 offen offset:2048
  s_mov_b32 exec_lo, -1
  s_mov_b32 exec_hi, 0
  s_mov_b32 s32, 0
XP_6:
  v_cmp_eq_u32 vcc, 0, v255
  s_cbranch_vccz XQ_7
  buffer_load_dword v255, v252, s[4:7], s67 offen sc1
  s_waitcnt vmcnt(0)
  s_add_u32 s32, s32, 1
  s_cmp_lt_u32 s32, 200000
  s_cbranch_scc1 XP_6
XQ_7:
  v_cmp_ne_u32 vcc, s35, v255
  s_nop 1
  s_cmp_eq_u64 vcc, 0
  s_cselect_b32 s23, 1, 0
  s_mov_b64 exec, -1
  v_cndmask_b32_e64 v196, v196, v197, s[40:41]
  v_cndmask_b32_e64 v196, v196, v198, s[42:43]
  v_cndmask_b32_e64 v196, v196, v199, s[44:45]
  s_mul_i32 s26, s36, 1280
  s_add_u32 s26, s26, s64
  s_add_u32 s26, s26, 0
  s_cmp_eq_u32 s23, 0
  s_cbranch_scc1 XS_8
  buffer_store_dwordx4 v[192:195], v2, s[4:7], s26 offen
  buffer_store_dword v196, v3, s[4:7], s26 offen offset:1024
XD_9:
  ds_read_b128 v[188:191], v4 offset:0
  ds_read_b128 v[192:195], v5 offset:0
  ds_read_b128 v[196:199], v6 offset:0
  ds_read_b128 v[200:203], v7 offset:0
  ds_read_b128 v[204:207], v4 offset:4096
  ds_read_b128 v[208:211], v5 offset:4096
  ds_read_b128 v[212:215], v6 offset:4096
  ds_read_b128 v[216:219], v7 offset:4096
  s_waitcnt vmcnt(17) lgkmcnt(4)
  v_mfma_f32_16x16x32_bf16 v[136:139], a[128:131], v[188:191], 0
  ds_read_b128 v[220:223], v4 offset:8192
  v_mfma_f32_16x16x32_bf16 v[140:143], a[128:131], v[192:195], 0
  ds_read_b128 v[224:227], v5 offset:8192
  v_mfma_f32_16x16x32_bf16 v[144:147], a[128:131], v[196:199], 0
  ds_read_b128 v[228:231], v6 offset:8192
  v_mfma_f32_16x16x32_bf16 v[148:151], a[128:131], v[200:203], 0
  ds_read_b128 v[232:235], v7 offset:8192
  buffer_load_dwordx4 a[220:223], v2, s[4:7], s25 offen offset:3072
  v_mfma_f32_16x16x32_bf16 v[72:75], a[128:131], v[24:27], 0
  s_waitcnt lgkmcnt(4)
  v_mfma_f32_16x16x32_bf16 v[136:139], a[132:135], v[204:207], v[136:139]
  ds_read_b128 v[188:191], v4 offset:12288
  v_mfma_f32_16x16x32_bf16 v[140:143], a[132:135], v[208:211], v[140:143]
  ds_read_b128 v[192:195], v5 offset:12288
  v_mfma_f32_16x16x32_bf16 v[144:147], a[132:135], v[212:215], v[144:147]
  ds_read_b128 v[196:199], v6 offset:12288
  s_add_u32 s25, s25, 4096
  buffer_load_dwordx4 a[224:227], v2, s[4:7], s25 offen offset:0
  v_mfma_f32_16x16x32_bf16 v[148:151], a[132:135], v[216:219], v[148:151]
  ds_read_b128 v[200:203], v7 offset:12288
  v_mfma_f32_16x16x32_bf16 v[72:75], a[132:135], v[24:27], v[72:75]
  s_add_u32 s74, s33, 0
  v_lshlrev_b32 v251, 7, v1
  s_mov_b64 exec, 15
  buffer_load_dword v250, v251, s[4:7], s74 offen
  s_mov_b64 exec, -1
  s_waitcnt lgkmcnt(4)
  v_mfma_f32_16x16x32_bf16 v[136:139], a[136:139], v[220:223], v[136:139]
  ds_read_b128 v[204:207], v4 offset:16384
  v_mfma_f32_16x16x32_bf16 v[140:143], a[136:139], v[224:227], v[140:143]
  ds_read_b128 v[208:211], v5 offset:16384
  buffer_load_dwordx4 a[228:231], v2, s[4:7], s25 offen offset:1024
  v_mfma_f32_16x16x32_bf16 v[144:147], a[136:139], v[228:231], v[144:147]
  ds_read_b128 v[212:215], v6 offset:16384
  v_mfma_f32_16x16x32_bf16 v[148:151], a[136:139], v[232:235], v[148:151]
  ds_read_b128 v[216:219], v7 offset:16384
  v_mfma_f32_16x16x32_bf16 v[72:75], a[136:139], v[24:27], v[72:75]
  s_waitcnt lgkmcnt(4)
  v_mfma_f32_16x16x32_bf16 v[136:139], a[140:143], v[188:191], v[136:139]
  ds_read_b128 v[220:223], v4 offset:20480
  buffer_load_dwordx4 a[232:235], v2, s[4:7], s25 offen offset:2048
  v_mfma_f32_16x16x32_bf16 v[140:143], a[140:143], v[192:195], v[140:143]
  ds_read_b128 v[224:227], v5 offset:20480
  v_mfma_f32_16x16x32_bf16 v[144:147], a[140:143], v[196:199], v[144:147]
  ds_read_b128 v[228:231], v6 offset:20480
  v_mfma_f32_16x16x32_bf16 v[148:151], a[140:143], v[200:203], v[148:151]
  ds_read_b128 v[232:235], v7 offset:20480
  v_mfma_f32_16x16x32_bf16 v[72:75], a[140:143], v[24:27], v[72:75]
  buffer_load_dwordx4 a[236:239], v2, s[4:7], s25 offen offset:3072
  s_cmp_lg_u32 s36, s22
  s_cbranch_scc1 K1_10
  s_add_u32 s26, s64, 0
  buffer_load_dwordx4 v[104:107], v2, s[4:7], s26 offen sc1
  buffer_load_dword v120, v3, s[4:7], s26 offen offset:1024 sc1
  s_add_u32 s26, s26, 1280
  buffer_load_dwordx4 v[108:111], v2, s[4:7], s26 offen sc1
  buffer_load_dword v121, v3, s[4:7], s26 offen offset:1024 sc1
  s_add_u32 s26, s26, 1280
  buffer_load_dwordx4 v[112:115], v2, s[4:7], s26 offen sc1
  buffer_load_dword v122, v3, s[4:7], s26 offen offset:1024 sc1
  s_add_u32 s26, s26, 1280
  buffer_load_dwordx4 v[116:119], v2, s[4:7], s26 offen sc1
  buffer_load_dword v123, v3, s[4:7], s26 offen offset:1024 sc1
K1_10:
  s_waitcnt lgkmcnt(4)
  v_mfma_f32_16x16x32_bf16 v[136:139], a[144:147], v[204:207], v[136:139]
  ds_read_b128 v[188:191], v4 offset:24576
  v_mfma_f32_16x16x32_bf16 v[140:143], a[144:147], v[208:211], v[140:143]
  ds_read_b128 v[192:195], v5 offset:24576
  v_mfma_f32_16x16x32_bf16 v[144:147], a[144:147], v[212:215], v[144:147]
  ds_read_b128 v[196:199], v6 offset:24576
  v_mfma_f32_16x16x32_bf16 v[148:151], a[144:147], v[216:219], v[148:151]
  ds_read_b128 v[200:203], v7 offset:24576
  s_add_u32 s25, s25, 4096
  buffer_load_dwordx4 a[240:243], v2, s[4:7], s25 offen offset:0
  v_mfma_f32_16x16x32_bf16 v[72:75], a[144:147], v[24:27], v[72:75]
  s_waitcnt lgkmcnt(4)
  v_mfma_f32_16x16x32_bf16 v[136:139], a[148:151], v[220:223], v[136:139]
  ds_read_b128 v[204:207], v4 offset:28672
  v_mfma_f32_16x16x32_bf16 v[140:143], a[148:151], v[224:227], v[140:143]
  ds_read_b128 v[208:211], v5 offset:28672
  v_mfma_f32_16x16x32_bf16 v[144:147], a[148:151], v[228:231], v[144:147]
  ds_read_b128 v[212:215], v6 offset:28672
  buffer_load_dwordx4 a[244:247], v2, s[4:7], s25 offen offset:1024
  v_mfma_f32_16x16x32_bf16 v[148:151], a[148:151], v[232:235], v[148:151]
  ds_read_b128 v[216:219], v7 offset:28672
  v_mfma_f32_16x16x32_bf16 v[72:75], a[148:151], v[24:27], v[72:75]
  s_waitcnt lgkmcnt(4)
  v_mfma_f32_16x16x32_bf16 v[136:139], a[152:155], v[188:191], v[136:139]
  ds_read_b128 v[220:223], v4 offset:32768
  v_mfma_f32_16x16x32_bf16 v[140:143], a[152:155], v[192:195], v[140:143]
  ds_read_b128 v[224:227], v5 offset:32768
  buffer_load_dwordx4 a[248:251], v2, s[4:7], s25 offen offset:2048
  v_mfma_f32_16x16x32_bf16 v[144:147], a[152:155], v[196:199], v[144:147]
  ds_read_b128 v[228:231], v6 offset:32768
  v_mfma_f32_16x16x32_bf16 v[148:151], a[152:155], v[200:203], v[148:151]
  ds_read_b128 v[232:235], v7 offset:32768
  v_mfma_f32_16x16x32_bf16 v[72:75], a[152:155], v[24:27], v[72:75]
  s_waitcnt lgkmcnt(4)
  v_mfma_f32_16x16x32_bf16 v[136:139], a[156:159], v[204:207], v[136:139]
  ds_read_b128 v[188:191], v4 offset:36864
  buffer_load_dwordx4 a[252:255], v2, s[4:7], s25 offen offset:3072
  v_mfma_f32_16x16x32_bf16 v[140:143], a[156:159], v[208:211], v[140:143]
  ds_read_b128 v[192:195], v5 offset:36864
  v_mfma_f32_16x16x32_bf16 v[144:147], a[156:159], v[212:215], v[144:147]
  ds_read_b128 v[196:199], v6 offset:36864
  v_mfma_f32_16x16x32_bf16 v[148:151], a[156:159], v[216:219], v[148:151]
  ds_read_b128 v[200:203], v7 offset:36864
  v_mfma_f32_16x16x32_bf16 v[72:75], a[156:159], v[24:27], v[72:75]
  s_add_u32 s25, s25, 4096
  buffer_load_dwordx4 a[0:3], v2, s[4:7], s25 offen offset:0
  s_waitcnt vmcnt(20) lgkmcnt(4)
  v_mfma_f32_16x16x32_bf16 v[136:139], a[160:163], v[220:223], v[136:139]
  ds_read_b128 v[204:207], v4 offset:40960
  v_mfma_f32_16x16x32_bf16 v[140:143], a[160:163], v[224:227], v[140:143]
  ds_read_b128 v[208:211], v5 offset:40960
  v_mfma_f32_16x16x32_bf16 v[144:147], a[160:163], v[228:231], v[144:147]
  ds_read_b128 v[212:215], v6 offset:40960
  v_mfma_f32_16x16x32_bf16 v[148:151], a[160:163], v[232:235], v[148:151]
  ds_read_b128 v[216:219], v7 offset:40960
  buffer_load_dwordx4 a[4:7], v2, s[4:7], s25 offen offset:1024
  v_mfma_f32_16x16x32_bf16 v[72:75], a[160:163], v[24:27], v[72:75]
  s_cmp_lg_u32 s36, s22
  s_cbranch_scc1 K2_11
  s_waitcnt vmcnt(6)
  v_max_u32 v250, v104, v105
  v_max3_u32 v250, v250, v106, v107
  v_max3_u32 v250, v250, v108, v109
  v_max3_u32 v250, v250, v110, v111
  v_max3_u32 v250, v250, v112, v113
  v_max3_u32 v250, v250, v114, v115
  v_max3_u32 v250, v250, v116, v117
  v_max3_u32 v250, v250, v118, v119
  v_max3_u32 v250, v250, v120, v121
  v_max3_u32 v250, v250, v122, v123
  v_cmp_eq_u32 vcc, -1, v250
  s_cbranch_vccz K2ok_12
  s_add_u32 s26, s64, 0
  buffer_load_dwordx4 v[104:107], v2, s[4:7], s26 offen sc1
  buffer_load_dword v120, v3, s[4:7], s26 offen offset:1024 sc1
  s_add_u32 s26, s26, 1280
  buffer_load_dwordx4 v[108:111], v2, s[4:7], s26 offen sc1
  buffer_load_dword v121, v3, s[4:7], s26 offen offset:1024 sc1
  s_add_u32 s26, s26, 1280
  buffer_load_dwordx4 v[112:115], v2, s[4:7], s26 offen sc1
  buffer_load_dword v122, v3, s[4:7], s26 offen offset:1024 sc1
  s_add_u32 s26, s26, 1280
  buffer_load_dwordx4 v[116:119], v2, s[4:7], s26 offen sc1
  buffer_load_dword v123, v3, s[4:7], s26 offen offset:1024 sc1
  s_waitcnt vmcnt(0)
  v_max_u32 v250, v104, v105
  v_max3_u32 v250, v250, v106, v107
  v_max3_u32 v250, v250, v108, v109
  v_max3_u32 v250, v250, v110, v111
  v_max3_u32 v250, v250, v112, v113
  v_max3_u32 v250, v250, v114, v115
  v_max3_u32 v250, v250, v116, v117
  v_max3_u32 v250, v250, v118, v119
  v_max3_u32 v250, v250, v120, v121
  v_max3_u32 v250, v250, v122, v123
  v_cmp_eq_u32 vcc, -1, v250
  s_cbranch_vccnz SP_13
SPok_14:
K2ok_12:
  v_pk_add_f32 v[104:105], v[104:105], v[108:109]
  v_pk_add_f32 v[112:113], v[112:113], v[116:117]
  v_pk_add_f32 v[106:107], v[106:107], v[110:111]
  v_pk_add_f32 v[114:115], v[114:115], v[118:119]
  v_add_f32 v120, v120, v121
  v_add_f32 v122, v122, v123
  v_pk_add_f32 v[104:105], v[104:105], v[112:113]
  v_pk_add_f32 v[106:107], v[106:107], v[114:115]
  v_add_f32 v126, v120, v122
  v_cvt_pk_bf16_f32 v124, v104, v105
  v_cvt_pk_bf16_f32 v125, v106, v107
  v_mov_b32 v127, 0
  s_add_u32 s26, s65, 0
  buffer_store_dwordx4 v[124:127], v2, s[4:7], s26 offen sc1
K2_11:
  s_waitcnt lgkmcnt(4)
  v_mfma_f32_16x16x32_bf16 v[136:139], a[164:167], v[188:191], v[136:139]
  ds_read_b128 v[220:223], v4 offset:45056
  v_mfma_f32_16x16x32_bf16 v[140:143], a[164:167], v[192:195], v[140:143]
  ds_read_b128 v[224:227], v5 offset:45056
  v_mfma_f32_16x16x32_bf16 v[144:147], a[164:167], v[196:199], v[144:147]
  ds_read_b128 v[228:231], v6 offset:45056
  buffer_load_dwordx4 a[8:11], v2, s[4:7], s25 offen offset:2048
  v_mfma_f32_16x16x32_bf16 v[148:151], a[164:167], v[200:203], v[148:151]
  ds_read_b128 v[232:235], v7 offset:45056
  v_mfma_f32_16x16x32_bf16 v[72:75], a[164:167], v[24:27], v[72:75]
  s_waitcnt lgkmcnt(4)
  v_mfma_f32_16x16x32_bf16 v[136:139], a[168:171], v[204:207], v[136:139]
  ds_read_b128 v[188:191], v4 offset:49152
  v_mfma_f32_16x16x32_bf16 v[140:143], a[168:171], v[208:211], v[140:143]
  ds_read_b128 v[192:195], v5 offset:49152
  buffer_load_dwordx4 a[12:15], v2, s[4:7], s25 offen offset:3072
  v_mfma_f32_16x16x32_bf16 v[144:147], a[168:171], v[212:215], v[144:147]
  ds_read_b128 v[196:199], v6 offset:49152
  v_mfma_f32_16x16x32_bf16 v[148:151], a[168:171], v[216:219], v[148:151]
  ds_read_b128 v[200:203], v7 offset:49152
  v_mfma_f32_16x16x32_bf16 v[72:75], a[168:171], v[24:27], v[72:75]
  s_waitcnt lgkmcnt(4)
  v_mfma_f32_16x16x32_bf16 v[136:139], a[172:175], v[220:223], v[136:139]
  ds_read_b128 v[204:207], v4 offset:53248
  s_add_u32 s25, s25, 4096
  buffer_load_dwordx4 a[16:19], v2, s[4:7], s25 offen offset:0
  v_mfma_f32_16x16x32_bf16 v[140:143], a[172:175], v[224:227], v[140:143]
  ds_read_b128 v[208:211], v5 offset:53248
  v_mfma_f32_16x16x32_bf16 v[144:147], a[172:175], v[228:231], v[144:147]
  ds_read_b128 v[212:215], v6 offset:53248
  v_mfma_f32_16x16x32_bf16 v[148:151], a[172:175], v[232:235], v[148:151]
  ds_read_b128 v[216:219], v7 offset:53248
  v_mfma_f32_16x16x32_bf16 v[72:75], a[172:175], v[24:27], v[72:75]
  buffer_load_dwordx4 a[20:23], v2, s[4:7], s25 offen offset:1024
  s_waitcnt lgkmcnt(4)
  v_mfma_f32_16x16x32_bf16 v[136:139], a[176:179], v[188:191], v[136:139]
  ds_read_b128 v[220:223], v4 offset:57344
  v_mfma_f32_16x16x32_bf16 v[140:143], a[176:179], v[192:195], v[140:143]
  ds_read_b128 v[224:227], v5 offset:57344
  v_mfma_f32_16x16x32_bf16 v[144:147], a[176:179], v[196:199], v[144:147]
  ds_read_b128 v[228:231], v6 offset:57344
  v_mfma_f32_16x16x32_bf16 v[148:151], a[176:179], v[200:203], v[148:151]
  ds_read_b128 v[232:235], v7 offset:57344
  buffer_load_dwordx4 a[24:27], v2, s[4:7], s25 offen offset:2048
  v_mfma_f32_16x16x32_bf16 v[72:75], a[176:179], v[24:27], v[72:75]
  s_waitcnt lgkmcnt(4)
  v_mfma_f32_16x16x32_bf16 v[136:139], a[180:183], v[204:207], v[136:139]
  ds_read_b128 v[188:191], v4 offset:61440
  v_mfma_f32_16x16x32_bf16 v[140:143], a[180:183], v[208:211], v[140:143]
  ds_read_b128 v[192:195], v5 offset:61440
  v_mfma_f32_16x16x32_bf16 v[144:147], a[180:183], v[212:215], v[144:147]
  ds_read_b128 v[196:199], v6 offset:61440
  buffer_load_dwordx4 a[28:31], v2, s[4:7], s25 offen offset:3072
  v_mfma_f32_16x16x32_bf16 v[148:151], a[180:183], v[216:219], v[148:151]
  ds_read_b128 v[200:203], v7 offset:61440
  v_mfma_f32_16x16x32_bf16 v[72:75], a[180:183], v[24:27], v[72:75]
  s_waitcnt lgkmcnt(4)
  v_mfma_f32_16x16x32_bf16 v[136:139], a[184:187], v[220:223], v[136:139]
  v_mfma_f32_16x16x32_bf16 v[140:143], a[184:187], v[224:227], v[140:143]
  s_add_u32 s25, s25, 4096
  buffer_load_dwordx4 a[32:35], v2, s[4:7], s25 offen offset:0
  v_mfma_f32_16x16x32_bf16 v[144:147], a[184:187], v[228:231], v[144:147]
  v_mfma_f32_16x16x32_bf16 v[148:151], a[184:187], v[232:235], v[148:151]
  v_mfma_f32_16x16x32_bf16 v[72:75], a[184:187], v[24:27], v[72:75]
  s_waitcnt lgkmcnt(0)
  v_mfma_f32_16x16x32_bf16 v[136:139], a[188:191], v[188:191], v[136:139]
  buffer_load_dwordx4 a[36:39], v2, s[4:7], s25 offen offset:1024
  v_mfma_f32_16x16x32_bf16 v[140:143], a[188:191], v[192:195], v[140:143]
  v_mfma_f32_16x16x32_bf16 v[144:147], a[188:191], v[196:199], v[144:147]
  v_mfma_f32_16x16x32_bf16 v[148:151], a[188:191], v[200:203], v[148:151]
  v_mfma_f32_16x16x32_bf16 v[72:75], a[188:191], v[24:27], v[72:75]
  buffer_load_dwordx4 a[40:43], v2, s[4:7], s25 offen offset:2048
  ds_read_b128 v[200:203], v14
  ds_read_b128 v[204:207], v15
  ds_read_b128 v[208:211], v16
  ds_read_b128 v[212:215], v17
  s_waitcnt lgkmcnt(0)
  s_nop 1
  v_pk_mul_f32 v[224:225], v[72:73], v[200:201] op_sel:[0,1] op_sel_hi:[1,1]
  v_pk_mul_f32 v[226:227], v[74:75], v[200:201] op_sel:[0,1] op_sel_hi:[1,1]
  v_pk_mul_f32 v[228:229], v[72:73], v[204:205] op_sel:[0,1] op_sel_hi:[1,1]
  v_pk_mul_f32 v[230:231], v[74:75], v[204:205] op_sel:[0,1] op_sel_hi:[1,1]
  v_pk_fma_f32 v[136:137], v[136:137], v[200:201], v[224:225] op_sel_hi:[1,0,1] neg_lo:[0,0,1] neg_hi:[0,0,1]
  v_pk_fma_f32 v[138:139], v[138:139], v[200:201], v[226:227] op_sel_hi:[1,0,1] neg_lo:[0,0,1] neg_hi:[0,0,1]
  v_pk_fma_f32 v[140:141], v[140:141], v[204:205], v[228:229] op_sel_hi:[1,0,1] neg_lo:[0,0,1] neg_hi:[0,0,1]
  v_pk_fma_f32 v[142:143], v[142:143], v[204:205], v[230:231] op_sel_hi:[1,0,1] neg_lo:[0,0,1] neg_hi:[0,0,1]
  v_pk_mul_f32 v[224:225], v[72:73], v[208:209] op_sel:[0,1] op_sel_hi:[1,1]
  v_pk_mul_f32 v[226:227], v[74:75], v[208:209] op_sel:[0,1] op_sel_hi:[1,1]
  v_pk_mul_f32 v[228:229], v[72:73], v[212:213] op_sel:[0,1] op_sel_hi:[1,1]
  v_pk_mul_f32 v[230:231], v[74:75], v[212:213] op_sel:[0,1] op_sel_hi:[1,1]
  v_pk_fma_f32 v[144:145], v[144:145], v[208:209], v[224:225] op_sel_hi:[1,0,1] neg_lo:[0,0,1] neg_hi:[0,0,1]
  buffer_load_dwordx4 a[44:47], v2, s[4:7], s25 offen offset:3072
  v_pk_fma_f32 v[146:147], v[146:147], v[208:209], v[226:227] op_sel_hi:[1,0,1] neg_lo:[0,0,1] neg_hi:[0,0,1]
  v_pk_fma_f32 v[148:149], v[148:149], v[212:213], v[228:229] op_sel_hi:[1,0,1] neg_lo:[0,0,1] neg_hi:[0,0,1]
  v_pk_fma_f32 v[150:151], v[150:151], v[212:213], v[230:231] op_sel_hi:[1,0,1] neg_lo:[0,0,1] neg_hi:[0,0,1]
  v_pk_mul_f32 v[224:225], v[136:137], v[30:31] op_sel_hi:[1,0]
  v_pk_mul_f32 v[226:227], v[138:139], v[30:31] op_sel_hi:[1,0]
  v_pk_mul_f32 v[228:229], v[140:141], v[30:31] op_sel_hi:[1,0]
  v_pk_mul_f32 v[230:231], v[142:143], v[30:31] op_sel_hi:[1,0]
  v_exp_f32_e64 v224, v224 clamp
  v_exp_f32_e64 v225, v225 clamp
  v_exp_f32_e64 v226, v226 clamp
  v_exp_f32_e64 v227, v227 clamp
  s_add_u32 s25, s25, 4096
  buffer_load_dwordx4 a[48:51], v2, s[4:7], s25 offen offset:0
  v_exp_f32_e64 v228, v228 clamp
  v_exp_f32_e64 v229, v229 clamp
  v_exp_f32_e64 v230, v230 clamp
  v_exp_f32_e64 v231, v231 clamp
  v_max_f32 v136, 0, v136
  v_max_f32 v137, 0, v137
  v_max_f32 v138, 0, v138
  v_max_f32 v139, 0, v139
  v_max_f32 v140, 0, v140
  v_max_f32 v141, 0, v141
  v_max_f32 v142, 0, v142
  buffer_load_dwordx4 a[52:55], v2, s[4:7], s25 offen offset:1024
  v_max_f32 v143, 0, v143
  v_pk_add_f32 v[224:225], v[224:225], v[30:31] op_sel:[0,1] op_sel_hi:[1,1]
  v_pk_add_f32 v[226:227], v[226:227], v[30:31] op_sel:[0,1] op_sel_hi:[1,1]
  v_pk_add_f32 v[228:229], v[228:229], v[30:31] op_sel:[0,1] op_sel_hi:[1,1]
  v_pk_add_f32 v[230:231], v[230:231], v[30:31] op_sel:[0,1] op_sel_hi:[1,1]
  v_pk_add_f32 v[136:137], v[136:137], v[224:225]
  v_pk_add_f32 v[138:139], v[138:139], v[226:227]
  v_pk_add_f32 v[140:141], v[140:141], v[228:229]
  v_pk_add_f32 v[142:143], v[142:143], v[230:231]
  v_pk_mul_f32 v[224:225], v[144:145], v[30:31] op_sel_hi:[1,0]
  v_pk_mul_f32 v[226:227], v[146:147], v[30:31] op_sel_hi:[1,0]
  v_pk_mul_f32 v[228:229], v[148:149], v[30:31] op_sel_hi:[1,0]
  v_pk_mul_f32 v[230:231], v[150:151], v[30:31] op_sel_hi:[1,0]
  v_exp_f32_e64 v224, v224 clamp
  buffer_load_dwordx4 a[56:59], v2, s[4:7], s25 offen offset:2048
  v_exp_f32_e64 v225, v225 clamp
  v_exp_f32_e64 v226, v226 clamp
  v_exp_f32_e64 v227, v227 clamp
  v_exp_f32_e64 v228, v228 clamp
  v_exp_f32_e64 v229, v229 clamp
  v_exp_f32_e64 v230, v230 clamp
  v_exp_f32_e64 v231, v231 clamp
  v_max_f32 v144, 0, v144
  buffer_load_dwordx4 a[60:63], v2, s[4:7], s25 offen offset:3072
  v_max_f32 v145, 0, v145
  v_max_f32 v146, 0, v146
  v_max_f32 v147, 0, v147
  v_max_f32 v148, 0, v148
  v_max_f32 v149, 0, v149
  v_max_f32 v150, 0, v150
  v_max_f32 v151, 0, v151
  v_pk_add_f32 v[224:225], v[224:225], v[30:31] op_sel:[0,1] op_sel_hi:[1,1]
  v_pk_add_f32 v[226:227], v[226:227], v[30:31] op_sel:[0,1] op_sel_hi:[1,1]
  v_pk_add_f32 v[228:229], v[228:229], v[30:31] op_sel:[0,1] op_sel_hi:[1,1]
  v_pk_add_f32 v[230:231], v[230:231], v[30:31] op_sel:[0,1] op_sel_hi:[1,1]
  v_pk_add_f32 v[144:145], v[144:145], v[224:225]
  v_pk_add_f32 v[146:147], v[146:147], v[226:227]
  v_pk_add_f32 v[148:149], v[148:149], v[228:229]
  s_add_u32 s25, s25, 4096
  buffer_load_dwordx4 a[64:67], v2, s[4:7], s25 offen offset:0
  v_pk_add_f32 v[150:151], v[150:151], v[230:231]
  v_cvt_pk_bf16_f32 v64, v136, v137
  v_cvt_pk_bf16_f32 v65, v138, v139
  v_cvt_pk_bf16_f32 v66, v140, v141
  v_cvt_pk_bf16_f32 v67, v142, v143
  v_cvt_pk_bf16_f32 v68, v144, v145
  v_cvt_pk_bf16_f32 v69, v146, v147
  v_cvt_pk_bf16_f32 v70, v148, v149
  v_cvt_pk_bf16_f32 v71, v150, v151
  buffer_load_dwordx4 a[68:71], v2, s[4:7], s25 offen offset:1024
  buffer_load_dwordx4 a[72:75], v2, s[4:7], s25 offen offset:2048
  buffer_load_dwordx4 a[76:79], v2, s[4:7], s25 offen offset:3072
  s_add_u32 s25, s25, 4096
  buffer_load_dwordx4 a[80:83], v2, s[4:7], s25 offen offset:0
  s_add_u32 s26, s66, 0
  buffer_load_dwordx4 v[176:179], v2, s[4:7], s26 offen offset:0 sc1
  buffer_load_dwordx4 v[180:183], v2, s[4:7], s26 offen offset:1024 sc1
  buffer_load_dwordx4 v[184:187], v2, s[4:7], s26 offen offset:2048 sc1
  buffer_load_dwordx4 v[188:191], v2, s[4:7], s26 offen offset:3072 sc1
  s_add_u32 s26, s26, 4096
  buffer_load_dwordx4 v[192:195], v2, s[4:7], s26 offen offset:0 sc1
  buffer_load_dwordx4 v[196:199], v2, s[4:7], s26 offen offset:1024 sc1
  buffer_load_dwordx4 v[200:203], v2, s[4:7], s26 offen offset:2048 sc1
  buffer_load_dwordx4 v[204:207], v2, s[4:7], s26 offen offset:3072 sc1
  s_waitcnt vmcnt(0)
  v_max_u32 v250, v176, v177
  v_max3_u32 v250, v250, v178, v180
  v_max3_u32 v250, v250, v181, v182
  v_max3_u32 v250, v250, v184, v185
  v_max3_u32 v250, v250, v186, v188
  v_max3_u32 v250, v250, v189, v190
  v_max3_u32 v250, v250, v192, v193
  v_max3_u32 v250, v250, v194, v196
  v_max3_u32 v250, v250, v197, v198
  v_max3_u32 v250, v250, v200, v201
  v_max3_u32 v250, v250, v202, v204
  v_max3_u32 v250, v250, v205, v206
  v_cmp_eq_u32 vcc, -1, v250
  s_cbranch_vccnz SP_17
SPok_18:
  v_mov_b32 v216, -1
  v_mov_b32 v217, -1
  v_mov_b32 v218, -1
  v_mov_b32 v219, -1
  s_mul_i32 s26, s36, 1280
  s_add_u32 s26, s26, s64
  s_cmp_eq_u32 s23, 0
  s_cbranch_scc1 XS_21
  buffer_store_dwordx4 v[216:219], v2, s[4:7], s26 offen
  buffer_store_dword v216, v3, s[4:7], s26 offen offset:1024
XD_22:
  v_mfma_f32_16x16x16_bf16 v[208:211], v[78:79], v[176:177], 0
  v_mfma_f32_16x16x16_bf16 v[208:211], v[78:79], v[180:181], v[208:211]
  v_mfma_f32_16x16x16_bf16 v[208:211], v[78:79], v[184:185], v[208:211]
  v_mfma_f32_16x16x16_bf16 v[208:211], v[78:79], v[188:189], v[208:211]
  v_mfma_f32_16x16x16_bf16 v[208:211], v[78:79], v[192:193], v[208:211]
  v_mfma_f32_16x16x16_bf16 v[208:211], v[78:79], v[196:197], v[208:211]
  v_mfma_f32_16x16x16_bf16 v[208:211], v[78:79], v[200:201], v[208:211]
  v_mfma_f32_16x16x16_bf16 v[208:211], v[78:79], v[204:205], v[208:211]
  v_add_f32 v212, v178, v182
  v_add_f32 v213, v186, v190
  v_add_f32 v214, v194, v198
  v_add_f32 v215, v202, v206
  v_add_f32 v212, v212, v213
  v_add_f32 v214, v214, v215
  v_add_f32 v212, v212, v214
  v_mov_b32_dpp v180, v212 quad_perm:[0,0,0,0] row_mask:0xf bank_mask:0xf
  v_mov_b32_dpp v181, v212 quad_perm:[1,1,1,1] row_mask:0xf bank_mask:0xf
  v_mov_b32_dpp v182, v212 quad_perm:[2,2,2,2] row_mask:0xf bank_mask:0xf
  v_mov_b32_dpp v183, v212 quad_perm:[3,3,3,3] row_mask:0xf bank_mask:0xf
  v_cvt_pk_bf16_f32 v220, v208, v209
  v_cvt_pk_bf16_f32 v221, v210, v211
  v_cvt_pk_bf16_f32 v222, v180, v181
  v_cvt_pk_bf16_f32 v223, v182, v183
  s_nop 1
  v_mfma_f32_16x16x16_bf16 v[120:123], v[222:223], v[64:65], 0
  v_mfma_f32_16x16x16_bf16 v[124:127], v[222:223], v[66:67], 0
  v_mfma_f32_16x16x16_bf16 v[128:131], v[222:223], v[68:69], 0
  v_mfma_f32_16x16x16_bf16 v[132:135], v[222:223], v[70:71], 0
  v_mfma_f32_16x16x16_bf16 v[104:107], v[220:221], v[64:65], 0
  v_mfma_f32_16x16x16_bf16 v[108:111], v[220:221], v[66:67], 0
  v_mfma_f32_16x16x16_bf16 v[112:115], v[220:221], v[68:69], 0
  v_mfma_f32_16x16x16_bf16 v[116:119], v[220:221], v[70:71], 0
  s_nop 0
  v_add_f32 v120, s59, v120
  v_add_f32 v124, s59, v124
  v_add_f32 v128, s59, v128
  v_add_f32 v132, s59, v132
  v_rcp_f32 v120, v120
  v_rcp_f32 v124, v124
  v_rcp_f32 v128, v128
  v_rcp_f32 v132, v132
  v_pk_mul_f32 v[104:105], v[104:105], v[120:121] op_sel_hi:[1,0]
  v_pk_mul_f32 v[106:107], v[106:107], v[120:121] op_sel_hi:[1,0]
  v_pk_mul_f32 v[108:109], v[108:109], v[124:125] op_sel_hi:[1,0]
  v_pk_mul_f32 v[110:111], v[110:111], v[124:125] op_sel_hi:[1,0]
  v_pk_mul_f32 v[112:113], v[112:113], v[128:129] op_sel_hi:[1,0]
  v_pk_mul_f32 v[114:115], v[114:115], v[128:129] op_sel_hi:[1,0]
  v_pk_mul_f32 v[116:117], v[116:117], v[132:133] op_sel_hi:[1,0]
  v_pk_mul_f32 v[118:119], v[118:119], v[132:133] op_sel_hi:[1,0]
  v_cvt_pk_bf16_f32 v176, v104, v105
  v_cvt_pk_bf16_f32 v177, v106, v107
  v_cvt_pk_bf16_f32 v178, v108, v109
  v_cvt_pk_bf16_f32 v179, v110, v111
  v_cvt_pk_bf16_f32 v180, v112, v113
  v_cvt_pk_bf16_f32 v181, v114, v115
  v_cvt_pk_bf16_f32 v182, v116, v117
  v_cvt_pk_bf16_f32 v183, v118, v119
  v_permlane16_swap_b32 v176, v178
  v_permlane16_swap_b32 v177, v179
  v_permlane16_swap_b32 v180, v182
  v_permlane16_swap_b32 v181, v183
  s_add_u32 s26, s3, 1835008
  s_cmp_eq_u32 s23, 0
  s_cbranch_scc1 XS_23
  buffer_store_dwordx4 v[176:179], v12, s[4:7], s26 offen
  buffer_store_dwordx4 v[180:183], v13, s[4:7], s26 offen
XD_24:
  s_barrier
  s_add_u32 s74, s68, 0
  v_lshlrev_b32 v251, 7, v1
  buffer_load_dwordx4 a[84:87], v2, s[4:7], s25 offen offset:1024
  buffer_load_dwordx4 a[88:91], v2, s[4:7], s25 offen offset:2048
  s_waitcnt vmcnt(2)
  s_mov_b64 exec, 15
  s_cmp_eq_u32 s23, 0
  s_cbranch_scc1 XS_25
  buffer_store_dword v254, v251, s[4:7], s74 offen
XD_26:
  s_mov_b64 exec, -1
  s_load_dwordx16 s[80:95], s[76:77], 0
  s_waitcnt lgkmcnt(0)
  s_and_b64 s[80:81], s[80:81], s[82:83]
  s_and_b64 s[84:85], s[84:85], s[86:87]
  s_and_b64 s[88:89], s[88:89], s[90:91]
  s_and_b64 s[92:93], s[92:93], s[94:95]
  s_and_b64 s[80:81], s[80:81], s[84:85]
  s_and_b64 s[88:89], s[88:89], s[92:93]
  s_and_b64 s[80:81], s[80:81], s[88:89]
  s_and_b32 s96, s80, s81
  s_cmp_eq_u32 s96, 1
  s_cbranch_scc0 SQ_27
SQok_28:
  s_add_u32 s72, s24, 1835008
  s_lshl_b32 s26, s22, 12
  s_add_u32 s72, s72, s26
  s_mov_b32 s73, s26
  s_add_u32 m0, s73, 0
  s_nop 0
  buffer_load_dwordx4 v2, s[4:7], s72 offen offset:0 sc1 lds
  buffer_load_dwordx4 v2, s[4:7], s72 offen offset:1024 sc1 lds
  buffer_load_dwordx4 v2, s[4:7], s72 offen offset:2048 sc1 lds
  buffer_load_dwordx4 v2, s[4:7], s72 offen offset:3072 sc1 lds
  s_add_u32 s72, s72, 16384
  s_add_u32 m0, s73, 16384
  s_nop 0
  buffer_load_dwordx4 v2, s[4:7], s72 offen offset:0 sc1 lds
  buffer_load_dwordx4 v2, s[4:7], s72 offen offset:1024 sc1 lds
  buffer_load_dwordx4 v2, s[4:7], s72 offen offset:2048 sc1 lds
  buffer_load_dwordx4 v2, s[4:7], s72 offen offset:3072 sc1 lds
  s_add_u32 s72, s72, 16384
  s_add_u32 m0, s73, 32768
  s_nop 0
  buffer_load_dwordx4 v2, s[4:7], s72 offen offset:0 sc1 lds
  buffer_load_dwordx4 v2, s[4:7], s72 offen offset:1024 sc1 lds
  buffer_load_dwordx4 v2, s[4:7], s72 offen offset:2048 sc1 lds
  buffer_load_dwordx4 v2, s[4:7], s72 offen offset:3072 sc1 lds
  s_waitcnt vmcnt(8)
  s_barrier
  ds_read_b128 v[188:191], v4 offset:0
  ds_read_b128 v[192:195], v5 offset:0
  ds_read_b128 v[196:199], v6 offset:0
  ds_read_b128 v[200:203], v7 offset:0
  ds_read_b128 v[204:207], v4 offset:4096
  ds_read_b128 v[208:211], v5 offset:4096
  ds_read_b128 v[212:215], v6 offset:4096
  ds_read_b128 v[216:219], v7 offset:4096
  s_waitcnt lgkmcnt(4)
  v_mfma_f32_16x16x32_bf16 v[32:35], a[192:195], v[188:191], v[32:35]
  ds_read_b128 v[220:223], v4 offset:8192
  v_mfma_f32_16x16x32_bf16 v[36:39], a[192:195], v[192:195], v[36:39]
  ds_read_b128 v[224:227], v5 offset:8192
  v_mfma_f32_16x16x32_bf16 v[40:43], a[192:195], v[196:199], v[40:43]
  ds_read_b128 v[228:231], v6 offset:8192
  v_mfma_f32_16x16x32_bf16 v[44:47], a[192:195], v[200:203], v[44:47]
  ds_read_b128 v[232:235], v7 offset:8192
  s_add_u32 s72, s72, 16384
  s_add_u32 m0, s73, 49152
  s_nop 0
  buffer_load_dwordx4 v2, s[4:7], s72 offen offset:0 sc1 lds
  s_waitcnt lgkmcnt(4)
  v_mfma_f32_16x16x32_bf16 v[32:35], a[196:199], v[204:207], v[32:35]
  ds_read_b128 v[188:191], v4 offset:12288
  v_mfma_f32_16x16x32_bf16 v[36:39], a[196:199], v[208:211], v[36:39]
  ds_read_b128 v[192:195], v5 offset:12288
  v_mfma_f32_16x16x32_bf16 v[40:43], a[196:199], v[212:215], v[40:43]
  ds_read_b128 v[196:199], v6 offset:12288
  v_mfma_f32_16x16x32_bf16 v[44:47], a[196:199], v[216:219], v[44:47]
  ds_read_b128 v[200:203], v7 offset:12288
  buffer_load_dwordx4 v2, s[4:7], s72 offen offset:1024 sc1 lds
  s_add_u32 s74, s33, 512
  v_lshlrev_b32 v251, 7, v1
  s_mov_b64 exec, 15
  buffer_load_dword v250, v251, s[4:7], s74 offen
  s_mov_b64 exec, -1
  s_waitcnt vmcnt(7)
  s_barrier
  s_waitcnt lgkmcnt(4)
  v_mfma_f32_16x16x32_bf16 v[32:35], a[200:203], v[220:223], v[32:35]
  ds_read_b128 v[204:207], v4 offset:16384
  v_mfma_f32_16x16x32_bf16 v[36:39], a[200:203], v[224:227], v[36:39]
  ds_read_b128 v[208:211], v5 offset:16384
  v_mfma_f32_16x16x32_bf16 v[40:43], a[200:203], v[228:231], v[40:43]
  ds_read_b128 v[212:215], v6 offset:16384
  v_mfma_f32_16x16x32_bf16 v[44:47], a[200:203], v[232:235], v[44:47]
  ds_read_b128 v[216:219], v7 offset:16384
  buffer_load_dwordx4 v2, s[4:7], s72 offen offset:2048 sc1 lds
  s_waitcnt lgkmcnt(4)
  v_mfma_f32_16x16x32_bf16 v[32:35], a[204:207], v[188:191], v[32:35]
  ds_read_b128 v[220:223], v4 offset:20480
  v_mfma_f32_16x16x32_bf16 v[36:39], a[204:207], v[192:195], v[36:39]
  ds_read_b128 v[224:227], v5 offset:20480
  v_mfma_f32_16x16x32_bf16 v[40:43], a[204:207], v[196:199], v[40:43]
  ds_read_b128 v[228:231], v6 offset:20480
  v_mfma_f32_16x16x32_bf16 v[44:47], a[204:207], v[200:203], v[44:47]
  ds_read_b128 v[232:235], v7 offset:20480
  buffer_load_dwordx4 v2, s[4:7], s72 offen offset:3072 sc1 lds
  s_waitcnt lgkmcnt(4)
  v_mfma_f32_16x16x32_bf16 v[32:35], a[208:211], v[204:207], v[32:35]
  ds_read_b128 v[188:191], v4 offset:24576
  v_mfma_f32_16x16x32_bf16 v[36:39], a[208:211], v[208:211], v[36:39]
  ds_read_b128 v[192:195], v5 offset:24576
  v_mfma_f32_16x16x32_bf16 v[40:43], a[208:211], v[212:215], v[40:43]
  ds_read_b128 v[196:199], v6 offset:24576
  v_mfma_f32_16x16x32_bf16 v[44:47], a[208:211], v[216:219], v[44:47]
  ds_read_b128 v[200:203], v7 offset:24576
  buffer_load_dwordx4 a[92:95], v2, s[4:7], s25 offen offset:3072
  s_waitcnt lgkmcnt(4)
  v_mfma_f32_16x16x32_bf16 v[32:35], a[212:215], v[220:223], v[32:35]
  ds_read_b128 v[204:207], v4 offset:28672
  v_mfma_f32_16x16x32_bf16 v[36:39], a[212:215], v[224:227], v[36:39]
  ds_read_b128 v[208:211], v5 offset:28672
  v_mfma_f32_16x16x32_bf16 v[40:43], a[212:215], v[228:231], v[40:43]
  ds_read_b128 v[212:215], v6 offset:28672
  v_mfma_f32_16x16x32_bf16 v[44:47], a[212:215], v[232:235], v[44:47]
  ds_read_b128 v[216:219], v7 offset:28672
  s_add_u32 s25, s25, 4096
  buffer_load_dwordx4 a[96:99], v2, s[4:7], s25 offen offset:0
  s_waitcnt vmcnt(7)
  s_barrier
  s_waitcnt lgkmcnt(4)
  v_mfma_f32_16x16x32_bf16 v[32:35], a[216:219], v[188:191], v[32:35]
  ds_read_b128 v[220:223], v4 offset:32768
  v_mfma_f32_16x16x32_bf16 v[36:39], a[216:219], v[192:195], v[36:39]
  ds_read_b128 v[224:227], v5 offset:32768
  v_mfma_f32_16x16x32_bf16 v[40:43], a[216:219], v[196:199], v[40:43]
  ds_read_b128 v[228:231], v6 offset:32768
  v_mfma_f32_16x16x32_bf16 v[44:47], a[216:219], v[200:203], v[44:47]
  ds_read_b128 v[232:235], v7 offset:32768
  buffer_load_dwordx4 a[100:103], v2, s[4:7], s25 offen offset:1024
  s_waitcnt lgkmcnt(4)
  v_mfma_f32_16x16x32_bf16 v[32:35], a[220:223], v[204:207], v[32:35]
  ds_read_b128 v[188:191], v4 offset:36864
  v_mfma_f32_16x16x32_bf16 v[36:39], a[220:223], v[208:211], v[36:39]
  ds_read_b128 v[192:195], v5 offset:36864
  v_mfma_f32_16x16x32_bf16 v[40:43], a[220:223], v[212:215], v[40:43]
  ds_read_b128 v[196:199], v6 offset:36864
  v_mfma_f32_16x16x32_bf16 v[44:47], a[220:223], v[216:219], v[44:47]
  ds_read_b128 v[200:203], v7 offset:36864
  buffer_load_dwordx4 a[104:107], v2, s[4:7], s25 offen offset:2048
  s_waitcnt lgkmcnt(4)
  v_mfma_f32_16x16x32_bf16 v[32:35], a[224:227], v[220:223], v[32:35]
  ds_read_b128 v[204:207], v4 offset:40960
  v_mfma_f32_16x16x32_bf16 v[36:39], a[224:227], v[224:227], v[36:39]
  ds_read_b128 v[208:211], v5 offset:40960
  v_mfma_f32_16x16x32_bf16 v[40:43], a[224:227], v[228:231], v[40:43]
  ds_read_b128 v[212:215], v6 offset:40960
  v_mfma_f32_16x16x32_bf16 v[44:47], a[224:227], v[232:235], v[44:47]
  ds_read_b128 v[216:219], v7 offset:40960
  buffer_load_dwordx4 a[108:111], v2, s[4:7], s25 offen offset:3072
  s_waitcnt lgkmcnt(4)
  v_mfma_f32_16x16x32_bf16 v[32:35], a[228:231], v[188:191], v[32:35]
  ds_read_b128 v[220:223], v4 offset:45056
  v_mfma_f32_16x16x32_bf16 v[36:39], a[228:231], v[192:195], v[36:39]
  ds_read_b128 v[224:227], v5 offset:45056
  v_mfma_f32_16x16x32_bf16 v[40:43], a[228:231], v[196:199], v[40:43]
  ds_read_b128 v[228:231], v6 offset:45056
  v_mfma_f32_16x16x32_bf16 v[44:47], a[228:231], v[200:203], v[44:47]
  ds_read_b128 v[232:235], v7 offset:45056
  s_add_u32 s25, s25, 4096
  buffer_load_dwordx4 a[112:115], v2, s[4:7], s25 offen offset:0
  s_waitcnt vmcnt(6)
  s_barrier
  s_waitcnt lgkmcnt(4)
  v_mfma_f32_16x16x32_bf16 v[32:35], a[232:235], v[204:207], v[32:35]
  ds_read_b128 v[188:191], v4 offset:49152
  v_mfma_f32_16x16x32_bf16 v[36:39], a[232:235], v[208:211], v[36:39]
  ds_read_b128 v[192:195], v5 offset:49152
  v_mfma_f32_16x16x32_bf16 v[40:43], a[232:235], v[212:215], v[40:43]
  ds_read_b128 v[196:199], v6 offset:49152
  v_mfma_f32_16x16x32_bf16 v[44:47], a[232:235], v[216:219], v[44:47]
  ds_read_b128 v[200:203], v7 offset:49152
  s_waitcnt lgkmcnt(4)
  v_mfma_f32_16x16x32_bf16 v[32:35], a[236:239], v[220:223], v[32:35]
  ds_read_b128 v[204:207], v4 offset:53248
  v_mfma_f32_16x16x32_bf16 v[36:39], a[236:239], v[224:227], v[36:39]
  ds_read_b128 v[208:211], v5 offset:53248
  v_mfma_f32_16x16x32_bf16 v[40:43], a[236:239], v[228:231], v[40:43]
  ds_read_b128 v[212:215], v6 offset:53248
  v_mfma_f32_16x16x32_bf16 v[44:47], a[236:239], v[232:235], v[44:47]
  ds_read_b128 v[216:219], v7 offset:53248
  s_waitcnt lgkmcnt(4)
  v_mfma_f32_16x16x32_bf16 v[32:35], a[240:243], v[188:191], v[32:35]
  ds_read_b128 v[220:223], v4 offset:57344
  v_mfma_f32_16x16x32_bf16 v[36:39], a[240:243], v[192:195], v[36:39]
  ds_read_b128 v[224:227], v5 offset:57344
  v_mfma_f32_16x16x32_bf16 v[40:43], a[240:243], v[196:199], v[40:43]
  ds_read_b128 v[228:231], v6 offset:57344
  v_mfma_f32_16x16x32_bf16 v[44:47], a[240:243], v[200:203], v[44:47]
  ds_read_b128 v[232:235], v7 offset:57344
  s_waitcnt lgkmcnt(4)
  v_mfma_f32_16x16x32_bf16 v[32:35], a[244:247], v[204:207], v[32:35]
  ds_read_b128 v[188:191], v4 offset:61440
  v_mfma_f32_16x16x32_bf16 v[36:39], a[244:247], v[208:211], v[36:39]
  ds_read_b128 v[192:195], v5 offset:61440
  v_mfma_f32_16x16x32_bf16 v[40:43], a[244:247], v[212:215], v[40:43]
  ds_read_b128 v[196:199], v6 offset:61440
  v_mfma_f32_16x16x32_bf16 v[44:47], a[244:247], v[216:219], v[44:47]
  ds_read_b128 v[200:203], v7 offset:61440
  s_waitcnt lgkmcnt(4)
  v_mfma_f32_16x16x32_bf16 v[32:35], a[248:251], v[220:223], v[32:35]
  v_mfma_f32_16x16x32_bf16 v[36:39], a[248:251], v[224:227], v[36:39]
  v_mfma_f32_16x16x32_bf16 v[40:43], a[248:251], v[228:231], v[40:43]
  v_mfma_f32_16x16x32_bf16 v[44:47], a[248:251], v[232:235], v[44:47]
  s_waitcnt lgkmcnt(0)
  v_mfma_f32_16x16x32_bf16 v[32:35], a[252:255], v[188:191], v[32:35]
  v_mfma_f32_16x16x32_bf16 v[36:39], a[252:255], v[192:195], v[36:39]
  v_mfma_f32_16x16x32_bf16 v[40:43], a[252:255], v[196:199], v[40:43]
  v_mfma_f32_16x16x32_bf16 v[44:47], a[252:255], v[200:203], v[44:47]
  s_barrier
  s_nop 3
  v_cvt_pk_bf16_f32 v176, v32, v33
  v_cvt_pk_bf16_f32 v177, v34, v35
  v_cvt_pk_bf16_f32 v178, v36, v37
  v_cvt_pk_bf16_f32 v179, v38, v39
  v_cvt_pk_bf16_f32 v180, v40, v41
  v_cvt_pk_bf16_f32 v181, v42, v43
  v_cvt_pk_bf16_f32 v182, v44, v45
  v_cvt_pk_bf16_f32 v183, v46, v47
  v_permlane16_swap_b32 v176, v178
  v_permlane16_swap_b32 v177, v179
  v_permlane16_swap_b32 v180, v182
  v_permlane16_swap_b32 v181, v183
  s_add_u32 s26, s3, 0
  s_cmp_eq_u32 s23, 0
  s_cbranch_scc1 XS_31
  buffer_store_dwordx4 v[176:179], v12, s[4:7], s26 offen
  buffer_store_dwordx4 v[180:183], v13, s[4:7], s26 offen
XD_32:
  s_add_u32 s74, s68, 512
  v_lshlrev_b32 v251, 7, v1
  buffer_load_dwordx4 a[116:119], v2, s[4:7], s25 offen offset:1024
  buffer_load_dwordx4 a[120:123], v2, s[4:7], s25 offen offset:2048
  s_waitcnt vmcnt(2)
  s_mov_b64 exec, 15
  s_cmp_eq_u32 s23, 0
  s_cbranch_scc1 XS_33
  buffer_store_dword v254, v251, s[4:7], s74 offen
XD_34:
  s_mov_b64 exec, -1
  s_load_dwordx16 s[80:95], s[76:77], 512
  s_waitcnt lgkmcnt(0)
  s_and_b64 s[80:81], s[80:81], s[82:83]
  s_and_b64 s[84:85], s[84:85], s[86:87]
  s_and_b64 s[88:89], s[88:89], s[90:91]
  s_and_b64 s[92:93], s[92:93], s[94:95]
  s_and_b64 s[80:81], s[80:81], s[84:85]
  s_and_b64 s[88:89], s[88:89], s[92:93]
  s_and_b64 s[80:81], s[80:81], s[88:89]
  s_and_b32 s96, s80, s81
  s_cmp_eq_u32 s96, 1
  s_cbranch_scc0 SQ_35
SQok_36:
  s_add_u32 s72, s24, 0
  s_lshl_b32 s26, s22, 12
  s_add_u32 s72, s72, s26
  s_mov_b32 s73, s26
  s_add_u32 m0, s73, 0
  s_nop 0
  buffer_load_dwordx4 v2, s[4:7], s72 offen offset:0 sc1 lds
  buffer_load_dwordx4 v2, s[4:7], s72 offen offset:1024 sc1 lds
  buffer_load_dwordx4 v2, s[4:7], s72 offen offset:2048 sc1 lds
  buffer_load_dwordx4 v2, s[4:7], s72 offen offset:3072 sc1 lds
  s_add_u32 s72, s72, 16384
  s_add_u32 m0, s73, 16384
  s_nop 0
  buffer_load_dwordx4 v2, s[4:7], s72 offen offset:0 sc1 lds
  buffer_load_dwordx4 v2, s[4:7], s72 offen offset:1024 sc1 lds
  buffer_load_dwordx4 v2, s[4:7], s72 offen offset:2048 sc1 lds
  buffer_load_dwordx4 v2, s[4:7], s72 offen offset:3072 sc1 lds
  s_add_u32 s72, s72, 16384
  s_add_u32 m0, s73, 32768
  s_nop 0
  buffer_load_dwordx4 v2, s[4:7], s72 offen offset:0 sc1 lds
  buffer_load_dwordx4 v2, s[4:7], s72 offen offset:1024 sc1 lds
  buffer_load_dwordx4 v2, s[4:7], s72 offen offset:2048 sc1 lds
  buffer_load_dwordx4 v2, s[4:7], s72 offen offset:3072 sc1 lds
  s_waitcnt vmcnt(8)
  s_barrier
  ds_read_b128 v[188:191], v4 offset:0
  ds_read_b128 v[192:195], v5 offset:0
  ds_read_b128 v[196:199], v6 offset:0
  ds_read_b128 v[200:203], v7 offset:0
  ds_read_b128 v[204:207], v4 offset:4096
  ds_read_b128 v[208:211], v5 offset:4096
  ds_read_b128 v[212:215], v6 offset:4096
  ds_read_b128 v[216:219], v7 offset:4096
  s_waitcnt lgkmcnt(4)
  v_mfma_f32_16x16x32_bf16 v[104:107], a[0:3], v[188:191], 0
  ds_read_b128 v[220:223], v4 offset:8192
  v_mfma_f32_16x16x32_bf16 v[108:111], a[0:3], v[192:195], 0
  ds_read_b128 v[224:227], v5 offset:8192
  v_mfma_f32_16x16x32_bf16 v[112:115], a[0:3], v[196:199], 0
  ds_read_b128 v[228:231], v6 offset:8192
  v_mfma_f32_16x16x32_bf16 v[116:119], a[0:3], v[200:203], 0
  ds_read_b128 v[232:235], v7 offset:8192
  s_add_u32 s72, s72, 16384
  s_add_u32 m0, s73, 49152
  s_nop 0
  buffer_load_dwordx4 v2, s[4:7], s72 offen offset:0 sc1 lds
  v_mfma_f32_16x16x32_bf16 v[152:155], v[24:27], v[188:191], 0
  v_mfma_f32_16x16x32_bf16 v[156:159], v[188:191], v[188:191], 0
  v_mfma_f32_16x16x32_bf16 v[84:87], a[0:3], v[24:27], 0
  s_waitcnt lgkmcnt(4)
  v_mfma_f32_16x16x32_bf16 v[104:107], a[4:7], v[204:207], v[104:107]
  ds_read_b128 v[188:191], v4 offset:12288
  buffer_load_dwordx4 v2, s[4:7], s72 offen offset:1024 sc1 lds
  v_mfma_f32_16x16x32_bf16 v[108:111], a[4:7], v[208:211], v[108:111]
  ds_read_b128 v[192:195], v5 offset:12288
  v_mfma_f32_16x16x32_bf16 v[112:115], a[4:7], v[212:215], v[112:115]
  ds_read_b128 v[196:199], v6 offset:12288
  v_mfma_f32_16x16x32_bf16 v[116:119], a[4:7], v[216:219], v[116:119]
  ds_read_b128 v[200:203], v7 offset:12288
  v_mfma_f32_16x16x32_bf16 v[152:155], v[24:27], v[204:207], v[152:155]
  buffer_load_dwordx4 v2, s[4:7], s72 offen offset:2048 sc1 lds
  v_mfma_f32_16x16x32_bf16 v[156:159], v[204:207], v[204:207], v[156:159]
  v_mfma_f32_16x16x32_bf16 v[84:87], a[4:7], v[24:27], v[84:87]
  s_add_u32 s74, s33, 1024
  v_lshlrev_b32 v251, 7, v1
  s_mov_b64 exec, 15
  buffer_load_dword v250, v251, s[4:7], s74 offen
  s_mov_b64 exec, -1
  s_waitcnt vmcnt(8)
  s_barrier
  s_waitcnt lgkmcnt(4)
  v_mfma_f32_16x16x32_bf16 v[104:107], a[8:11], v[220:223], v[104:107]
  ds_read_b128 v[204:207], v4 offset:16384
  v_mfma_f32_16x16x32_bf16 v[108:111], a[8:11], v[224:227], v[108:111]
  ds_read_b128 v[208:211], v5 offset:16384
  buffer_load_dwordx4 v2, s[4:7], s72 offen offset:3072 sc1 lds
  v_mfma_f32_16x16x32_bf16 v[112:115], a[8:11], v[228:231], v[112:115]
  ds_read_b128 v[212:215], v6 offset:16384
  v_mfma_f32_16x16x32_bf16 v[116:119], a[8:11], v[232:235], v[116:119]
  ds_read_b128 v[216:219], v7 offset:16384
  v_mfma_f32_16x16x32_bf16 v[152:155], v[24:27], v[220:223], v[152:155]
  v_mfma_f32_16x16x32_bf16 v[156:159], v[220:223], v[220:223], v[156:159]
  buffer_load_dwordx4 a[124:127], v2, s[4:7], s25 offen offset:3072
  v_mfma_f32_16x16x32_bf16 v[84:87], a[8:11], v[24:27], v[84:87]
  s_waitcnt lgkmcnt(4)
  v_mfma_f32_16x16x32_bf16 v[104:107], a[12:15], v[188:191], v[104:107]
  ds_read_b128 v[220:223], v4 offset:20480
  v_mfma_f32_16x16x32_bf16 v[108:111], a[12:15], v[192:195], v[108:111]
  ds_read_b128 v[224:227], v5 offset:20480
  v_mfma_f32_16x16x32_bf16 v[112:115], a[12:15], v[196:199], v[112:115]
  ds_read_b128 v[228:231], v6 offset:20480
  s_add_u32 s25, s25, 4096
  buffer_load_dwordx4 a[128:131], v2, s[4:7], s25 offen offset:0
  v_mfma_f32_16x16x32_bf16 v[116:119], a[12:15], v[200:203], v[116:119]
  ds_read_b128 v[232:235], v7 offset:20480
  v_mfma_f32_16x16x32_bf16 v[152:155], v[24:27], v[188:191], v[152:155]
  v_mfma_f32_16x16x32_bf16 v[156:159], v[188:191], v[188:191], v[156:159]
  v_mfma_f32_16x16x32_bf16 v[84:87], a[12:15], v[24:27], v[84:87]
  buffer_load_dwordx4 a[132:135], v2, s[4:7], s25 offen offset:1024
  s_waitcnt lgkmcnt(4)
  v_mfma_f32_16x16x32_bf16 v[104:107], a[16:19], v[204:207], v[104:107]
  ds_read_b128 v[188:191], v4 offset:24576
  v_mfma_f32_16x16x32_bf16 v[108:111], a[16:19], v[208:211], v[108:111]
  ds_read_b128 v[192:195], v5 offset:24576
  v_mfma_f32_16x16x32_bf16 v[112:115], a[16:19], v[212:215], v[112:115]
  ds_read_b128 v[196:199], v6 offset:24576
  v_mfma_f32_16x16x32_bf16 v[116:119], a[16:19], v[216:219], v[116:119]
  ds_read_b128 v[200:203], v7 offset:24576
  buffer_load_dwordx4 a[136:139], v2, s[4:7], s25 offen offset:2048
  v_mfma_f32_16x16x32_bf16 v[152:155], v[24:27], v[204:207], v[152:155]
  v_mfma_f32_16x16x32_bf16 v[156:159], v[204:207], v[204:207], v[156:159]
  v_mfma_f32_16x16x32_bf16 v[84:87], a[16:19], v[24:27], v[84:87]
  s_waitcnt lgkmcnt(4)
  v_mfma_f32_16x16x32_bf16 v[104:107], a[20:23], v[220:223], v[104:107]
  ds_read_b128 v[204:207], v4 offset:28672
  buffer_load_dwordx4 a[140:143], v2, s[4:7], s25 offen offset:3072
  v_mfma_f32_16x16x32_bf16 v[108:111], a[20:23], v[224:227], v[108:111]
  ds_read_b128 v[208:211], v5 offset:28672
  v_mfma_f32_16x16x32_bf16 v[112:115], a[20:23], v[228:231], v[112:115]
  ds_read_b128 v[212:215], v6 offset:28672
  v_mfma_f32_16x16x32_bf16 v[116:119], a[20:23], v[232:235], v[116:119]
  ds_read_b128 v[216:219], v7 offset:28672
  v_mfma_f32_16x16x32_bf16 v[152:155], v[24:27], v[220:223], v[152:155]
  s_add_u32 s25, s25, 4096
  buffer_load_dwordx4 a[144:147], v2, s[4:7], s25 offen offset:0
  v_mfma_f32_16x16x32_bf16 v[156:159], v[220:223], v[220:223], v[156:159]
  v_mfma_f32_16x16x32_bf16 v[84:87], a[20:23], v[24:27], v[84:87]
  s_waitcnt vmcnt(11)
  s_barrier
  s_waitcnt lgkmcnt(4)
  v_mfma_f32_16x16x32_bf16 v[104:107], a[24:27], v[188:191], v[104:107]
  ds_read_b128 v[220:223], v4 offset:32768
  v_mfma_f32_16x16x32_bf16 v[108:111], a[24:27], v[192:195], v[108:111]
  ds_read_b128 v[224:227], v5 offset:32768
  buffer_load_dwordx4 a[148:151], v2, s[4:7], s25 offen offset:1024
  v_mfma_f32_16x16x32_bf16 v[112:115], a[24:27], v[196:199], v[112:115]
  ds_read_b128 v[228:231], v6 offset:32768
  v_mfma_f32_16x16x32_bf16 v[116:119], a[24:27], v[200:203], v[116:119]
  ds_read_b128 v[232:235], v7 offset:32768
  v_mfma_f32_16x16x32_bf16 v[152:155], v[24:27], v[188:191], v[152:155]
  v_mfma_f32_16x16x32_bf16 v[156:159], v[188:191], v[188:191], v[156:159]
  buffer_load_dwordx4 a[152:155], v2, s[4:7], s25 offen offset:2048
  v_mfma_f32_16x16x32_bf16 v[84:87], a[24:27], v[24:27], v[84:87]
  s_waitcnt lgkmcnt(4)
  v_mfma_f32_16x16x32_bf16 v[104:107], a[28:31], v[204:207], v[104:107]
  ds_read_b128 v[188:191], v4 offset:36864
  v_mfma_f32_16x16x32_bf16 v[108:111], a[28:31], v[208:211], v[108:111]
  ds_read_b128 v[192:195], v5 offset:36864
  v_mfma_f32_16x16x32_bf16 v[112:115], a[28:31], v[212:215], v[112:115]
  ds_read_b128 v[196:199], v6 offset:36864
  buffer_load_dwordx4 a[156:159], v2, s[4:7], s25 offen offset:3072
  v_mfma_f32_16x16x32_bf16 v[116:119], a[28:31], v[216:219], v[116:119]
  ds_read_b128 v[200:203], v7 offset:36864
  v_mfma_f32_16x16x32_bf16 v[152:155], v[24:27], v[204:207], v[152:155]
  v_mfma_f32_16x16x32_bf16 v[156:159], v[204:207], v[204:207], v[156:159]
  v_mfma_f32_16x16x32_bf16 v[84:87], a[28:31], v[24:27], v[84:87]
  s_add_u32 s25, s25, 4096
  buffer_load_dwordx4 a[160:163], v2, s[4:7], s25 offen offset:0
  s_waitcnt lgkmcnt(4)
  v_mfma_f32_16x16x32_bf16 v[104:107], a[32:35], v[220:223], v[104:107]
  ds_read_b128 v[204:207], v4 offset:40960
  v_mfma_f32_16x16x32_bf16 v[108:111], a[32:35], v[224:227], v[108:111]
  ds_read_b128 v[208:211], v5 offset:40960
  v_mfma_f32_16x16x32_bf16 v[112:115], a[32:35], v[228:231], v[112:115]
  ds_read_b128 v[212:215], v6 offset:40960
  v_mfma_f32_16x16x32_bf16 v[116:119], a[32:35], v[232:235], v[116:119]
  ds_read_b128 v[216:219], v7 offset:40960
  buffer_load_dwordx4 a[164:167], v2, s[4:7], s25 offen offset:1024
  v_mfma_f32_16x16x32_bf16 v[152:155], v[24:27], v[220:223], v[152:155]
  v_mfma_f32_16x16x32_bf16 v[156:159], v[220:223], v[220:223], v[156:159]
  v_mfma_f32_16x16x32_bf16 v[84:87], a[32:35], v[24:27], v[84:87]
  s_waitcnt lgkmcnt(4)
  v_mfma_f32_16x16x32_bf16 v[104:107], a[36:39], v[188:191], v[104:107]
  ds_read_b128 v[220:223], v4 offset:45056
  buffer_load_dwordx4 a[168:171], v2, s[4:7], s25 offen offset:2048
  v_mfma_f32_16x16x32_bf16 v[108:111], a[36:39], v[192:195], v[108:111]
  ds_read_b128 v[224:227], v5 offset:45056
  v_mfma_f32_16x16x32_bf16 v[112:115], a[36:39], v[196:199], v[112:115]
  ds_read_b128 v[228:231], v6 offset:45056
  v_mfma_f32_16x16x32_bf16 v[116:119], a[36:39], v[200:203], v[116:119]
  ds_read_b128 v[232:235], v7 offset:45056
  v_mfma_f32_16x16x32_bf16 v[152:155], v[24:27], v[188:191], v[152:155]
  buffer_load_dwordx4 a[172:175], v2, s[4:7], s25 offen offset:3072
  v_mfma_f32_16x16x32_bf16 v[156:159], v[188:191], v[188:191], v[156:159]
  v_mfma_f32_16x16x32_bf16 v[84:87], a[36:39], v[24:27], v[84:87]
  s_waitcnt vmcnt(13)
  s_barrier
  s_waitcnt lgkmcnt(4)
  v_mfma_f32_16x16x32_bf16 v[104:107], a[40:43], v[204:207], v[104:107]
  ds_read_b128 v[188:191], v4 offset:49152
  v_mfma_f32_16x16x32_bf16 v[108:111], a[40:43], v[208:211], v[108:111]
  ds_read_b128 v[192:195], v5 offset:49152
  s_add_u32 s25, s25, 4096
  buffer_load_dwordx4 a[176:179], v2, s[4:7], s25 offen offset:0
  v_mfma_f32_16x16x32_bf16 v[112:115], a[40:43], v[212:215], v[112:115]
  ds_read_b128 v[196:199], v6 offset:49152
  v_mfma_f32_16x16x32_bf16 v[116:119], a[40:43], v[216:219], v[116:119]
  ds_read_b128 v[200:203], v7 offset:49152
  v_mfma_f32_16x16x32_bf16 v[152:155], v[24:27], v[204:207], v[152:155]
  v_mfma_f32_16x16x32_bf16 v[156:159], v[204:207], v[204:207], v[156:159]
  buffer_load_dwordx4 a[180:183], v2, s[4:7], s25 offen offset:1024
  v_mfma_f32_16x16x32_bf16 v[84:87], a[40:43], v[24:27], v[84:87]
  s_waitcnt lgkmcnt(4)
  v_mfma_f32_16x16x32_bf16 v[104:107], a[44:47], v[220:223], v[104:107]
  ds_read_b128 v[204:207], v4 offset:53248
  v_mfma_f32_16x16x32_bf16 v[108:111], a[44:47], v[224:227], v[108:111]
  ds_read_b128 v[208:211], v5 offset:53248
  v_mfma_f32_16x16x32_bf16 v[112:115], a[44:47], v[228:231], v[112:115]
  ds_read_b128 v[212:215], v6 offset:53248
  buffer_load_dwordx4 a[184:187], v2, s[4:7], s25 offen offset:2048
  v_mfma_f32_16x16x32_bf16 v[116:119], a[44:47], v[232:235], v[116:119]
  ds_read_b128 v[216:219], v7 offset:53248
  v_mfma_f32_16x16x32_bf16 v[152:155], v[24:27], v[220:223], v[152:155]
  v_mfma_f32_16x16x32_bf16 v[156:159], v[220:223], v[220:223], v[156:159]
  v_mfma_f32_16x16x32_bf16 v[84:87], a[44:47], v[24:27], v[84:87]
  buffer_load_dwordx4 a[188:191], v2, s[4:7], s25 offen offset:3072
  s_waitcnt lgkmcnt(4)
  v_mfma_f32_16x16x32_bf16 v[104:107], a[48:51], v[188:191], v[104:107]
  ds_read_b128 v[220:223], v4 offset:57344
  v_mfma_f32_16x16x32_bf16 v[108:111], a[48:51], v[192:195], v[108:111]
  ds_read_b128 v[224:227], v5 offset:57344
  v_mfma_f32_16x16x32_bf16 v[112:115], a[48:51], v[196:199], v[112:115]
  ds_read_b128 v[228:231], v6 offset:57344
  v_mfma_f32_16x16x32_bf16 v[116:119], a[48:51], v[200:203], v[116:119]
  ds_read_b128 v[232:235], v7 offset:57344
  s_add_u32 s25, s25, 4096
  buffer_load_dwordx4 a[192:195], v2, s[4:7], s25 offen offset:0
  v_mfma_f32_16x16x32_bf16 v[152:155], v[24:27], v[188:191], v[152:155]
  v_mfma_f32_16x16x32_bf16 v[156:159], v[188:191], v[188:191], v[156:159]
  v_mfma_f32_16x16x32_bf16 v[84:87], a[48:51], v[24:27], v[84:87]
  s_waitcnt lgkmcnt(4)
  v_mfma_f32_16x16x32_bf16 v[104:107], a[52:55], v[204:207], v[104:107]
  ds_read_b128 v[188:191], v4 offset:61440
  buffer_load_dwordx4 a[196:199], v2, s[4:7], s25 offen offset:1024
  v_mfma_f32_16x16x32_bf16 v[108:111], a[52:55], v[208:211], v[108:111]
  ds_read_b128 v[192:195], v5 offset:61440
  v_mfma_f32_16x16x32_bf16 v[112:115], a[52:55], v[212:215], v[112:115]
  ds_read_b128 v[196:199], v6 offset:61440
  v_mfma_f32_16x16x32_bf16 v[116:119], a[52:55], v[216:219], v[116:119]
  ds_read_b128 v[200:203], v7 offset:61440
  v_mfma_f32_16x16x32_bf16 v[152:155], v[24:27], v[204:207], v[152:155]
  buffer_load_dwordx4 a[200:203], v2, s[4:7], s25 offen offset:2048
  v_mfma_f32_16x16x32_bf16 v[156:159], v[204:207], v[204:207], v[156:159]
  v_mfma_f32_16x16x32_bf16 v[84:87], a[52:55], v[24:27], v[84:87]
  s_waitcnt lgkmcnt(4)
  v_mfma_f32_16x16x32_bf16 v[104:107], a[56:59], v[220:223], v[104:107]
  v_mfma_f32_16x16x32_bf16 v[108:111], a[56:59], v[224:227], v[108:111]
  buffer_load_dwordx4 a[204:207], v2, s[4:7], s25 offen offset:3072
  v_mfma_f32_16x16x32_bf16 v[112:115], a[56:59], v[228:231], v[112:115]
  v_mfma_f32_16x16x32_bf16 v[116:119], a[56:59], v[232:235], v[116:119]
  v_mfma_f32_16x16x32_bf16 v[152:155], v[24:27], v[220:223], v[152:155]
  v_mfma_f32_16x16x32_bf16 v[156:159], v[220:223], v[220:223], v[156:159]
  s_add_u32 s25, s25, 4096
  buffer_load_dwordx4 a[208:211], v2, s[4:7], s25 offen offset:0
  v_mfma_f32_16x16x32_bf16 v[84:87], a[56:59], v[24:27], v[84:87]
  s_waitcnt lgkmcnt(0)
  v_mfma_f32_16x16x32_bf16 v[104:107], a[60:63], v[188:191], v[104:107]
  v_mfma_f32_16x16x32_bf16 v[108:111], a[60:63], v[192:195], v[108:111]
  v_mfma_f32_16x16x32_bf16 v[112:115], a[60:63], v[196:199], v[112:115]
  buffer_load_dwordx4 a[212:215], v2, s[4:7], s25 offen offset:1024
  v_mfma_f32_16x16x32_bf16 v[116:119], a[60:63], v[200:203], v[116:119]
  v_mfma_f32_16x16x32_bf16 v[152:155], v[24:27], v[188:191], v[152:155]
  v_mfma_f32_16x16x32_bf16 v[156:159], v[188:191], v[188:191], v[156:159]
  v_mfma_f32_16x16x32_bf16 v[84:87], a[60:63], v[24:27], v[84:87]
  buffer_load_dwordx4 a[216:219], v2, s[4:7], s25 offen offset:2048
  s_nop 5
  v_cndmask_b32_e64 v224, v156, v157, s[40:41]
  v_mul_f32 v225, s60, v152
  v_cndmask_b32_e64 v224, v224, v158, s[42:43]
  v_cndmask_b32_e64 v224, v224, v159, s[44:45]
  v_mul_f32 v224, s60, v224
  v_fma_f32 v224, -v225, v225, v224
  v_max_f32 v224, 0, v224
  v_add_f32 v226, s61, v224
  v_rsq_f32 v230, v226
  v_subrev_u32 v232, 131072, v14
  v_mul_f32 v231, v230, v225
  v_lshrrev_b32 v232, 2, v232
  v_add_u32 v232, 132096, v232
  v_mul_f32 v227, v230, v230
  v_mul_f32 v227, v227, v224
  v_add_f32 v227, s61, v227
  v_rsq_f32 v227, v227
  s_nop 0
  v_mul_f32 v228, v230, v227
  v_mul_f32 v229, v231, v227
  s_mov_b64 exec, s[46:47]
  ds_write_b128 v14, v[228:231]
  s_mov_b64 exec, -1
  s_waitcnt lgkmcnt(0)
  s_barrier
  ds_read_b128 v[200:203], v14
  ds_read_b128 v[204:207], v15
  ds_read_b128 v[208:211], v16
  ds_read_b128 v[212:215], v17
  s_waitcnt lgkmcnt(0)
  v_pk_mul_f32 v[224:225], v[84:85], v[200:201] op_sel:[0,1] op_sel_hi:[1,1]
  v_pk_mul_f32 v[226:227], v[86:87], v[200:201] op_sel:[0,1] op_sel_hi:[1,1]
  v_pk_mul_f32 v[228:229], v[84:85], v[204:205] op_sel:[0,1] op_sel_hi:[1,1]
  v_pk_mul_f32 v[230:231], v[86:87], v[204:205] op_sel:[0,1] op_sel_hi:[1,1]
  v_pk_fma_f32 v[104:105], v[104:105], v[200:201], v[224:225] op_sel_hi:[1,0,1] neg_lo:[0,0,1] neg_hi:[0,0,1]
  v_pk_fma_f32 v[106:107], v[106:107], v[200:201], v[226:227] op_sel_hi:[1,0,1] neg_lo:[0,0,1] neg_hi:[0,0,1]
  v_pk_fma_f32 v[108:109], v[108:109], v[204:205], v[228:229] op_sel_hi:[1,0,1] neg_lo:[0,0,1] neg_hi:[0,0,1]
  v_pk_fma_f32 v[110:111], v[110:111], v[204:205], v[230:231] op_sel_hi:[1,0,1] neg_lo:[0,0,1] neg_hi:[0,0,1]
  v_pk_mul_f32 v[224:225], v[84:85], v[208:209] op_sel:[0,1] op_sel_hi:[1,1]
  v_pk_mul_f32 v[226:227], v[86:87], v[208:209] op_sel:[0,1] op_sel_hi:[1,1]
  v_pk_mul_f32 v[228:229], v[84:85], v[212:213] op_sel:[0,1] op_sel_hi:[1,1]
  v_pk_mul_f32 v[230:231], v[86:87], v[212:213] op_sel:[0,1] op_sel_hi:[1,1]
  v_pk_fma_f32 v[112:113], v[112:113], v[208:209], v[224:225] op_sel_hi:[1,0,1] neg_lo:[0,0,1] neg_hi:[0,0,1]
  v_pk_fma_f32 v[114:115], v[114:115], v[208:209], v[226:227] op_sel_hi:[1,0,1] neg_lo:[0,0,1] neg_hi:[0,0,1]
  buffer_load_dwordx4 a[220:223], v2, s[4:7], s25 offen offset:3072
  v_pk_fma_f32 v[116:117], v[116:117], v[212:213], v[228:229] op_sel_hi:[1,0,1] neg_lo:[0,0,1] neg_hi:[0,0,1]
  v_pk_fma_f32 v[118:119], v[118:119], v[212:213], v[230:231] op_sel_hi:[1,0,1] neg_lo:[0,0,1] neg_hi:[0,0,1]
  s_add_u32 s97, s3, 1835008
  v_pk_mul_f32 v[224:225], v[104:105], v[104:105]
  v_pk_mul_f32 v[226:227], v[106:107], v[106:107]
  v_pk_mul_f32 v[228:229], v[108:109], v[108:109]
  v_pk_mul_f32 v[230:231], v[110:111], v[110:111]
  v_pk_fma_f32 v[224:225], v[224:225], v[28:29], v[28:29] op_sel:[0,1,0] op_sel_hi:[1,1,0]
  v_pk_fma_f32 v[226:227], v[226:227], v[28:29], v[28:29] op_sel:[0,1,0] op_sel_hi:[1,1,0]
  v_pk_fma_f32 v[228:229], v[228:229], v[28:29], v[28:29] op_sel:[0,1,0] op_sel_hi:[1,1,0]
  v_pk_fma_f32 v[230:231], v[230:231], v[28:29], v[28:29] op_sel:[0,1,0] op_sel_hi:[1,1,0]
  v_pk_mul_f32 v[224:225], v[224:225], v[104:105]
  v_pk_mul_f32 v[226:227], v[226:227], v[106:107]
  v_pk_mul_f32 v[228:229], v[228:229], v[108:109]
  v_pk_mul_f32 v[230:231], v[230:231], v[110:111]
  v_exp_f32 v224, v224
  v_exp_f32 v225, v225
  v_exp_f32 v226, v226
  v_exp_f32 v227, v227
  v_exp_f32 v228, v228
  v_exp_f32 v229, v229
  v_exp_f32 v230, v230
  v_exp_f32 v231, v231
  v_pk_add_f32 v[224:225], v[224:225], 1.0 op_sel_hi:[1,0]
  v_pk_add_f32 v[226:227], v[226:227], 1.0 op_sel_hi:[1,0]
  v_pk_add_f32 v[228:229], v[228:229], 1.0 op_sel_hi:[1,0]
  v_pk_add_f32 v[230:231], v[230:231], 1.0 op_sel_hi:[1,0]
  v_rcp_f32 v224, v224
  v_rcp_f32 v225, v225
  v_rcp_f32 v226, v226
  v_rcp_f32 v227, v227
  v_rcp_f32 v228, v228
  v_rcp_f32 v229, v229
  v_rcp_f32 v230, v230
  v_rcp_f32 v231, v231
  v_pk_mul_f32 v[104:105], v[104:105], v[224:225]
  v_pk_mul_f32 v[106:107], v[106:107], v[226:227]
  v_pk_mul_f32 v[108:109], v[108:109], v[228:229]
  v_pk_mul_f32 v[110:111], v[110:111], v[230:231]
  v_cvt_pk_bf16_f32 v176, v104, v105
  v_cvt_pk_bf16_f32 v177, v106, v107
  v_cvt_pk_bf16_f32 v178, v108, v109
  v_cvt_pk_bf16_f32 v179, v110, v111
  s_nop 0
  v_permlane16_swap_b32 v176, v178
  v_permlane16_swap_b32 v177, v179
  s_cmp_eq_u32 s23, 0
  s_cbranch_scc1 XS_39
  buffer_store_dwordx4 v[176:179], v12, s[4:7], s97 offen
XD_40:
  v_pk_mul_f32 v[224:225], v[112:113], v[112:113]
  v_pk_mul_f32 v[226:227], v[114:115], v[114:115]
  v_pk_mul_f32 v[228:229], v[116:117], v[116:117]
  v_pk_mul_f32 v[230:231], v[118:119], v[118:119]
  v_pk_fma_f32 v[224:225], v[224:225], v[28:29], v[28:29] op_sel:[0,1,0] op_sel_hi:[1,1,0]
  v_pk_fma_f32 v[226:227], v[226:227], v[28:29], v[28:29] op_sel:[0,1,0] op_sel_hi:[1,1,0]
  v_pk_fma_f32 v[228:229], v[228:229], v[28:29], v[28:29] op_sel:[0,1,0] op_sel_hi:[1,1,0]
  v_pk_fma_f32 v[230:231], v[230:231], v[28:29], v[28:29] op_sel:[0,1,0] op_sel_hi:[1,1,0]
  v_pk_mul_f32 v[224:225], v[224:225], v[112:113]
  v_pk_mul_f32 v[226:227], v[226:227], v[114:115]
  v_pk_mul_f32 v[228:229], v[228:229], v[116:117]
  v_pk_mul_f32 v[230:231], v[230:231], v[118:119]
  v_exp_f32 v224, v224
  v_exp_f32 v225, v225
  v_exp_f32 v226, v226
  v_exp_f32 v227, v227
  v_exp_f32 v228, v228
  v_exp_f32 v229, v229
  v_exp_f32 v230, v230
  v_exp_f32 v231, v231
  v_pk_add_f32 v[224:225], v[224:225], 1.0 op_sel_hi:[1,0]
  v_pk_add_f32 v[226:227], v[226:227], 1.0 op_sel_hi:[1,0]
  v_pk_add_f32 v[228:229], v[228:229], 1.0 op_sel_hi:[1,0]
  v_pk_add_f32 v[230:231], v[230:231], 1.0 op_sel_hi:[1,0]
  v_rcp_f32 v224, v224
  v_rcp_f32 v225, v225
  v_rcp_f32 v226, v226
  v_rcp_f32 v227, v227
  v_rcp_f32 v228, v228
  v_rcp_f32 v229, v229
  v_rcp_f32 v230, v230
  v_rcp_f32 v231, v231
  v_pk_mul_f32 v[112:113], v[112:113], v[224:225]
  v_pk_mul_f32 v[114:115], v[114:115], v[226:227]
  v_pk_mul_f32 v[116:117], v[116:117], v[228:229]
  v_pk_mul_f32 v[118:119], v[118:119], v[230:231]
  v_cvt_pk_bf16_f32 v180, v112, v113
  v_cvt_pk_bf16_f32 v181, v114, v115
  v_cvt_pk_bf16_f32 v182, v116, v117
  v_cvt_pk_bf16_f32 v183, v118, v119
  s_nop 0
  v_permlane16_swap_b32 v180, v182
  v_permlane16_swap_b32 v181, v183
  s_cmp_eq_u32 s23, 0
  s_cbranch_scc1 XS_41
  buffer_store_dwordx4 v[180:183], v13, s[4:7], s97 offen
XD_42:
  v_pk_fma_f32 v[48:49], v[32:33], v[202:203], v[202:203] op_sel:[0,0,1] op_sel_hi:[1,0,1] neg_lo:[0,0,1] neg_hi:[0,0,1]
  v_pk_fma_f32 v[50:51], v[34:35], v[202:203], v[202:203] op_sel:[0,0,1] op_sel_hi:[1,0,1] neg_lo:[0,0,1] neg_hi:[0,0,1]
  v_pk_fma_f32 v[52:53], v[36:37], v[206:207], v[206:207] op_sel:[0,0,1] op_sel_hi:[1,0,1] neg_lo:[0,0,1] neg_hi:[0,0,1]
  v_pk_fma_f32 v[54:55], v[38:39], v[206:207], v[206:207] op_sel:[0,0,1] op_sel_hi:[1,0,1] neg_lo:[0,0,1] neg_hi:[0,0,1]
  v_pk_fma_f32 v[56:57], v[40:41], v[210:211], v[210:211] op_sel:[0,0,1] op_sel_hi:[1,0,1] neg_lo:[0,0,1] neg_hi:[0,0,1]
  v_pk_fma_f32 v[58:59], v[42:43], v[210:211], v[210:211] op_sel:[0,0,1] op_sel_hi:[1,0,1] neg_lo:[0,0,1] neg_hi:[0,0,1]
  v_pk_fma_f32 v[60:61], v[44:45], v[214:215], v[214:215] op_sel:[0,0,1] op_sel_hi:[1,0,1] neg_lo:[0,0,1] neg_hi:[0,0,1]
  v_pk_fma_f32 v[62:63], v[46:47], v[214:215], v[214:215] op_sel:[0,0,1] op_sel_hi:[1,0,1] neg_lo:[0,0,1] neg_hi:[0,0,1]
  s_add_u32 s74, s68, 1024
  v_lshlrev_b32 v251, 7, v1
  s_add_u32 s25, s25, 4096
  buffer_load_dwordx4 a[224:227], v2, s[4:7], s25 offen offset:0
  buffer_load_dwordx4 a[228:231], v2, s[4:7], s25 offen offset:1024
  s_waitcnt vmcnt(2)
  s_mov_b64 exec, 15
  s_cmp_eq_u32 s23, 0
  s_cbranch_scc1 XS_43
  buffer_store_dword v254, v251, s[4:7], s74 offen
XD_44:
  s_mov_b64 exec, -1
  s_add_u32 s26, s62, 0
  s_mov_b64 exec, s[48:49]
  s_cbranch_execz HS_45
  buffer_store_dwordx4 v[176:179], v22, s[4:7], s26 offen sc1
HS_45:
  s_mov_b64 exec, -1
  s_mov_b64 exec, s[50:51]
  s_cbranch_execz HS_46
  buffer_store_dwordx4 v[180:183], v23, s[4:7], s26 offen sc1
HS_46:
  s_mov_b64 exec, -1
  s_load_dwordx16 s[80:95], s[76:77], 1024
  s_waitcnt lgkmcnt(0)
  s_and_b64 s[80:81], s[80:81], s[82:83]
  s_and_b64 s[84:85], s[84:85], s[86:87]
  s_and_b64 s[88:89], s[88:89], s[90:91]
  s_and_b64 s[92:93], s[92:93], s[94:95]
  s_and_b64 s[80:81], s[80:81], s[84:85]
  s_and_b64 s[88:89], s[88:89], s[92:93]
  s_and_b64 s[80:81], s[80:81], s[88:89]
  s_and_b32 s96, s80, s81
  s_cmp_eq_u32 s96, 1
  s_cbranch_scc0 SQ_47
SQok_48:
  s_add_u32 s72, s24, 1835008
  s_lshl_b32 s26, s22, 12
  s_add_u32 s72, s72, s26
  s_mul_i32 s73, s22, 5120
  s_add_u32 s73, s73, 32
  s_add_u32 m0, s73, 0
  s_nop 0
  buffer_load_dwordx4 v2, s[4:7], s72 offen offset:0 sc1 lds
  s_add_u32 m0, s73, 256
  s_nop 0
  buffer_load_dwordx4 v2, s[4:7], s72 offen offset:1024 sc1 lds
  s_add_u32 m0, s73, 512
  s_nop 0
  buffer_load_dwordx4 v2, s[4:7], s72 offen offset:2048 sc1 lds
  s_add_u32 m0, s73, 768
  s_nop 0
  buffer_load_dwordx4 v2, s[4:7], s72 offen offset:3072 sc1 lds
  s_add_u32 s72, s72, 16384
  s_add_u32 m0, s73, 20480
  s_nop 0
  buffer_load_dwordx4 v2, s[4:7], s72 offen offset:0 sc1 lds
  s_add_u32 m0, s73, 20736
  s_nop 0
  buffer_load_dwordx4 v2, s[4:7], s72 offen offset:1024 sc1 lds
  s_add_u32 m0, s73, 20992
  s_nop 0
  buffer_load_dwordx4 v2, s[4:7], s72 offen offset:2048 sc1 lds
  s_add_u32 m0, s73, 21248
  s_nop 0
  buffer_load_dwordx4 v2, s[4:7], s72 offen offset:3072 sc1 lds
  s_add_u32 s72, s72, 16384
  s_add_u32 m0, s73, 40960
  s_nop 0
  buffer_load_dwordx4 v2, s[4:7], s72 offen offset:0 sc1 lds
  s_add_u32 m0, s73, 41216
  s_nop 0
  buffer_load_dwordx4 v2, s[4:7], s72 offen offset:1024 sc1 lds
  s_add_u32 m0, s73, 41472
  s_nop 0
  buffer_load_dwordx4 v2, s[4:7], s72 offen offset:2048 sc1 lds
  s_add_u32 m0, s73, 41728
  s_nop 0
  buffer_load_dwordx4 v2, s[4:7], s72 offen offset:3072 sc1 lds
  s_cmp_lg_u32 s22, 3
  s_cbranch_scc1 HW_51
  v_lshlrev_b32 v184, 5, v1
  s_add_u32 s26, s63, 0
  buffer_load_dwordx4 v[176:179], v184, s[4:7], s26 offen sc1
  buffer_load_dwordx4 v[180:183], v184, s[4:7], s26 offen offset:16 sc1
  s_waitcnt vmcnt(0)
  v_max_u32 v250, v176, v177
  v_max3_u32 v250, v250, v178, v179
  v_max3_u32 v250, v250, v180, v181
  v_max3_u32 v250, v250, v182, v183
  v_cmp_eq_u32 vcc, -1, v250
  s_cbranch_vccnz SP_52
SPok_53:
  v_mul_u32_u24 v185, 1280, v1
  v_bfe_u32 v186, v1, 4, 1
  v_mul_u32_u24 v186, 1056, v186
  v_add_u32 v185, v185, v186
  ds_write_b128 v185, v[176:179]
  ds_write_b128 v185, v[180:183] offset:16
  s_waitcnt lgkmcnt(0)
HW_51:
  s_waitcnt vmcnt(8)
  s_barrier
  ds_read_b128 v[188:191], v8 offset:16
  ds_read_b128 v[192:195], v9 offset:16
  ds_read_b128 v[196:199], v10 offset:16
  ds_read_b128 v[200:203], v11 offset:16
  ds_read_b128 v[204:207], v8 offset:5136
  ds_read_b128 v[208:211], v9 offset:5136
  ds_read_b128 v[212:215], v10 offset:5136
  ds_read_b128 v[216:219], v11 offset:5136
  s_waitcnt lgkmcnt(4)
  v_mfma_f32_16x16x32_bf16 v[48:51], a[64:67], v[188:191], v[48:51]
  ds_read_b128 v[220:223], v8 offset:10256
  v_mfma_f32_16x16x32_bf16 v[52:55], a[64:67], v[192:195], v[52:55]
  ds_read_b128 v[224:227], v9 offset:10256
  v_mfma_f32_16x16x32_bf16 v[56:59], a[64:67], v[196:199], v[56:59]
  ds_read_b128 v[228:231], v10 offset:10256
  v_mfma_f32_16x16x32_bf16 v[60:63], a[64:67], v[200:203], v[60:63]
  ds_read_b128 v[232:235], v11 offset:10256
  s_add_u32 s72, s72, 16384
  s_add_u32 m0, s73, 61440
  s_nop 0
  buffer_load_dwordx4 v2, s[4:7], s72 offen offset:0 sc1 lds
  s_waitcnt lgkmcnt(4)
  v_mfma_f32_16x16x32_bf16 v[48:51], a[68:71], v[204:207], v[48:51]
  ds_read_b128 v[188:191], v8 offset:15376
  v_mfma_f32_16x16x32_bf16 v[52:55], a[68:71], v[208:211], v[52:55]
  ds_read_b128 v[192:195], v9 offset:15376
  v_mfma_f32_16x16x32_bf16 v[56:59], a[68:71], v[212:215], v[56:59]
  ds_read_b128 v[196:199], v10 offset:15376
  v_mfma_f32_16x16x32_bf16 v[60:63], a[68:71], v[216:219], v[60:63]
  ds_read_b128 v[200:203], v11 offset:15376
  s_add_u32 m0, s73, 61696
  s_nop 0
  buffer_load_dwordx4 v2, s[4:7], s72 offen offset:1024 sc1 lds
  s_add_u32 s74, s33, 1536
  v_lshlrev_b32 v251, 7, v1
  s_mov_b64 exec, 15
  buffer_load_dword v250, v251, s[4:7], s74 offen
  s_mov_b64 exec, -1
  s_waitcnt vmcnt(7)
  s_barrier
  s_waitcnt lgkmcnt(4)
  v_mfma_f32_16x16x32_bf16 v[48:51], a[72:75], v[220:223], v[48:51]
  ds_read_b128 v[204:207], v8 offset:20528
  v_mfma_f32_16x16x32_bf16 v[52:55], a[72:75], v[224:227], v[52:55]
  ds_read_b128 v[208:211], v9 offset:20528
  v_mfma_f32_16x16x32_bf16 v[56:59], a[72:75], v[228:231], v[56:59]
  ds_read_b128 v[212:215], v10 offset:20528
  v_mfma_f32_16x16x32_bf16 v[60:63], a[72:75], v[232:235], v[60:63]
  ds_read_b128 v[216:219], v11 offset:20528
  s_add_u32 m0, s73, 61952
  s_nop 0
  buffer_load_dwordx4 v2, s[4:7], s72 offen offset:2048 sc1 lds
  s_waitcnt lgkmcnt(4)
  v_mfma_f32_16x16x32_bf16 v[48:51], a[76:79], v[188:191], v[48:51]
  ds_read_b128 v[220:223], v8 offset:25648
  v_mfma_f32_16x16x32_bf16 v[52:55], a[76:79], v[192:195], v[52:55]
  ds_read_b128 v[224:227], v9 offset:25648
  v_mfma_f32_16x16x32_bf16 v[56:59], a[76:79], v[196:199], v[56:59]
  ds_read_b128 v[228:231], v10 offset:25648
  v_mfma_f32_16x16x32_bf16 v[60:63], a[76:79], v[200:203], v[60:63]
  ds_read_b128 v[232:235], v11 offset:25648
  s_add_u32 m0, s73, 62208
  s_nop 0
  buffer_load_dwordx4 v2, s[4:7], s72 offen offset:3072 sc1 lds
  s_waitcnt lgkmcnt(4)
  v_mfma_f32_16x16x32_bf16 v[48:51], a[80:83], v[204:207], v[48:51]
  ds_read_b128 v[188:191], v8 offset:30768
  v_mfma_f32_16x16x32_bf16 v[52:55], a[80:83], v[208:211], v[52:55]
  ds_read_b128 v[192:195], v9 offset:30768
  v_mfma_f32_16x16x32_bf16 v[56:59], a[80:83], v[212:215], v[56:59]
  ds_read_b128 v[196:199], v10 offset:30768
  v_mfma_f32_16x16x32_bf16 v[60:63], a[80:83], v[216:219], v[60:63]
  ds_read_b128 v[200:203], v11 offset:30768
  buffer_load_dwordx4 a[232:235], v2, s[4:7], s25 offen offset:2048
  s_waitcnt lgkmcnt(4)
  v_mfma_f32_16x16x32_bf16 v[48:51], a[84:87], v[220:223], v[48:51]
  ds_read_b128 v[204:207], v8 offset:35888
  v_mfma_f32_16x16x32_bf16 v[52:55], a[84:87], v[224:227], v[52:55]
  ds_read_b128 v[208:211], v9 offset:35888
  v_mfma_f32_16x16x32_bf16 v[56:59], a[84:87], v[228:231], v[56:59]
  ds_read_b128 v[212:215], v10 offset:35888
  v_mfma_f32_16x16x32_bf16 v[60:63], a[84:87], v[232:235], v[60:63]
  ds_read_b128 v[216:219], v11 offset:35888
  buffer_load_dwordx4 a[236:239], v2, s[4:7], s25 offen offset:3072
  v_add_u32 v8, 40960, v8
  v_add_u32 v9, 40960, v9
  v_add_u32 v10, 40960, v10
  v_add_u32 v11, 40960, v11
  s_waitcnt vmcnt(7)
  s_barrier
  s_waitcnt lgkmcnt(4)
  v_mfma_f32_16x16x32_bf16 v[48:51], a[88:91], v[188:191], v[48:51]
  ds_read_b128 v[220:223], v8 offset:0
  v_mfma_f32_16x16x32_bf16 v[52:55], a[88:91], v[192:195], v[52:55]
  ds_read_b128 v[224:227], v9 offset:0
  v_mfma_f32_16x16x32_bf16 v[56:59], a[88:91], v[196:199], v[56:59]
  ds_read_b128 v[228:231], v10 offset:0
  v_mfma_f32_16x16x32_bf16 v[60:63], a[88:91], v[200:203], v[60:63]
  ds_read_b128 v[232:235], v11 offset:0
  s_add_u32 s25, s25, 4096
  buffer_load_dwordx4 a[240:243], v2, s[4:7], s25 offen offset:0
  s_waitcnt lgkmcnt(4)
  v_mfma_f32_16x16x32_bf16 v[48:51], a[92:95], v[204:207], v[48:51]
  ds_read_b128 v[188:191], v8 offset:5120
  v_mfma_f32_16x16x32_bf16 v[52:55], a[92:95], v[208:211], v[52:55]
  ds_read_b128 v[192:195], v9 offset:5120
  v_mfma_f32_16x16x32_bf16 v[56:59], a[92:95], v[212:215], v[56:59]
  ds_read_b128 v[196:199], v10 offset:5120
  v_mfma_f32_16x16x32_bf16 v[60:63], a[92:95], v[216:219], v[60:63]
  ds_read_b128 v[200:203], v11 offset:5120
  buffer_load_dwordx4 a[244:247], v2, s[4:7], s25 offen offset:1024
  s_waitcnt lgkmcnt(4)
  v_mfma_f32_16x16x32_bf16 v[48:51], a[96:99], v[220:223], v[48:51]
  ds_read_b128 v[204:207], v8 offset:10240
  v_mfma_f32_16x16x32_bf16 v[52:55], a[96:99], v[224:227], v[52:55]
  ds_read_b128 v[208:211], v9 offset:10240
  v_mfma_f32_16x16x32_bf16 v[56:59], a[96:99], v[228:231], v[56:59]
  ds_read_b128 v[212:215], v10 offset:10240
  v_mfma_f32_16x16x32_bf16 v[60:63], a[96:99], v[232:235], v[60:63]
  ds_read_b128 v[216:219], v11 offset:10240
  buffer_load_dwordx4 a[248:251], v2, s[4:7], s25 offen offset:2048
  s_waitcnt lgkmcnt(4)
  v_mfma_f32_16x16x32_bf16 v[48:51], a[100:103], v[188:191], v[48:51]
  ds_read_b128 v[220:223], v8 offset:15360
  v_mfma_f32_16x16x32_bf16 v[52:55], a[100:103], v[192:195], v[52:55]
  ds_read_b128 v[224:227], v9 offset:15360
  v_mfma_f32_16x16x32_bf16 v[56:59], a[100:103], v[196:199], v[56:59]
  ds_read_b128 v[228:231], v10 offset:15360
  v_mfma_f32_16x16x32_bf16 v[60:63], a[100:103], v[200:203], v[60:63]
  ds_read_b128 v[232:235], v11 offset:15360
  buffer_load_dwordx4 a[252:255], v2, s[4:7], s25 offen offset:3072
  s_waitcnt vmcnt(6)
  s_barrier
  s_waitcnt lgkmcnt(4)
  v_mfma_f32_16x16x32_bf16 v[48:51], a[104:107], v[204:207], v[48:51]
  ds_read_b128 v[188:191], v8 offset:20544
  v_mfma_f32_16x16x32_bf16 v[52:55], a[104:107], v[208:211], v[52:55]
  ds_read_b128 v[192:195], v9 offset:20544
  v_mfma_f32_16x16x32_bf16 v[56:59], a[104:107], v[212:215], v[56:59]
  ds_read_b128 v[196:199], v10 offset:20544
  v_mfma_f32_16x16x32_bf16 v[60:63], a[104:107], v[216:219], v[60:63]
  ds_read_b128 v[200:203], v11 offset:20544
  s_waitcnt lgkmcnt(4)
  v_mfma_f32_16x16x32_bf16 v[48:51], a[108:111], v[220:223], v[48:51]
  ds_read_b128 v[204:207], v8 offset:25664
  v_mfma_f32_16x16x32_bf16 v[52:55], a[108:111], v[224:227], v[52:55]
  ds_read_b128 v[208:211], v9 offset:25664
  v_mfma_f32_16x16x32_bf16 v[56:59], a[108:111], v[228:231], v[56:59]
  ds_read_b128 v[212:215], v10 offset:25664
  v_mfma_f32_16x16x32_bf16 v[60:63], a[108:111], v[232:235], v[60:63]
  ds_read_b128 v[216:219], v11 offset:25664
  s_waitcnt lgkmcnt(4)
  v_mfma_f32_16x16x32_bf16 v[48:51], a[112:115], v[188:191], v[48:51]
  ds_read_b128 v[220:223], v8 offset:30784
  v_mfma_f32_16x16x32_bf16 v[52:55], a[112:115], v[192:195], v[52:55]
  ds_read_b128 v[224:227], v9 offset:30784
  v_mfma_f32_16x16x32_bf16 v[56:59], a[112:115], v[196:199], v[56:59]
  ds_read_b128 v[228:231], v10 offset:30784
  v_mfma_f32_16x16x32_bf16 v[60:63], a[112:115], v[200:203], v[60:63]
  ds_read_b128 v[232:235], v11 offset:30784
  s_waitcnt lgkmcnt(4)
  v_mfma_f32_16x16x32_bf16 v[48:51], a[116:119], v[204:207], v[48:51]
  ds_read_b128 v[188:191], v8 offset:35904
  v_mfma_f32_16x16x32_bf16 v[52:55], a[116:119], v[208:211], v[52:55]
  ds_read_b128 v[192:195], v9 offset:35904
  v_mfma_f32_16x16x32_bf16 v[56:59], a[116:119], v[212:215], v[56:59]
  ds_read_b128 v[196:199], v10 offset:35904
  v_mfma_f32_16x16x32_bf16 v[60:63], a[116:119], v[216:219], v[60:63]
  ds_read_b128 v[200:203], v11 offset:35904
  s_waitcnt lgkmcnt(4)
  v_mfma_f32_16x16x32_bf16 v[48:51], a[120:123], v[220:223], v[48:51]
  v_mfma_f32_16x16x32_bf16 v[52:55], a[120:123], v[224:227], v[52:55]
  v_mfma_f32_16x16x32_bf16 v[56:59], a[120:123], v[228:231], v[56:59]
  v_mfma_f32_16x16x32_bf16 v[60:63], a[120:123], v[232:235], v[60:63]
  s_waitcnt lgkmcnt(0)
  v_mfma_f32_16x16x32_bf16 v[48:51], a[124:127], v[188:191], v[48:51]
  v_mfma_f32_16x16x32_bf16 v[52:55], a[124:127], v[192:195], v[52:55]
  v_mfma_f32_16x16x32_bf16 v[56:59], a[124:127], v[196:199], v[56:59]
  v_mfma_f32_16x16x32_bf16 v[60:63], a[124:127], v[200:203], v[60:63]
  v_subrev_u32 v8, 40960, v8
  v_subrev_u32 v9, 40960, v9
  v_subrev_u32 v10, 40960, v10
  v_subrev_u32 v11, 40960, v11
  s_barrier
  v_cvt_pk_bf16_f32 v176, v48, v49
  v_cvt_pk_bf16_f32 v177, v50, v51
  v_cvt_pk_bf16_f32 v178, v52, v53
  v_cvt_pk_bf16_f32 v179, v54, v55
  v_cvt_pk_bf16_f32 v180, v56, v57
  v_cvt_pk_bf16_f32 v181, v58, v59
  v_cvt_pk_bf16_f32 v182, v60, v61
  v_cvt_pk_bf16_f32 v183, v62, v63
  v_permlane16_swap_b32 v176, v178
  v_permlane16_swap_b32 v177, v179
  v_permlane16_swap_b32 v180, v182
  v_permlane16_swap_b32 v181, v183
  s_add_u32 s26, s3, 0
  s_cmp_eq_u32 s23, 0
  s_cbranch_scc1 XS_56
  buffer_store_dwordx4 v[176:179], v12, s[4:7], s26 offen
  buffer_store_dwordx4 v[180:183], v13, s[4:7], s26 offen
XD_57:
  v_pk_add_f32 v[32:33], v[32:33], v[48:49]
  v_pk_add_f32 v[34:35], v[34:35], v[50:51]
  v_pk_add_f32 v[36:37], v[36:37], v[52:53]
  v_pk_add_f32 v[38:39], v[38:39], v[54:55]
  v_pk_add_f32 v[40:41], v[40:41], v[56:57]
  v_pk_add_f32 v[42:43], v[42:43], v[58:59]
  v_pk_add_f32 v[44:45], v[44:45], v[60:61]
  v_pk_add_f32 v[46:47], v[46:47], v[62:63]
  s_add_u32 s74, s68, 1536
  v_lshlrev_b32 v251, 7, v1
  s_add_u32 s25, s25, 4096
  buffer_load_dwordx4 a[0:3], v2, s[4:7], s25 offen offset:0
  buffer_load_dwordx4 a[4:7], v2, s[4:7], s25 offen offset:1024
  s_waitcnt vmcnt(2)
  s_mov_b64 exec, 15
  s_cmp_eq_u32 s23, 0
  s_cbranch_scc1 XS_58
  buffer_store_dword v254, v251, s[4:7], s74 offen
XD_59:
  s_mov_b64 exec, -1
  s_load_dwordx16 s[80:95], s[76:77], 1536
  s_waitcnt lgkmcnt(0)
  s_and_b64 s[80:81], s[80:81], s[82:83]
  s_and_b64 s[84:85], s[84:85], s[86:87]
  s_and_b64 s[88:89], s[88:89], s[90:91]
  s_and_b64 s[92:93], s[92:93], s[94:95]
  s_and_b64 s[80:81], s[80:81], s[84:85]
  s_and_b64 s[88:89], s[88:89], s[92:93]
  s_and_b64 s[80:81], s[80:81], s[88:89]
  s_and_b32 s96, s80, s81
  s_cmp_eq_u32 s96, 1
  s_cbranch_scc0 SQ_60
SQok_61:
  s_add_u32 s72, s24, 0
  s_lshl_b32 s26, s22, 12
  s_add_u32 s72, s72, s26
  s_mov_b32 s73, s26
  s_add_u32 m0, s73, 0
  s_nop 0
  buffer_load_dwordx4 v2, s[4:7], s72 offen offset:0 sc1 lds
  buffer_load_dwordx4 v2, s[4:7], s72 offen offset:1024 sc1 lds
  buffer_load_dwordx4 v2, s[4:7], s72 offen offset:2048 sc1 lds
  buffer_load_dwordx4 v2, s[4:7], s72 offen offset:3072 sc1 lds
  s_add_u32 s72, s72, 16384
  s_add_u32 m0, s73, 16384
  s_nop 0
  buffer_load_dwordx4 v2, s[4:7], s72 offen offset:0 sc1 lds
  buffer_load_dwordx4 v2, s[4:7], s72 offen offset:1024 sc1 lds
  buffer_load_dwordx4 v2, s[4:7], s72 offen offset:2048 sc1 lds
  buffer_load_dwordx4 v2, s[4:7], s72 offen offset:3072 sc1 lds
  s_add_u32 s72, s72, 16384
  s_add_u32 m0, s73, 32768
  s_nop 0
  buffer_load_dwordx4 v2, s[4:7], s72 offen offset:0 sc1 lds
  buffer_load_dwordx4 v2, s[4:7], s72 offen offset:1024 sc1 lds
  buffer_load_dwordx4 v2, s[4:7], s72 offen offset:2048 sc1 lds
  buffer_load_dwordx4 v2, s[4:7], s72 offen offset:3072 sc1 lds
  s_waitcnt vmcnt(8)
  s_barrier
  ds_read_b128 v[188:191], v4 offset:0
  ds_read_b128 v[192:195], v5 offset:0
  ds_read_b128 v[196:199], v6 offset:0
  ds_read_b128 v[200:203], v7 offset:0
  ds_read_b128 v[204:207], v4 offset:4096
  ds_read_b128 v[208:211], v5 offset:4096
  ds_read_b128 v[212:215], v6 offset:4096
  ds_read_b128 v[216:219], v7 offset:4096
  s_waitcnt lgkmcnt(4)
  v_mfma_f32_16x16x32_bf16 v[104:107], a[128:131], v[188:191], 0
  ds_read_b128 v[220:223], v4 offset:8192
  v_mfma_f32_16x16x32_bf16 v[108:111], a[128:131], v[192:195], 0
  ds_read_b128 v[224:227], v5 offset:8192
  v_mfma_f32_16x16x32_bf16 v[112:115], a[128:131], v[196:199], 0
  ds_read_b128 v[228:231], v6 offset:8192
  v_mfma_f32_16x16x32_bf16 v[116:119], a[128:131], v[200:203], 0
  ds_read_b128 v[232:235], v7 offset:8192
  s_add_u32 s72, s72, 16384
  s_add_u32 m0, s73, 49152
  s_nop 0
  buffer_load_dwordx4 v2, s[4:7], s72 offen offset:0 sc1 lds
  v_mfma_f32_16x16x32_bf16 v[120:123], a[132:135], v[188:191], 0
  v_mfma_f32_16x16x32_bf16 v[124:127], a[132:135], v[192:195], 0
  v_mfma_f32_16x16x32_bf16 v[128:131], a[132:135], v[196:199], 0
  v_mfma_f32_16x16x32_bf16 v[132:135], a[132:135], v[200:203], 0
  buffer_load_dwordx4 v2, s[4:7], s72 offen offset:1024 sc1 lds
  v_mfma_f32_16x16x32_bf16 v[160:163], v[24:27], v[188:191], 0
  v_mfma_f32_16x16x32_bf16 v[164:167], v[188:191], v[188:191], 0
  v_mfma_f32_16x16x32_bf16 v[88:91], a[128:131], v[24:27], 0
  v_mfma_f32_16x16x32_bf16 v[92:95], a[132:135], v[24:27], 0
  buffer_load_dwordx4 v2, s[4:7], s72 offen offset:2048 sc1 lds
  s_waitcnt lgkmcnt(4)
  v_mfma_f32_16x16x32_bf16 v[104:107], a[136:139], v[204:207], v[104:107]
  ds_read_b128 v[188:191], v4 offset:12288
  v_mfma_f32_16x16x32_bf16 v[108:111], a[136:139], v[208:211], v[108:111]
  ds_read_b128 v[192:195], v5 offset:12288
  v_mfma_f32_16x16x32_bf16 v[112:115], a[136:139], v[212:215], v[112:115]
  ds_read_b128 v[196:199], v6 offset:12288
  v_mfma_f32_16x16x32_bf16 v[116:119], a[136:139], v[216:219], v[116:119]
  ds_read_b128 v[200:203], v7 offset:12288
  buffer_load_dwordx4 v2, s[4:7], s72 offen offset:3072 sc1 lds
  v_mfma_f32_16x16x32_bf16 v[120:123], a[140:143], v[204:207], v[120:123]
  v_mfma_f32_16x16x32_bf16 v[124:127], a[140:143], v[208:211], v[124:127]
  v_mfma_f32_16x16x32_bf16 v[128:131], a[140:143], v[212:215], v[128:131]
  v_mfma_f32_16x16x32_bf16 v[132:135], a[140:143], v[216:219], v[132:135]
  buffer_load_dwordx4 a[8:11], v2, s[4:7], s25 offen offset:2048
  v_mfma_f32_16x16x32_bf16 v[160:163], v[24:27], v[204:207], v[160:163]
  v_mfma_f32_16x16x32_bf16 v[164:167], v[204:207], v[204:207], v[164:167]
  v_mfma_f32_16x16x32_bf16 v[88:91], a[136:139], v[24:27], v[88:91]
  v_mfma_f32_16x16x32_bf16 v[92:95], a[140:143], v[24:27], v[92:95]
  buffer_load_dwordx4 a[12:15], v2, s[4:7], s25 offen offset:3072
  s_waitcnt vmcnt(10)
  s_barrier
  s_waitcnt lgkmcnt(4)
  v_mfma_f32_16x16x32_bf16 v[104:107], a[144:147], v[220:223], v[104:107]
  ds_read_b128 v[204:207], v4 offset:16384
  v_mfma_f32_16x16x32_bf16 v[108:111], a[144:147], v[224:227], v[108:111]
  ds_read_b128 v[208:211], v5 offset:16384
  v_mfma_f32_16x16x32_bf16 v[112:115], a[144:147], v[228:231], v[112:115]
  ds_read_b128 v[212:215], v6 offset:16384
  v_mfma_f32_16x16x32_bf16 v[116:119], a[144:147], v[232:235], v[116:119]
  ds_read_b128 v[216:219], v7 offset:16384
  s_add_u32 s25, s25, 4096
  buffer_load_dwordx4 a[16:19], v2, s[4:7], s25 offen offset:0
  v_mfma_f32_16x16x32_bf16 v[120:123], a[148:151], v[220:223], v[120:123]
  v_mfma_f32_16x16x32_bf16 v[124:127], a[148:151], v[224:227], v[124:127]
  v_mfma_f32_16x16x32_bf16 v[128:131], a[148:151], v[228:231], v[128:131]
  v_mfma_f32_16x16x32_bf16 v[132:135], a[148:151], v[232:235], v[132:135]
  buffer_load_dwordx4 a[20:23], v2, s[4:7], s25 offen offset:1024
  v_mfma_f32_16x16x32_bf16 v[160:163], v[24:27], v[220:223], v[160:163]
  v_mfma_f32_16x16x32_bf16 v[164:167], v[220:223], v[220:223], v[164:167]
  v_mfma_f32_16x16x32_bf16 v[88:91], a[144:147], v[24:27], v[88:91]
  v_mfma_f32_16x16x32_bf16 v[92:95], a[148:151], v[24:27], v[92:95]
  buffer_load_dwordx4 a[24:27], v2, s[4:7], s25 offen offset:2048
  s_waitcnt lgkmcnt(4)
  v_mfma_f32_16x16x32_bf16 v[104:107], a[152:155], v[188:191], v[104:107]
  ds_read_b128 v[220:223], v4 offset:20480
  v_mfma_f32_16x16x32_bf16 v[108:111], a[152:155], v[192:195], v[108:111]
  ds_read_b128 v[224:227], v5 offset:20480
  v_mfma_f32_16x16x32_bf16 v[112:115], a[152:155], v[196:199], v[112:115]
  ds_read_b128 v[228:231], v6 offset:20480
  v_mfma_f32_16x16x32_bf16 v[116:119], a[152:155], v[200:203], v[116:119]
  ds_read_b128 v[232:235], v7 offset:20480
  buffer_load_dwordx4 a[28:31], v2, s[4:7], s25 offen offset:3072
  v_mfma_f32_16x16x32_bf16 v[120:123], a[156:159], v[188:191], v[120:123]
  v_mfma_f32_16x16x32_bf16 v[124:127], a[156:159], v[192:195], v[124:127]
  v_mfma_f32_16x16x32_bf16 v[128:131], a[156:159], v[196:199], v[128:131]
  v_mfma_f32_16x16x32_bf16 v[132:135], a[156:159], v[200:203], v[132:135]
  s_add_u32 s25, s25, 4096
  buffer_load_dwordx4 a[32:35], v2, s[4:7], s25 offen offset:0
  v_mfma_f32_16x16x32_bf16 v[160:163], v[24:27], v[188:191], v[160:163]
  v_mfma_f32_16x16x32_bf16 v[164:167], v[188:191], v[188:191], v[164:167]
  v_mfma_f32_16x16x32_bf16 v[88:91], a[152:155], v[24:27], v[88:91]
  v_mfma_f32_16x16x32_bf16 v[92:95], a[156:159], v[24:27], v[92:95]
  buffer_load_dwordx4 a[36:39], v2, s[4:7], s25 offen offset:1024
  s_waitcnt lgkmcnt(4)
  v_mfma_f32_16x16x32_bf16 v[104:107], a[160:163], v[204:207], v[104:107]
  ds_read_b128 v[188:191], v4 offset:24576
  v_mfma_f32_16x16x32_bf16 v[108:111], a[160:163], v[208:211], v[108:111]
  ds_read_b128 v[192:195], v5 offset:24576
  v_mfma_f32_16x16x32_bf16 v[112:115], a[160:163], v[212:215], v[112:115]
  ds_read_b128 v[196:199], v6 offset:24576
  v_mfma_f32_16x16x32_bf16 v[116:119], a[160:163], v[216:219], v[116:119]
  ds_read_b128 v[200:203], v7 offset:24576
  buffer_load_dwordx4 a[40:43], v2, s[4:7], s25 offen offset:2048
  v_mfma_f32_16x16x32_bf16 v[120:123], a[164:167], v[204:207], v[120:123]
  v_mfma_f32_16x16x32_bf16 v[124:127], a[164:167], v[208:211], v[124:127]
  v_mfma_f32_16x16x32_bf16 v[128:131], a[164:167], v[212:215], v[128:131]
  v_mfma_f32_16x16x32_bf16 v[132:135], a[164:167], v[216:219], v[132:135]
  buffer_load_dwordx4 a[44:47], v2, s[4:7], s25 offen offset:3072
  v_mfma_f32_16x16x32_bf16 v[160:163], v[24:27], v[204:207], v[160:163]
  v_mfma_f32_16x16x32_bf16 v[164:167], v[204:207], v[204:207], v[164:167]
  v_mfma_f32_16x16x32_bf16 v[88:91], a[160:163], v[24:27], v[88:91]
  v_mfma_f32_16x16x32_bf16 v[92:95], a[164:167], v[24:27], v[92:95]
  s_add_u32 s25, s25, 4096
  buffer_load_dwordx4 a[48:51], v2, s[4:7], s25 offen offset:0
  s_waitcnt lgkmcnt(4)
  v_mfma_f32_16x16x32_bf16 v[104:107], a[168:171], v[220:223], v[104:107]
  ds_read_b128 v[204:207], v4 offset:28672
  v_mfma_f32_16x16x32_bf16 v[108:111], a[168:171], v[224:227], v[108:111]
  ds_read_b128 v[208:211], v5 offset:28672
  v_mfma_f32_16x16x32_bf16 v[112:115], a[168:171], v[228:231], v[112:115]
  ds_read_b128 v[212:215], v6 offset:28672
  v_mfma_f32_16x16x32_bf16 v[116:119], a[168:171], v[232:235], v[116:119]
  ds_read_b128 v[216:219], v7 offset:28672
  buffer_load_dwordx4 a[52:55], v2, s[4:7], s25 offen offset:1024
  v_mfma_f32_16x16x32_bf16 v[120:123], a[172:175], v[220:223], v[120:123]
  v_mfma_f32_16x16x32_bf16 v[124:127], a[172:175], v[224:227], v[124:127]
  v_mfma_f32_16x16x32_bf16 v[128:131], a[172:175], v[228:231], v[128:131]
  v_mfma_f32_16x16x32_bf16 v[132:135], a[172:175], v[232:235], v[132:135]
  buffer_load_dwordx4 a[56:59], v2, s[4:7], s25 offen offset:2048
  v_mfma_f32_16x16x32_bf16 v[160:163], v[24:27], v[220:223], v[160:163]
  v_mfma_f32_16x16x32_bf16 v[164:167], v[220:223], v[220:223], v[164:167]
  v_mfma_f32_16x16x32_bf16 v[88:91], a[168:171], v[24:27], v[88:91]
  v_mfma_f32_16x16x32_bf16 v[92:95], a[172:175], v[24:27], v[92:95]
  buffer_load_dwordx4 a[60:63], v2, s[4:7], s25 offen offset:3072
  s_waitcnt vmcnt(18)
  s_barrier
  s_waitcnt lgkmcnt(4)
  v_mfma_f32_16x16x32_bf16 v[104:107], a[176:179], v[188:191], v[104:107]
  ds_read_b128 v[220:223], v4 offset:32768
  v_mfma_f32_16x16x32_bf16 v[108:111], a[176:179], v[192:195], v[108:111]
  ds_read_b128 v[224:227], v5 offset:32768
  v_mfma_f32_16x16x32_bf16 v[112:115], a[176:179], v[196:199], v[112:115]
  ds_read_b128 v[228:231], v6 offset:32768
  v_mfma_f32_16x16x32_bf16 v[116:119], a[176:179], v[200:203], v[116:119]
  ds_read_b128 v[232:235], v7 offset:32768
  s_add_u32 s25, s25, 4096
  buffer_load_dwordx4 a[64:67], v2, s[4:7], s25 offen offset:0
  v_mfma_f32_16x16x32_bf16 v[120:123], a[180:183], v[188:191], v[120:123]
  v_mfma_f32_16x16x32_bf16 v[124:127], a[180:183], v[192:195], v[124:127]
  v_mfma_f32_16x16x32_bf16 v[128:131], a[180:183], v[196:199], v[128:131]
  v_mfma_f32_16x16x32_bf16 v[132:135], a[180:183], v[200:203], v[132:135]
  buffer_load_dwordx4 a[68:71], v2, s[4:7], s25 offen offset:1024
  v_mfma_f32_16x16x32_bf16 v[160:163], v[24:27], v[188:191], v[160:163]
  v_mfma_f32_16x16x32_bf16 v[164:167], v[188:191], v[188:191], v[164:167]
  v_mfma_f32_16x16x32_bf16 v[88:91], a[176:179], v[24:27], v[88:91]
  v_mfma_f32_16x16x32_bf16 v[92:95], a[180:183], v[24:27], v[92:95]
  buffer_load_dwordx4 a[72:75], v2, s[4:7], s25 offen offset:2048
  s_waitcnt lgkmcnt(4)
  v_mfma_f32_16x16x32_bf16 v[104:107], a[184:187], v[204:207], v[104:107]
  ds_read_b128 v[188:191], v4 offset:36864
  v_mfma_f32_16x16x32_bf16 v[108:111], a[184:187], v[208:211], v[108:111]
  ds_read_b128 v[192:195], v5 offset:36864
  v_mfma_f32_16x16x32_bf16 v[112:115], a[184:187], v[212:215], v[112:115]
  ds_read_b128 v[196:199], v6 offset:36864
  v_mfma_f32_16x16x32_bf16 v[116:119], a[184:187], v[216:219], v[116:119]
  ds_read_b128 v[200:203], v7 offset:36864
  buffer_load_dwordx4 a[76:79], v2, s[4:7], s25 offen offset:3072
  v_mfma_f32_16x16x32_bf16 v[120:123], a[188:191], v[204:207], v[120:123]
  v_mfma_f32_16x16x32_bf16 v[124:127], a[188:191], v[208:211], v[124:127]
  v_mfma_f32_16x16x32_bf16 v[128:131], a[188:191], v[212:215], v[128:131]
  v_mfma_f32_16x16x32_bf16 v[132:135], a[188:191], v[216:219], v[132:135]
  s_add_u32 s25, s25, 4096
  buffer_load_dwordx4 a[80:83], v2, s[4:7], s25 offen offset:0
  v_mfma_f32_16x16x32_bf16 v[160:163], v[24:27], v[204:207], v[160:163]
  v_mfma_f32_16x16x32_bf16 v[164:167], v[204:207], v[204:207], v[164:167]
  v_mfma_f32_16x16x32_bf16 v[88:91], a[184:187], v[24:27], v[88:91]
  v_mfma_f32_16x16x32_bf16 v[92:95], a[188:191], v[24:27], v[92:95]
  buffer_load_dwordx4 a[84:87], v2, s[4:7], s25 offen offset:1024
  s_waitcnt lgkmcnt(4)
  v_mfma_f32_16x16x32_bf16 v[104:107], a[192:195], v[220:223], v[104:107]
  ds_read_b128 v[204:207], v4 offset:40960
  v_mfma_f32_16x16x32_bf16 v[108:111], a[192:195], v[224:227], v[108:111]
  ds_read_b128 v[208:211], v5 offset:40960
  v_mfma_f32_16x16x32_bf16 v[112:115], a[192:195], v[228:231], v[112:115]
  ds_read_b128 v[212:215], v6 offset:40960
  v_mfma_f32_16x16x32_bf16 v[116:119], a[192:195], v[232:235], v[116:119]
  ds_read_b128 v[216:219], v7 offset:40960
  buffer_load_dwordx4 a[88:91], v2, s[4:7], s25 offen offset:2048
  v_mfma_f32_16x16x32_bf16 v[120:123], a[196:199], v[220:223], v[120:123]
  v_mfma_f32_16x16x32_bf16 v[124:127], a[196:199], v[224:227], v[124:127]
  v_mfma_f32_16x16x32_bf16 v[128:131], a[196:199], v[228:231], v[128:131]
  v_mfma_f32_16x16x32_bf16 v[132:135], a[196:199], v[232:235], v[132:135]
  buffer_load_dwordx4 a[92:95], v2, s[4:7], s25 offen offset:3072
  v_mfma_f32_16x16x32_bf16 v[160:163], v[24:27], v[220:223], v[160:163]
  v_mfma_f32_16x16x32_bf16 v[164:167], v[220:223], v[220:223], v[164:167]
  v_mfma_f32_16x16x32_bf16 v[88:91], a[192:195], v[24:27], v[88:91]
  v_mfma_f32_16x16x32_bf16 v[92:95], a[196:199], v[24:27], v[92:95]
  s_add_u32 s25, s25, 4096
  buffer_load_dwordx4 a[96:99], v2, s[4:7], s25 offen offset:0
  s_waitcnt lgkmcnt(4)
  v_mfma_f32_16x16x32_bf16 v[104:107], a[200:203], v[188:191], v[104:107]
  ds_read_b128 v[220:223], v4 offset:45056
  v_mfma_f32_16x16x32_bf16 v[108:111], a[200:203], v[192:195], v[108:111]
  ds_read_b128 v[224:227], v5 offset:45056
  v_mfma_f32_16x16x32_bf16 v[112:115], a[200:203], v[196:199], v[112:115]
  ds_read_b128 v[228:231], v6 offset:45056
  v_mfma_f32_16x16x32_bf16 v[116:119], a[200:203], v[200:203], v[116:119]
  ds_read_b128 v[232:235], v7 offset:45056
  buffer_load_dwordx4 a[100:103], v2, s[4:7], s25 offen offset:1024
  v_mfma_f32_16x16x32_bf16 v[120:123], a[204:207], v[188:191], v[120:123]
  v_mfma_f32_16x16x32_bf16 v[124:127], a[204:207], v[192:195], v[124:127]
  v_mfma_f32_16x16x32_bf16 v[128:131], a[204:207], v[196:199], v[128:131]
  v_mfma_f32_16x16x32_bf16 v[132:135], a[204:207], v[200:203], v[132:135]
  buffer_load_dwordx4 a[104:107], v2, s[4:7], s25 offen offset:2048
  v_mfma_f32_16x16x32_bf16 v[160:163], v[24:27], v[188:191], v[160:163]
  v_mfma_f32_16x16x32_bf16 v[164:167], v[188:191], v[188:191], v[164:167]
  v_mfma_f32_16x16x32_bf16 v[88:91], a[200:203], v[24:27], v[88:91]
  v_mfma_f32_16x16x32_bf16 v[92:95], a[204:207], v[24:27], v[92:95]
  buffer_load_dwordx4 a[108:111], v2, s[4:7], s25 offen offset:3072
  s_waitcnt vmcnt(26)
  s_barrier
  s_waitcnt lgkmcnt(4)
  v_mfma_f32_16x16x32_bf16 v[104:107], a[208:211], v[204:207], v[104:107]
  ds_read_b128 v[188:191], v4 offset:49152
  v_mfma_f32_16x16x32_bf16 v[108:111], a[208:211], v[208:211], v[108:111]
  ds_read_b128 v[192:195], v5 offset:49152
  v_mfma_f32_16x16x32_bf16 v[112:115], a[208:211], v[212:215], v[112:115]
  ds_read_b128 v[196:199], v6 offset:49152
  v_mfma_f32_16x16x32_bf16 v[116:119], a[208:211], v[216:219], v[116:119]
  ds_read_b128 v[200:203], v7 offset:49152
  s_add_u32 s25, s25, 4096
  buffer_load_dwordx4 a[112:115], v2, s[4:7], s25 offen offset:0
  v_mfma_f32_16x16x32_bf16 v[120:123], a[212:215], v[204:207], v[120:123]
  v_mfma_f32_16x16x32_bf16 v[124:127], a[212:215], v[208:211], v[124:127]
  v_mfma_f32_16x16x32_bf16 v[128:131], a[212:215], v[212:215], v[128:131]
  v_mfma_f32_16x16x32_bf16 v[132:135], a[212:215], v[216:219], v[132:135]
  buffer_load_dwordx4 a[116:119], v2, s[4:7], s25 offen offset:1024
  v_mfma_f32_16x16x32_bf16 v[160:163], v[24:27], v[204:207], v[160:163]
  v_mfma_f32_16x16x32_bf16 v[164:167], v[204:207], v[204:207], v[164:167]
  v_mfma_f32_16x16x32_bf16 v[88:91], a[208:211], v[24:27], v[88:91]
  v_mfma_f32_16x16x32_bf16 v[92:95], a[212:215], v[24:27], v[92:95]
  buffer_load_dwordx4 a[120:123], v2, s[4:7], s25 offen offset:2048
  s_waitcnt lgkmcnt(4)
  v_mfma_f32_16x16x32_bf16 v[104:107], a[216:219], v[220:223], v[104:107]
  ds_read_b128 v[204:207], v4 offset:53248
  v_mfma_f32_16x16x32_bf16 v[108:111], a[216:219], v[224:227], v[108:111]
  ds_read_b128 v[208:211], v5 offset:53248
  v_mfma_f32_16x16x32_bf16 v[112:115], a[216:219], v[228:231], v[112:115]
  ds_read_b128 v[212:215], v6 offset:53248
  v_mfma_f32_16x16x32_bf16 v[116:119], a[216:219], v[232:235], v[116:119]
  ds_read_b128 v[216:219], v7 offset:53248
  buffer_load_dwordx4 a[124:127], v2, s[4:7], s25 offen offset:3072
  v_mfma_f32_16x16x32_bf16 v[120:123], a[220:223], v[220:223], v[120:123]
  v_mfma_f32_16x16x32_bf16 v[124:127], a[220:223], v[224:227], v[124:127]
  v_mfma_f32_16x16x32_bf16 v[128:131], a[220:223], v[228:231], v[128:131]
  v_mfma_f32_16x16x32_bf16 v[132:135], a[220:223], v[232:235], v[132:135]
  s_add_u32 s25, s25, 4096
  buffer_load_dwordx4 a[128:131], v2, s[4:7], s25 offen offset:0
  v_mfma_f32_16x16x32_bf16 v[160:163], v[24:27], v[220:223], v[160:163]
  v_mfma_f32_16x16x32_bf16 v[164:167], v[220:223], v[220:223], v[164:167]
  v_mfma_f32_16x16x32_bf16 v[88:91], a[216:219], v[24:27], v[88:91]
  v_mfma_f32_16x16x32_bf16 v[92:95], a[220:223], v[24:27], v[92:95]
  buffer_load_dwordx4 a[132:135], v2, s[4:7], s25 offen offset:1024
  s_waitcnt lgkmcnt(4)
  v_mfma_f32_16x16x32_bf16 v[104:107], a[224:227], v[188:191], v[104:107]
  ds_read_b128 v[220:223], v4 offset:57344
  v_mfma_f32_16x16x32_bf16 v[108:111], a[224:227], v[192:195], v[108:111]
  ds_read_b128 v[224:227], v5 offset:57344
  v_mfma_f32_16x16x32_bf16 v[112:115], a[224:227], v[196:199], v[112:115]
  ds_read_b128 v[228:231], v6 offset:57344
  v_mfma_f32_16x16x32_bf16 v[116:119], a[224:227], v[200:203], v[116:119]
  ds_read_b128 v[232:235], v7 offset:57344
  buffer_load_dwordx4 a[136:139], v2, s[4:7], s25 offen offset:2048
  v_mfma_f32_16x16x32_bf16 v[120:123], a[228:231], v[188:191], v[120:123]
  v_mfma_f32_16x16x32_bf16 v[124:127], a[228:231], v[192:195], v[124:127]
  v_mfma_f32_16x16x32_bf16 v[128:131], a[228:231], v[196:199], v[128:131]
  v_mfma_f32_16x16x32_bf16 v[132:135], a[228:231], v[200:203], v[132:135]
  buffer_load_dwordx4 a[140:143], v2, s[4:7], s25 offen offset:3072
  v_mfma_f32_16x16x32_bf16 v[160:163], v[24:27], v[188:191], v[160:163]
  v_mfma_f32_16x16x32_bf16 v[164:167], v[188:191], v[188:191], v[164:167]
  v_mfma_f32_16x16x32_bf16 v[88:91], a[224:227], v[24:27], v[88:91]
  v_mfma_f32_16x16x32_bf16 v[92:95], a[228:231], v[24:27], v[92:95]
  s_add_u32 s25, s25, 4096
  buffer_load_dwordx4 a[144:147], v2, s[4:7], s25 offen offset:0
  s_waitcnt lgkmcnt(4)
  v_mfma_f32_16x16x32_bf16 v[104:107], a[232:235], v[204:207], v[104:107]
  ds_read_b128 v[188:191], v4 offset:61440
  v_mfma_f32_16x16x32_bf16 v[108:111], a[232:235], v[208:211], v[108:111]
  ds_read_b128 v[192:195], v5 offset:61440
  v_mfma_f32_16x16x32_bf16 v[112:115], a[232:235], v[212:215], v[112:115]
  ds_read_b128 v[196:199], v6 offset:61440
  v_mfma_f32_16x16x32_bf16 v[116:119], a[232:235], v[216:219], v[116:119]
  ds_read_b128 v[200:203], v7 offset:61440
  buffer_load_dwordx4 a[148:151], v2, s[4:7], s25 offen offset:1024
  v_mfma_f32_16x16x32_bf16 v[120:123], a[236:239], v[204:207], v[120:123]
  v_mfma_f32_16x16x32_bf16 v[124:127], a[236:239], v[208:211], v[124:127]
  v_mfma_f32_16x16x32_bf16 v[128:131], a[236:239], v[212:215], v[128:131]
  v_mfma_f32_16x16x32_bf16 v[132:135], a[236:239], v[216:219], v[132:135]
  buffer_load_dwordx4 a[152:155], v2, s[4:7], s25 offen offset:2048
  v_mfma_f32_16x16x32_bf16 v[160:163], v[24:27], v[204:207], v[160:163]
  v_mfma_f32_16x16x32_bf16 v[164:167], v[204:207], v[204:207], v[164:167]
  v_mfma_f32_16x16x32_bf16 v[88:91], a[232:235], v[24:27], v[88:91]
  v_mfma_f32_16x16x32_bf16 v[92:95], a[236:239], v[24:27], v[92:95]
  buffer_load_dwordx4 a[156:159], v2, s[4:7], s25 offen offset:3072
  s_waitcnt lgkmcnt(4)
  v_mfma_f32_16x16x32_bf16 v[104:107], a[240:243], v[220:223], v[104:107]
  v_mfma_f32_16x16x32_bf16 v[108:111], a[240:243], v[224:227], v[108:111]
  v_mfma_f32_16x16x32_bf16 v[112:115], a[240:243], v[228:231], v[112:115]
  v_mfma_f32_16x16x32_bf16 v[116:119], a[240:243], v[232:235], v[116:119]
  s_add_u32 s25, s25, 4096
  buffer_load_dwordx4 a[160:163], v2, s[4:7], s25 offen offset:0
  v_mfma_f32_16x16x32_bf16 v[120:123], a[244:247], v[220:223], v[120:123]
  v_mfma_f32_16x16x32_bf16 v[124:127], a[244:247], v[224:227], v[124:127]
  v_mfma_f32_16x16x32_bf16 v[128:131], a[244:247], v[228:231], v[128:131]
  v_mfma_f32_16x16x32_bf16 v[132:135], a[244:247], v[232:235], v[132:135]
  buffer_load_dwordx4 a[164:167], v2, s[4:7], s25 offen offset:1024
  v_mfma_f32_16x16x32_bf16 v[160:163], v[24:27], v[220:223], v[160:163]
  v_mfma_f32_16x16x32_bf16 v[164:167], v[220:223], v[220:223], v[164:167]
  v_mfma_f32_16x16x32_bf16 v[88:91], a[240:243], v[24:27], v[88:91]
  v_mfma_f32_16x16x32_bf16 v[92:95], a[244:247], v[24:27], v[92:95]
  buffer_load_dwordx4 a[168:171], v2, s[4:7], s25 offen offset:2048
  s_waitcnt lgkmcnt(0)
  v_mfma_f32_16x16x32_bf16 v[104:107], a[248:251], v[188:191], v[104:107]
  v_mfma_f32_16x16x32_bf16 v[108:111], a[248:251], v[192:195], v[108:111]
  v_mfma_f32_16x16x32_bf16 v[112:115], a[248:251], v[196:199], v[112:115]
  v_mfma_f32_16x16x32_bf16 v[116:119], a[248:251], v[200:203], v[116:119]
  buffer_load_dwordx4 a[172:175], v2, s[4:7], s25 offen offset:3072
  v_mfma_f32_16x16x32_bf16 v[120:123], a[252:255], v[188:191], v[120:123]
  v_mfma_f32_16x16x32_bf16 v[124:127], a[252:255], v[192:195], v[124:127]
  v_mfma_f32_16x16x32_bf16 v[128:131], a[252:255], v[196:199], v[128:131]
  v_mfma_f32_16x16x32_bf16 v[132:135], a[252:255], v[200:203], v[132:135]
  s_add_u32 s25, s25, 4096
  buffer_load_dwordx4 a[176:179], v2, s[4:7], s25 offen offset:0
  v_mfma_f32_16x16x32_bf16 v[160:163], v[24:27], v[188:191], v[160:163]
  v_mfma_f32_16x16x32_bf16 v[164:167], v[188:191], v[188:191], v[164:167]
  v_mfma_f32_16x16x32_bf16 v[88:91], a[248:251], v[24:27], v[88:91]
  v_mfma_f32_16x16x32_bf16 v[92:95], a[252:255], v[24:27], v[92:95]
  buffer_load_dwordx4 a[180:183], v2, s[4:7], s25 offen offset:1024
  s_nop 4
  v_cndmask_b32_e64 v224, v164, v165, s[40:41]
  v_mul_f32 v225, s60, v160
  v_cndmask_b32_e64 v224, v224, v166, s[42:43]
  v_cndmask_b32_e64 v224, v224, v167, s[44:45]
  v_mul_f32 v224, s60, v224
  v_fma_f32 v224, -v225, v225, v224
  v_max_f32 v224, 0, v224
  v_add_f32 v226, s61, v224
  v_rsq_f32 v230, v226
  v_subrev_u32 v232, 131072, v14
  v_mul_f32 v231, v230, v225
  v_lshrrev_b32 v232, 2, v232
  v_add_u32 v232, 132096, v232
  v_mov_b32 v228, v230
  v_mov_b32 v229, v231
  s_mov_b64 exec, s[46:47]
  ds_write_b128 v14, v[228:231]
  s_mov_b64 exec, -1
  s_waitcnt lgkmcnt(0)
  s_barrier
  ds_read_b128 v[200:203], v14
  ds_read_b128 v[204:207], v15
  ds_read_b128 v[208:211], v16
  ds_read_b128 v[212:215], v17
  s_waitcnt lgkmcnt(0)
  v_pk_mul_f32 v[224:225], v[88:89], v[200:201] op_sel:[0,1] op_sel_hi:[1,1]
  v_pk_mul_f32 v[226:227], v[90:91], v[200:201] op_sel:[0,1] op_sel_hi:[1,1]
  v_pk_mul_f32 v[228:229], v[88:89], v[204:205] op_sel:[0,1] op_sel_hi:[1,1]
  v_pk_mul_f32 v[230:231], v[90:91], v[204:205] op_sel:[0,1] op_sel_hi:[1,1]
  v_pk_fma_f32 v[104:105], v[104:105], v[200:201], v[224:225] op_sel_hi:[1,0,1] neg_lo:[0,0,1] neg_hi:[0,0,1]
  v_pk_fma_f32 v[106:107], v[106:107], v[200:201], v[226:227] op_sel_hi:[1,0,1] neg_lo:[0,0,1] neg_hi:[0,0,1]
  v_pk_fma_f32 v[108:109], v[108:109], v[204:205], v[228:229] op_sel_hi:[1,0,1] neg_lo:[0,0,1] neg_hi:[0,0,1]
  v_pk_fma_f32 v[110:111], v[110:111], v[204:205], v[230:231] op_sel_hi:[1,0,1] neg_lo:[0,0,1] neg_hi:[0,0,1]
  v_pk_mul_f32 v[224:225], v[88:89], v[208:209] op_sel:[0,1] op_sel_hi:[1,1]
  v_pk_mul_f32 v[226:227], v[90:91], v[208:209] op_sel:[0,1] op_sel_hi:[1,1]
  v_pk_mul_f32 v[228:229], v[88:89], v[212:213] op_sel:[0,1] op_sel_hi:[1,1]
  v_pk_mul_f32 v[230:231], v[90:91], v[212:213] op_sel:[0,1] op_sel_hi:[1,1]
  v_pk_fma_f32 v[112:113], v[112:113], v[208:209], v[224:225] op_sel_hi:[1,0,1] neg_lo:[0,0,1] neg_hi:[0,0,1]
  v_pk_fma_f32 v[114:115], v[114:115], v[208:209], v[226:227] op_sel_hi:[1,0,1] neg_lo:[0,0,1] neg_hi:[0,0,1]
  buffer_load_dwordx4 a[184:187], v2, s[4:7], s25 offen offset:2048
  v_pk_fma_f32 v[116:117], v[116:117], v[212:213], v[228:229] op_sel_hi:[1,0,1] neg_lo:[0,0,1] neg_hi:[0,0,1]
  v_pk_fma_f32 v[118:119], v[118:119], v[212:213], v[230:231] op_sel_hi:[1,0,1] neg_lo:[0,0,1] neg_hi:[0,0,1]
  v_pk_mul_f32 v[224:225], v[104:105], v[104:105]
  v_pk_mul_f32 v[226:227], v[106:107], v[106:107]
  v_pk_mul_f32 v[228:229], v[108:109], v[108:109]
  v_pk_mul_f32 v[230:231], v[110:111], v[110:111]
  v_pk_fma_f32 v[224:225], v[224:225], v[28:29], v[28:29] op_sel:[0,1,0] op_sel_hi:[1,1,0]
  v_pk_fma_f32 v[226:227], v[226:227], v[28:29], v[28:29] op_sel:[0,1,0] op_sel_hi:[1,1,0]
  v_pk_fma_f32 v[228:229], v[228:229], v[28:29], v[28:29] op_sel:[0,1,0] op_sel_hi:[1,1,0]
  v_pk_fma_f32 v[230:231], v[230:231], v[28:29], v[28:29] op_sel:[0,1,0] op_sel_hi:[1,1,0]
  v_pk_mul_f32 v[224:225], v[224:225], v[104:105]
  v_pk_mul_f32 v[226:227], v[226:227], v[106:107]
  v_pk_mul_f32 v[228:229], v[228:229], v[108:109]
  v_pk_mul_f32 v[230:231], v[230:231], v[110:111]
  buffer_load_dwordx4 a[188:191], v2, s[4:7], s25 offen offset:3072
  v_exp_f32 v224, v224
  v_exp_f32 v225, v225
  v_exp_f32 v226, v226
  v_exp_f32 v227, v227
  v_exp_f32 v228, v228
  v_exp_f32 v229, v229
  v_exp_f32 v230, v230
  v_exp_f32 v231, v231
  s_add_u32 s25, s25, 4096
  buffer_load_dwordx4 a[192:195], v2, s[4:7], s25 offen offset:0
  v_pk_add_f32 v[224:225], v[224:225], 1.0 op_sel_hi:[1,0]
  v_pk_add_f32 v[226:227], v[226:227], 1.0 op_sel_hi:[1,0]
  v_pk_add_f32 v[228:229], v[228:229], 1.0 op_sel_hi:[1,0]
  v_pk_add_f32 v[230:231], v[230:231], 1.0 op_sel_hi:[1,0]
  v_rcp_f32 v224, v224
  v_rcp_f32 v225, v225
  v_rcp_f32 v226, v226
  v_rcp_f32 v227, v227
  v_rcp_f32 v228, v228
  v_rcp_f32 v229, v229
  buffer_load_dwordx4 a[196:199], v2, s[4:7], s25 offen offset:1024
  v_rcp_f32 v230, v230
  v_rcp_f32 v231, v231
  v_pk_mul_f32 v[104:105], v[104:105], v[224:225]
  v_pk_mul_f32 v[106:107], v[106:107], v[226:227]
  v_pk_mul_f32 v[108:109], v[108:109], v[228:229]
  v_pk_mul_f32 v[110:111], v[110:111], v[230:231]
  v_pk_mul_f32 v[224:225], v[112:113], v[112:113]
  v_pk_mul_f32 v[226:227], v[114:115], v[114:115]
  v_pk_mul_f32 v[228:229], v[116:117], v[116:117]
  v_pk_mul_f32 v[230:231], v[118:119], v[118:119]
  v_pk_fma_f32 v[224:225], v[224:225], v[28:29], v[28:29] op_sel:[0,1,0] op_sel_hi:[1,1,0]
  v_pk_fma_f32 v[226:227], v[226:227], v[28:29], v[28:29] op_sel:[0,1,0] op_sel_hi:[1,1,0]
  buffer_load_dwordx4 a[200:203], v2, s[4:7], s25 offen offset:2048
  v_pk_fma_f32 v[228:229], v[228:229], v[28:29], v[28:29] op_sel:[0,1,0] op_sel_hi:[1,1,0]
  v_pk_fma_f32 v[230:231], v[230:231], v[28:29], v[28:29] op_sel:[0,1,0] op_sel_hi:[1,1,0]
  v_pk_mul_f32 v[224:225], v[224:225], v[112:113]
  v_pk_mul_f32 v[226:227], v[226:227], v[114:115]
  v_pk_mul_f32 v[228:229], v[228:229], v[116:117]
  v_pk_mul_f32 v[230:231], v[230:231], v[118:119]
  v_exp_f32 v224, v224
  v_exp_f32 v225, v225
  v_exp_f32 v226, v226
  v_exp_f32 v227, v227
  v_exp_f32 v228, v228
  buffer_load_dwordx4 a[204:207], v2, s[4:7], s25 offen offset:3072
  v_exp_f32 v229, v229
  v_exp_f32 v230, v230
  v_exp_f32 v231, v231
  v_pk_add_f32 v[224:225], v[224:225], 1.0 op_sel_hi:[1,0]
  v_pk_add_f32 v[226:227], v[226:227], 1.0 op_sel_hi:[1,0]
  v_pk_add_f32 v[228:229], v[228:229], 1.0 op_sel_hi:[1,0]
  v_pk_add_f32 v[230:231], v[230:231], 1.0 op_sel_hi:[1,0]
  v_rcp_f32 v224, v224
  v_rcp_f32 v225, v225
  v_rcp_f32 v226, v226
  s_add_u32 s25, s25, 4096
  buffer_load_dwordx4 a[208:211], v2, s[4:7], s25 offen offset:0
  v_rcp_f32 v227, v227
  v_rcp_f32 v228, v228
  v_rcp_f32 v229, v229
  v_rcp_f32 v230, v230
  v_rcp_f32 v231, v231
  v_pk_mul_f32 v[112:113], v[112:113], v[224:225]
  v_pk_mul_f32 v[114:115], v[114:115], v[226:227]
  v_pk_mul_f32 v[116:117], v[116:117], v[228:229]
  v_pk_mul_f32 v[118:119], v[118:119], v[230:231]
  v_cvt_pk_bf16_f32 v176, v104, v105
  v_cvt_pk_bf16_f32 v177, v106, v107
  v_cvt_pk_bf16_f32 v178, v108, v109
  v_cvt_pk_bf16_f32 v179, v110, v111
  v_cvt_pk_bf16_f32 v180, v112, v113
  v_cvt_pk_bf16_f32 v181, v114, v115
  v_cvt_pk_bf16_f32 v182, v116, v117
  v_cvt_pk_bf16_f32 v183, v118, v119
  v_permlane16_swap_b32 v176, v178
  v_permlane16_swap_b32 v177, v179
  v_permlane16_swap_b32 v180, v182
  v_permlane16_swap_b32 v181, v183
  s_lshl_b32 s28, s22, 11
  s_add_u32 s28, s28, 0
  s_add_u32 s29, s28, 65536
  v_add_u32 v250, s29, v12
  v_add_u32 v251, s29, v13
  ds_write_b128 v250, v[176:179]
  ds_write_b128 v251, v[180:183]
  s_add_u32 s27, s24, 1572864
  s_add_u32 s97, s27, s38
  s_add_u32 s97, s97, s28
  s_cmp_eq_u32 s23, 0
  s_cbranch_scc1 XS_64
  buffer_store_dwordx4 v[176:179], v12, s[4:7], s97 offen
XD_65:
  v_pk_mul_f32 v[224:225], v[92:93], v[200:201] op_sel:[0,1] op_sel_hi:[1,1]
  buffer_load_dwordx4 a[212:215], v2, s[4:7], s25 offen offset:1024
  v_pk_mul_f32 v[226:227], v[94:95], v[200:201] op_sel:[0,1] op_sel_hi:[1,1]
  v_pk_mul_f32 v[228:229], v[92:93], v[204:205] op_sel:[0,1] op_sel_hi:[1,1]
  v_pk_mul_f32 v[230:231], v[94:95], v[204:205] op_sel:[0,1] op_sel_hi:[1,1]
  v_pk_fma_f32 v[120:121], v[120:121], v[200:201], v[224:225] op_sel_hi:[1,0,1] neg_lo:[0,0,1] neg_hi:[0,0,1]
  v_pk_fma_f32 v[122:123], v[122:123], v[200:201], v[226:227] op_sel_hi:[1,0,1] neg_lo:[0,0,1] neg_hi:[0,0,1]
  v_pk_fma_f32 v[124:125], v[124:125], v[204:205], v[228:229] op_sel_hi:[1,0,1] neg_lo:[0,0,1] neg_hi:[0,0,1]
  v_pk_fma_f32 v[126:127], v[126:127], v[204:205], v[230:231] op_sel_hi:[1,0,1] neg_lo:[0,0,1] neg_hi:[0,0,1]
  v_pk_mul_f32 v[224:225], v[92:93], v[208:209] op_sel:[0,1] op_sel_hi:[1,1]
  v_pk_mul_f32 v[226:227], v[94:95], v[208:209] op_sel:[0,1] op_sel_hi:[1,1]
  v_pk_mul_f32 v[228:229], v[92:93], v[212:213] op_sel:[0,1] op_sel_hi:[1,1]
  v_pk_mul_f32 v[230:231], v[94:95], v[212:213] op_sel:[0,1] op_sel_hi:[1,1]
  v_pk_fma_f32 v[128:129], v[128:129], v[208:209], v[224:225] op_sel_hi:[1,0,1] neg_lo:[0,0,1] neg_hi:[0,0,1]
  v_pk_fma_f32 v[130:131], v[130:131], v[208:209], v[226:227] op_sel_hi:[1,0,1] neg_lo:[0,0,1] neg_hi:[0,0,1]
  v_pk_fma_f32 v[132:133], v[132:133], v[212:213], v[228:229] op_sel_hi:[1,0,1] neg_lo:[0,0,1] neg_hi:[0,0,1]
  buffer_load_dwordx4 a[216:219], v2, s[4:7], s25 offen offset:2048
  v_pk_fma_f32 v[134:135], v[134:135], v[212:213], v[230:231] op_sel_hi:[1,0,1] neg_lo:[0,0,1] neg_hi:[0,0,1]
  v_pk_mul_f32 v[224:225], v[120:121], v[120:121]
  v_pk_mul_f32 v[226:227], v[122:123], v[122:123]
  v_pk_mul_f32 v[228:229], v[124:125], v[124:125]
  v_pk_mul_f32 v[230:231], v[126:127], v[126:127]
  v_pk_fma_f32 v[224:225], v[224:225], v[28:29], v[28:29] op_sel:[0,1,0] op_sel_hi:[1,1,0]
  v_pk_fma_f32 v[226:227], v[226:227], v[28:29], v[28:29] op_sel:[0,1,0] op_sel_hi:[1,1,0]
  v_pk_fma_f32 v[228:229], v[228:229], v[28:29], v[28:29] op_sel:[0,1,0] op_sel_hi:[1,1,0]
  v_pk_fma_f32 v[230:231], v[230:231], v[28:29], v[28:29] op_sel:[0,1,0] op_sel_hi:[1,1,0]
  v_pk_mul_f32 v[224:225], v[224:225], v[120:121]
  v_pk_mul_f32 v[226:227], v[226:227], v[122:123]
  v_pk_mul_f32 v[228:229], v[228:229], v[124:125]
  v_pk_mul_f32 v[230:231], v[230:231], v[126:127]
  v_exp_f32 v224, v224
  buffer_load_dwordx4 a[220:223], v2, s[4:7], s25 offen offset:3072
  v_exp_f32 v225, v225
  v_exp_f32 v226, v226
  v_exp_f32 v227, v227
  v_exp_f32 v228, v228
  v_exp_f32 v229, v229
  v_exp_f32 v230, v230
  v_exp_f32 v231, v231
  s_cmp_eq_u32 s23, 0
  s_cbranch_scc1 XS_66
  buffer_store_dwordx4 v[180:183], v13, s[4:7], s97 offen
XD_67:
  v_pk_add_f32 v[224:225], v[224:225], 1.0 op_sel_hi:[1,0]
  v_pk_add_f32 v[226:227], v[226:227], 1.0 op_sel_hi:[1,0]
  v_pk_add_f32 v[228:229], v[228:229], 1.0 op_sel_hi:[1,0]
  v_pk_add_f32 v[230:231], v[230:231], 1.0 op_sel_hi:[1,0]
  v_rcp_f32 v224, v224
  v_rcp_f32 v225, v225
  v_rcp_f32 v226, v226
  v_rcp_f32 v227, v227
  v_rcp_f32 v228, v228
  v_rcp_f32 v229, v229
  s_add_u32 s25, s25, 4096
  buffer_load_dwordx4 a[224:227], v2, s[4:7], s25 offen offset:0
  v_rcp_f32 v230, v230
  v_rcp_f32 v231, v231
  v_pk_mul_f32 v[120:121], v[120:121], v[224:225]
  v_pk_mul_f32 v[122:123], v[122:123], v[226:227]
  v_pk_mul_f32 v[124:125], v[124:125], v[228:229]
  v_pk_mul_f32 v[126:127], v[126:127], v[230:231]
  v_pk_mul_f32 v[224:225], v[128:129], v[128:129]
  v_pk_mul_f32 v[226:227], v[130:131], v[130:131]
  v_pk_mul_f32 v[228:229], v[132:133], v[132:133]
  v_pk_mul_f32 v[230:231], v[134:135], v[134:135]
  v_pk_fma_f32 v[224:225], v[224:225], v[28:29], v[28:29] op_sel:[0,1,0] op_sel_hi:[1,1,0]
  v_pk_fma_f32 v[226:227], v[226:227], v[28:29], v[28:29] op_sel:[0,1,0] op_sel_hi:[1,1,0]
  buffer_load_dwordx4 a[228:231], v2, s[4:7], s25 offen offset:1024
  v_pk_fma_f32 v[228:229], v[228:229], v[28:29], v[28:29] op_sel:[0,1,0] op_sel_hi:[1,1,0]
  v_pk_fma_f32 v[230:231], v[230:231], v[28:29], v[28:29] op_sel:[0,1,0] op_sel_hi:[1,1,0]
  v_pk_mul_f32 v[224:225], v[224:225], v[128:129]
  v_pk_mul_f32 v[226:227], v[226:227], v[130:131]
  v_pk_mul_f32 v[228:229], v[228:229], v[132:133]
  v_pk_mul_f32 v[230:231], v[230:231], v[134:135]
  v_exp_f32 v224, v224
  v_exp_f32 v225, v225
  v_exp_f32 v226, v226
  v_exp_f32 v227, v227
  v_exp_f32 v228, v228
  buffer_load_dwordx4 a[232:235], v2, s[4:7], s25 offen offset:2048
  v_exp_f32 v229, v229
  v_exp_f32 v230, v230
  v_exp_f32 v231, v231
  v_pk_add_f32 v[224:225], v[224:225], 1.0 op_sel_hi:[1,0]
  v_pk_add_f32 v[226:227], v[226:227], 1.0 op_sel_hi:[1,0]
  v_pk_add_f32 v[228:229], v[228:229], 1.0 op_sel_hi:[1,0]
  v_pk_add_f32 v[230:231], v[230:231], 1.0 op_sel_hi:[1,0]
  v_rcp_f32 v224, v224
  v_rcp_f32 v225, v225
  v_rcp_f32 v226, v226
  buffer_load_dwordx4 a[236:239], v2, s[4:7], s25 offen offset:3072
  v_rcp_f32 v227, v227
  v_rcp_f32 v228, v228
  v_rcp_f32 v229, v229
  v_rcp_f32 v230, v230
  v_rcp_f32 v231, v231
  v_pk_mul_f32 v[128:129], v[128:129], v[224:225]
  v_pk_mul_f32 v[130:131], v[130:131], v[226:227]
  v_pk_mul_f32 v[132:133], v[132:133], v[228:229]
  v_pk_mul_f32 v[134:135], v[134:135], v[230:231]
  v_cvt_pk_bf16_f32 v168, v120, v121
  v_cvt_pk_bf16_f32 v169, v122, v123
  v_cvt_pk_bf16_f32 v170, v124, v125
  v_cvt_pk_bf16_f32 v171, v126, v127
  v_cvt_pk_bf16_f32 v172, v128, v129
  v_cvt_pk_bf16_f32 v173, v130, v131
  v_cvt_pk_bf16_f32 v174, v132, v133
  v_cvt_pk_bf16_f32 v175, v134, v135
  v_permlane16_swap_b32 v168, v170
  v_permlane16_swap_b32 v169, v171
  v_permlane16_swap_b32 v172, v174
  v_permlane16_swap_b32 v173, v175
  s_lshl_b32 s28, s22, 11
  s_add_u32 s28, s28, 8192
  s_add_u32 s29, s28, 65536
  v_add_u32 v250, s29, v12
  v_add_u32 v251, s29, v13
  ds_write_b128 v250, v[168:171]
  ds_write_b128 v251, v[172:175]
  s_add_u32 s27, s24, 1572864
  s_add_u32 s57, s27, s38
  s_add_u32 s57, s57, s28
  s_cmp_eq_u32 s23, 0
  s_cbranch_scc1 XS_68
  buffer_store_dwordx4 v[168:171], v12, s[4:7], s57 offen
XD_69:
  ds_read_b128 v[188:191], v4 offset:0
  ds_read_b128 v[192:195], v5 offset:0
  ds_read_b128 v[196:199], v6 offset:0
  ds_read_b128 v[200:203], v7 offset:0
  ds_read_b128 v[176:179], v237 offset:0
  ds_read_b128 v[204:207], v4 offset:4096
  ds_read_b128 v[208:211], v5 offset:4096
  ds_read_b128 v[212:215], v6 offset:4096
  ds_read_b128 v[216:219], v7 offset:4096
  ds_read_b128 v[180:183], v237 offset:4096
  s_waitcnt vmcnt(54) lgkmcnt(5)
  v_mfma_f32_16x16x32_bf16 v[136:139], a[0:3], v[188:191], 0
  ds_read_b128 v[220:223], v4 offset:8192
  s_add_u32 s25, s25, 4096
  buffer_load_dwordx4 a[240:243], v2, s[4:7], s25 offen offset:0
  v_mfma_f32_16x16x32_bf16 v[140:143], a[0:3], v[192:195], 0
  ds_read_b128 v[224:227], v5 offset:8192
  v_mfma_f32_16x16x32_bf16 v[144:147], a[0:3], v[196:199], 0
  ds_read_b128 v[228:231], v6 offset:8192
  v_mfma_f32_16x16x32_bf16 v[148:151], a[0:3], v[200:203], 0
  ds_read_b128 v[232:235], v7 offset:8192
  v_mfma_f32_16x16x32_bf16 v[152:155], a[4:7], v[176:179], 0
  ds_read_b128 v[184:187], v237 offset:8192
  buffer_load_dwordx4 a[244:247], v2, s[4:7], s25 offen offset:1024
  v_mfma_f32_16x16x32_bf16 v[156:159], a[4:7], v[192:195], 0
  v_mfma_f32_16x16x32_bf16 v[96:99], a[0:3], v[24:27], 0
  v_mfma_f32_16x16x32_bf16 v[100:103], a[4:7], v[24:27], 0
  s_waitcnt lgkmcnt(5)
  v_mfma_f32_16x16x32_bf16 v[136:139], a[8:11], v[204:207], v[136:139]
  ds_read_b128 v[188:191], v4 offset:12288
  buffer_load_dwordx4 a[248:251], v2, s[4:7], s25 offen offset:2048
  v_mfma_f32_16x16x32_bf16 v[140:143], a[8:11], v[208:211], v[140:143]
  ds_read_b128 v[192:195], v5 offset:12288
  v_mfma_f32_16x16x32_bf16 v[144:147], a[8:11], v[212:215], v[144:147]
  ds_read_b128 v[196:199], v6 offset:12288
  v_mfma_f32_16x16x32_bf16 v[148:151], a[8:11], v[216:219], v[148:151]
  ds_read_b128 v[200:203], v7 offset:12288
  s_cmp_eq_u32 s23, 0
  s_cbranch_scc1 XS_70
  buffer_store_dwordx4 v[172:175], v13, s[4:7], s57 offen
XD_71:
  v_mfma_f32_16x16x32_bf16 v[152:155], a[12:15], v[180:183], v[152:155]
  ds_read_b128 v[176:179], v237 offset:12288
  v_mfma_f32_16x16x32_bf16 v[156:159], a[12:15], v[208:211], v[156:159]
  v_mfma_f32_16x16x32_bf16 v[96:99], a[8:11], v[24:27], v[96:99]
  v_mfma_f32_16x16x32_bf16 v[100:103], a[12:15], v[24:27], v[100:103]
  buffer_load_dwordx4 a[252:255], v2, s[4:7], s25 offen offset:3072
  s_add_u32 s74, s33, 2048
  v_lshlrev_b32 v251, 7, v1
  s_mov_b64 exec, 15
  buffer_load_dword v250, v251, s[4:7], s74 offen
  s_mov_b64 exec, -1
  s_waitcnt lgkmcnt(5)
  v_mfma_f32_16x16x32_bf16 v[136:139], a[16:19], v[220:223], v[136:139]
  ds_read_b128 v[204:207], v4 offset:16384
  v_mfma_f32_16x16x32_bf16 v[140:143], a[16:19], v[224:227], v[140:143]
  ds_read_b128 v[208:211], v5 offset:16384
  v_mfma_f32_16x16x32_bf16 v[144:147], a[16:19], v[228:231], v[144:147]
  ds_read_b128 v[212:215], v6 offset:16384
  v_mfma_f32_16x16x32_bf16 v[148:151], a[16:19], v[232:235], v[148:151]
  ds_read_b128 v[216:219], v7 offset:16384
  s_add_u32 s25, s25, 4096
  buffer_load_dwordx4 a[0:3], v2, s[4:7], s25 offen offset:0
  v_mfma_f32_16x16x32_bf16 v[152:155], a[20:23], v[184:187], v[152:155]
  ds_read_b128 v[180:183], v237 offset:16384
  v_mfma_f32_16x16x32_bf16 v[156:159], a[20:23], v[224:227], v[156:159]
  v_mfma_f32_16x16x32_bf16 v[96:99], a[16:19], v[24:27], v[96:99]
  v_mfma_f32_16x16x32_bf16 v[100:103], a[20:23], v[24:27], v[100:103]
  buffer_load_dwordx4 a[4:7], v2, s[4:7], s25 offen offset:1024
  s_waitcnt lgkmcnt(5)
  v_mfma_f32_16x16x32_bf16 v[136:139], a[24:27], v[188:191], v[136:139]
  ds_read_b128 v[220:223], v4 offset:20480
  v_mfma_f32_16x16x32_bf16 v[140:143], a[24:27], v[192:195], v[140:143]
  ds_read_b128 v[224:227], v5 offset:20480
  v_mfma_f32_16x16x32_bf16 v[144:147], a[24:27], v[196:199], v[144:147]
  ds_read_b128 v[228:231], v6 offset:20480
  v_mfma_f32_16x16x32_bf16 v[148:151], a[24:27], v[200:203], v[148:151]
  ds_read_b128 v[232:235], v7 offset:20480
  buffer_load_dwordx4 a[8:11], v2, s[4:7], s25 offen offset:2048
  v_mfma_f32_16x16x32_bf16 v[152:155], a[28:31], v[176:179], v[152:155]
  ds_read_b128 v[184:187], v237 offset:20480
  v_mfma_f32_16x16x32_bf16 v[156:159], a[28:31], v[192:195], v[156:159]
  v_mfma_f32_16x16x32_bf16 v[96:99], a[24:27], v[24:27], v[96:99]
  v_mfma_f32_16x16x32_bf16 v[100:103], a[28:31], v[24:27], v[100:103]
  buffer_load_dwordx4 a[12:15], v2, s[4:7], s25 offen offset:3072
  s_waitcnt vmcnt(56) lgkmcnt(5)
  v_mfma_f32_16x16x32_bf16 v[136:139], a[32:35], v[204:207], v[136:139]
  ds_read_b128 v[188:191], v4 offset:24576
  v_mfma_f32_16x16x32_bf16 v[140:143], a[32:35], v[208:211], v[140:143]
  ds_read_b128 v[192:195], v5 offset:24576
  v_mfma_f32_16x16x32_bf16 v[144:147], a[32:35], v[212:215], v[144:147]
  ds_read_b128 v[196:199], v6 offset:24576
  v_mfma_f32_16x16x32_bf16 v[148:151], a[32:35], v[216:219], v[148:151]
  ds_read_b128 v[200:203], v7 offset:24576
  s_add_u32 s25, s25, 4096
  buffer_load_dwordx4 a[16:19], v2, s[4:7], s25 offen offset:0
  v_mfma_f32_16x16x32_bf16 v[152:155], a[36:39], v[180:183], v[152:155]
  ds_read_b128 v[176:179], v237 offset:24576
  v_mfma_f32_16x16x32_bf16 v[156:159], a[36:39], v[208:211], v[156:159]
  v_mfma_f32_16x16x32_bf16 v[96:99], a[32:35], v[24:27], v[96:99]
  v_mfma_f32_16x16x32_bf16 v[100:103], a[36:39], v[24:27], v[100:103]
  buffer_load_dwordx4 a[20:23], v2, s[4:7], s25 offen offset:1024
  s_waitcnt lgkmcnt(5)
  v_mfma_f32_16x16x32_bf16 v[136:139], a[40:43], v[220:223], v[136:139]
  ds_read_b128 v[204:207], v4 offset:28672
  v_mfma_f32_16x16x32_bf16 v[140:143], a[40:43], v[224:227], v[140:143]
  ds_read_b128 v[208:211], v5 offset:28672
  v_mfma_f32_16x16x32_bf16 v[144:147], a[40:43], v[228:231], v[144:147]
  ds_read_b128 v[212:215], v6 offset:28672
  v_mfma_f32_16x16x32_bf16 v[148:151], a[40:43], v[232:235], v[148:151]
  ds_read_b128 v[216:219], v7 offset:28672
  buffer_load_dwordx4 a[24:27], v2, s[4:7], s25 offen offset:2048
  v_mfma_f32_16x16x32_bf16 v[152:155], a[44:47], v[184:187], v[152:155]
  ds_read_b128 v[180:183], v237 offset:28672
  v_mfma_f32_16x16x32_bf16 v[156:159], a[44:47], v[224:227], v[156:159]
  v_mfma_f32_16x16x32_bf16 v[96:99], a[40:43], v[24:27], v[96:99]
  v_mfma_f32_16x16x32_bf16 v[100:103], a[44:47], v[24:27], v[100:103]
  buffer_load_dwordx4 a[28:31], v2, s[4:7], s25 offen offset:3072
  s_waitcnt lgkmcnt(5)
  v_mfma_f32_16x16x32_bf16 v[136:139], a[48:51], v[188:191], v[136:139]
  ds_read_b128 v[220:223], v4 offset:32768
  v_mfma_f32_16x16x32_bf16 v[140:143], a[48:51], v[192:195], v[140:143]
  ds_read_b128 v[224:227], v5 offset:32768
  v_mfma_f32_16x16x32_bf16 v[144:147], a[48:51], v[196:199], v[144:147]
  ds_read_b128 v[228:231], v6 offset:32768
  v_mfma_f32_16x16x32_bf16 v[148:151], a[48:51], v[200:203], v[148:151]
  ds_read_b128 v[232:235], v7 offset:32768
  s_add_u32 s25, s25, 4096
  buffer_load_dwordx4 a[32:35], v2, s[4:7], s25 offen offset:0
  v_mfma_f32_16x16x32_bf16 v[152:155], a[52:55], v[176:179], v[152:155]
  ds_read_b128 v[184:187], v237 offset:32768
  v_mfma_f32_16x16x32_bf16 v[156:159], a[52:55], v[192:195], v[156:159]
  v_mfma_f32_16x16x32_bf16 v[96:99], a[48:51], v[24:27], v[96:99]
  v_mfma_f32_16x16x32_bf16 v[100:103], a[52:55], v[24:27], v[100:103]
  buffer_load_dwordx4 a[36:39], v2, s[4:7], s25 offen offset:1024
  s_waitcnt lgkmcnt(5)
  v_mfma_f32_16x16x32_bf16 v[136:139], a[56:59], v[204:207], v[136:139]
  ds_read_b128 v[188:191], v4 offset:36864
  v_mfma_f32_16x16x32_bf16 v[140:143], a[56:59], v[208:211], v[140:143]
  ds_read_b128 v[192:195], v5 offset:36864
  v_mfma_f32_16x16x32_bf16 v[144:147], a[56:59], v[212:215], v[144:147]
  ds_read_b128 v[196:199], v6 offset:36864
  v_mfma_f32_16x16x32_bf16 v[148:151], a[56:59], v[216:219], v[148:151]
  ds_read_b128 v[200:203], v7 offset:36864
  buffer_load_dwordx4 a[40:43], v2, s[4:7], s25 offen offset:2048
  v_mfma_f32_16x16x32_bf16 v[152:155], a[60:63], v[180:183], v[152:155]
  ds_read_b128 v[176:179], v237 offset:36864
  v_mfma_f32_16x16x32_bf16 v[156:159], a[60:63], v[208:211], v[156:159]
  v_mfma_f32_16x16x32_bf16 v[96:99], a[56:59], v[24:27], v[96:99]
  v_mfma_f32_16x16x32_bf16 v[100:103], a[60:63], v[24:27], v[100:103]
  buffer_load_dwordx4 a[44:47], v2, s[4:7], s25 offen offset:3072
  s_waitcnt vmcnt(56) lgkmcnt(5)
  v_mfma_f32_16x16x32_bf16 v[136:139], a[64:67], v[220:223], v[136:139]
  ds_read_b128 v[204:207], v4 offset:40960
  v_mfma_f32_16x16x32_bf16 v[140:143], a[64:67], v[224:227], v[140:143]
  ds_read_b128 v[208:211], v5 offset:40960
  v_mfma_f32_16x16x32_bf16 v[144:147], a[64:67], v[228:231], v[144:147]
  ds_read_b128 v[212:215], v6 offset:40960
  v_mfma_f32_16x16x32_bf16 v[148:151], a[64:67], v[232:235], v[148:151]
  ds_read_b128 v[216:219], v7 offset:40960
  s_add_u32 s25, s25, 4096
  buffer_load_dwordx4 a[48:51], v2, s[4:7], s25 offen offset:0
  v_mfma_f32_16x16x32_bf16 v[152:155], a[68:71], v[184:187], v[152:155]
  ds_read_b128 v[180:183], v237 offset:40960
  v_mfma_f32_16x16x32_bf16 v[156:159], a[68:71], v[224:227], v[156:159]
  v_mfma_f32_16x16x32_bf16 v[96:99], a[64:67], v[24:27], v[96:99]
  v_mfma_f32_16x16x32_bf16 v[100:103], a[68:71], v[24:27], v[100:103]
  buffer_load_dwordx4 a[52:55], v2, s[4:7], s25 offen offset:1024
  s_waitcnt lgkmcnt(5)
  v_mfma_f32_16x16x32_bf16 v[136:139], a[72:75], v[188:191], v[136:139]
  ds_read_b128 v[220:223], v4 offset:45056
  v_mfma_f32_16x16x32_bf16 v[140:143], a[72:75], v[192:195], v[140:143]
  ds_read_b128 v[224:227], v5 offset:45056
  v_mfma_f32_16x16x32_bf16 v[144:147], a[72:75], v[196:199], v[144:147]
  ds_read_b128 v[228:231], v6 offset:45056
  v_mfma_f32_16x16x32_bf16 v[148:151], a[72:75], v[200:203], v[148:151]
  ds_read_b128 v[232:235], v7 offset:45056
  buffer_load_dwordx4 a[56:59], v2, s[4:7], s25 offen offset:2048
  v_mfma_f32_16x16x32_bf16 v[152:155], a[76:79], v[176:179], v[152:155]
  ds_read_b128 v[184:187], v237 offset:45056
  v_mfma_f32_16x16x32_bf16 v[156:159], a[76:79], v[192:195], v[156:159]
  v_mfma_f32_16x16x32_bf16 v[96:99], a[72:75], v[24:27], v[96:99]
  v_mfma_f32_16x16x32_bf16 v[100:103], a[76:79], v[24:27], v[100:103]
  buffer_load_dwordx4 a[60:63], v2, s[4:7], s25 offen offset:3072
  s_waitcnt lgkmcnt(5)
  v_mfma_f32_16x16x32_bf16 v[136:139], a[80:83], v[204:207], v[136:139]
  ds_read_b128 v[188:191], v4 offset:49152
  v_mfma_f32_16x16x32_bf16 v[140:143], a[80:83], v[208:211], v[140:143]
  ds_read_b128 v[192:195], v5 offset:49152
  v_mfma_f32_16x16x32_bf16 v[144:147], a[80:83], v[212:215], v[144:147]
  ds_read_b128 v[196:199], v6 offset:49152
  v_mfma_f32_16x16x32_bf16 v[148:151], a[80:83], v[216:219], v[148:151]
  ds_read_b128 v[200:203], v7 offset:49152
  s_add_u32 s25, s25, 4096
  buffer_load_dwordx4 a[64:67], v2, s[4:7], s25 offen offset:0
  v_mfma_f32_16x16x32_bf16 v[152:155], a[84:87], v[180:183], v[152:155]
  ds_read_b128 v[176:179], v237 offset:49152
  v_mfma_f32_16x16x32_bf16 v[156:159], a[84:87], v[208:211], v[156:159]
  v_mfma_f32_16x16x32_bf16 v[96:99], a[80:83], v[24:27], v[96:99]
  v_mfma_f32_16x16x32_bf16 v[100:103], a[84:87], v[24:27], v[100:103]
  buffer_load_dwordx4 a[68:71], v2, s[4:7], s25 offen offset:1024
  s_waitcnt lgkmcnt(5)
  v_mfma_f32_16x16x32_bf16 v[136:139], a[88:91], v[220:223], v[136:139]
  ds_read_b128 v[204:207], v4 offset:53248
  v_mfma_f32_16x16x32_bf16 v[140:143], a[88:91], v[224:227], v[140:143]
  ds_read_b128 v[208:211], v5 offset:53248
  v_mfma_f32_16x16x32_bf16 v[144:147], a[88:91], v[228:231], v[144:147]
  ds_read_b128 v[212:215], v6 offset:53248
  v_mfma_f32_16x16x32_bf16 v[148:151], a[88:91], v[232:235], v[148:151]
  ds_read_b128 v[216:219], v7 offset:53248
  buffer_load_dwordx4 a[72:75], v2, s[4:7], s25 offen offset:2048
  v_mfma_f32_16x16x32_bf16 v[152:155], a[92:95], v[184:187], v[152:155]
  ds_read_b128 v[180:183], v237 offset:53248
  v_mfma_f32_16x16x32_bf16 v[156:159], a[92:95], v[224:227], v[156:159]
  v_mfma_f32_16x16x32_bf16 v[96:99], a[88:91], v[24:27], v[96:99]
  v_mfma_f32_16x16x32_bf16 v[100:103], a[92:95], v[24:27], v[100:103]
  buffer_load_dwordx4 a[76:79], v2, s[4:7], s25 offen offset:3072
  s_waitcnt vmcnt(56) lgkmcnt(5)
  v_mfma_f32_16x16x32_bf16 v[136:139], a[96:99], v[188:191], v[136:139]
  ds_read_b128 v[220:223], v4 offset:57344
  v_mfma_f32_16x16x32_bf16 v[140:143], a[96:99], v[192:195], v[140:143]
  ds_read_b128 v[224:227], v5 offset:57344
  v_mfma_f32_16x16x32_bf16 v[144:147], a[96:99], v[196:199], v[144:147]
  ds_read_b128 v[228:231], v6 offset:57344
  v_mfma_f32_16x16x32_bf16 v[148:151], a[96:99], v[200:203], v[148:151]
  ds_read_b128 v[232:235], v7 offset:57344
  s_add_u32 s25, s25, 4096
  buffer_load_dwordx4 a[80:83], v2, s[4:7], s25 offen offset:0
  v_mfma_f32_16x16x32_bf16 v[152:155], a[100:103], v[176:179], v[152:155]
  ds_read_b128 v[184:187], v237 offset:57344
  v_mfma_f32_16x16x32_bf16 v[156:159], a[100:103], v[192:195], v[156:159]
  v_mfma_f32_16x16x32_bf16 v[96:99], a[96:99], v[24:27], v[96:99]
  v_mfma_f32_16x16x32_bf16 v[100:103], a[100:103], v[24:27], v[100:103]
  buffer_load_dwordx4 a[84:87], v2, s[4:7], s25 offen offset:1024
  s_waitcnt lgkmcnt(5)
  v_mfma_f32_16x16x32_bf16 v[136:139], a[104:107], v[204:207], v[136:139]
  ds_read_b128 v[188:191], v4 offset:61440
  v_mfma_f32_16x16x32_bf16 v[140:143], a[104:107], v[208:211], v[140:143]
  ds_read_b128 v[192:195], v5 offset:61440
  v_mfma_f32_16x16x32_bf16 v[144:147], a[104:107], v[212:215], v[144:147]
  ds_read_b128 v[196:199], v6 offset:61440
  v_mfma_f32_16x16x32_bf16 v[148:151], a[104:107], v[216:219], v[148:151]
  ds_read_b128 v[200:203], v7 offset:61440
  buffer_load_dwordx4 a[88:91], v2, s[4:7], s25 offen offset:2048
  v_mfma_f32_16x16x32_bf16 v[152:155], a[108:111], v[180:183], v[152:155]
  ds_read_b128 v[176:179], v237 offset:61440
  v_mfma_f32_16x16x32_bf16 v[156:159], a[108:111], v[208:211], v[156:159]
  v_mfma_f32_16x16x32_bf16 v[96:99], a[104:107], v[24:27], v[96:99]
  v_mfma_f32_16x16x32_bf16 v[100:103], a[108:111], v[24:27], v[100:103]
  buffer_load_dwordx4 a[92:95], v2, s[4:7], s25 offen offset:3072
  s_waitcnt lgkmcnt(5)
  v_mfma_f32_16x16x32_bf16 v[136:139], a[112:115], v[220:223], v[136:139]
  v_mfma_f32_16x16x32_bf16 v[140:143], a[112:115], v[224:227], v[140:143]
  v_mfma_f32_16x16x32_bf16 v[144:147], a[112:115], v[228:231], v[144:147]
  v_mfma_f32_16x16x32_bf16 v[148:151], a[112:115], v[232:235], v[148:151]
  s_mov_b32 s25, s34
  buffer_load_dwordx4 a[96:99], v2, s[4:7], s25 offen offset:0
  v_mfma_f32_16x16x32_bf16 v[152:155], a[116:119], v[184:187], v[152:155]
  v_mfma_f32_16x16x32_bf16 v[156:159], a[116:119], v[224:227], v[156:159]
  v_mfma_f32_16x16x32_bf16 v[96:99], a[112:115], v[24:27], v[96:99]
  v_mfma_f32_16x16x32_bf16 v[100:103], a[116:119], v[24:27], v[100:103]
  buffer_load_dwordx4 a[100:103], v2, s[4:7], s25 offen offset:1024
  s_waitcnt lgkmcnt(0)
  v_mfma_f32_16x16x32_bf16 v[136:139], a[120:123], v[188:191], v[136:139]
  v_mfma_f32_16x16x32_bf16 v[140:143], a[120:123], v[192:195], v[140:143]
  v_mfma_f32_16x16x32_bf16 v[144:147], a[120:123], v[196:199], v[144:147]
  v_mfma_f32_16x16x32_bf16 v[148:151], a[120:123], v[200:203], v[148:151]
  buffer_load_dwordx4 a[104:107], v2, s[4:7], s25 offen offset:2048
  v_mfma_f32_16x16x32_bf16 v[152:155], a[124:127], v[176:179], v[152:155]
  v_mfma_f32_16x16x32_bf16 v[156:159], a[124:127], v[192:195], v[156:159]
  v_mfma_f32_16x16x32_bf16 v[96:99], a[120:123], v[24:27], v[96:99]
  v_mfma_f32_16x16x32_bf16 v[100:103], a[124:127], v[24:27], v[100:103]
  buffer_load_dwordx4 a[108:111], v2, s[4:7], s25 offen offset:3072
  ds_read_b128 v[200:203], v14
  ds_read_b128 v[204:207], v15
  ds_read_b128 v[208:211], v16
  ds_read_b128 v[212:215], v17
  ds_read_b128 v[188:191], v238
  s_waitcnt lgkmcnt(0)
  v_pk_mul_f32 v[224:225], v[96:97], v[200:201] op_sel:[0,1] op_sel_hi:[1,1]
  v_pk_mul_f32 v[226:227], v[98:99], v[200:201] op_sel:[0,1] op_sel_hi:[1,1]
  v_pk_mul_f32 v[228:229], v[96:97], v[204:205] op_sel:[0,1] op_sel_hi:[1,1]
  v_pk_mul_f32 v[230:231], v[98:99], v[204:205] op_sel:[0,1] op_sel_hi:[1,1]
  v_pk_fma_f32 v[136:137], v[136:137], v[200:201], v[224:225] op_sel_hi:[1,0,1] neg_lo:[0,0,1] neg_hi:[0,0,1]
  v_pk_fma_f32 v[138:139], v[138:139], v[200:201], v[226:227] op_sel_hi:[1,0,1] neg_lo:[0,0,1] neg_hi:[0,0,1]
  v_pk_fma_f32 v[140:141], v[140:141], v[204:205], v[228:229] op_sel_hi:[1,0,1] neg_lo:[0,0,1] neg_hi:[0,0,1]
  v_pk_fma_f32 v[142:143], v[142:143], v[204:205], v[230:231] op_sel_hi:[1,0,1] neg_lo:[0,0,1] neg_hi:[0,0,1]
  v_pk_mul_f32 v[224:225], v[96:97], v[208:209] op_sel:[0,1] op_sel_hi:[1,1]
  v_pk_mul_f32 v[226:227], v[98:99], v[208:209] op_sel:[0,1] op_sel_hi:[1,1]
  v_pk_mul_f32 v[228:229], v[96:97], v[212:213] op_sel:[0,1] op_sel_hi:[1,1]
  v_pk_mul_f32 v[230:231], v[98:99], v[212:213] op_sel:[0,1] op_sel_hi:[1,1]
  v_pk_fma_f32 v[144:145], v[144:145], v[208:209], v[224:225] op_sel_hi:[1,0,1] neg_lo:[0,0,1] neg_hi:[0,0,1]
  v_pk_fma_f32 v[146:147], v[146:147], v[208:209], v[226:227] op_sel_hi:[1,0,1] neg_lo:[0,0,1] neg_hi:[0,0,1]
  s_add_u32 s25, s25, 4096
  buffer_load_dwordx4 a[112:115], v2, s[4:7], s25 offen offset:0
  v_pk_fma_f32 v[148:149], v[148:149], v[212:213], v[228:229] op_sel_hi:[1,0,1] neg_lo:[0,0,1] neg_hi:[0,0,1]
  v_pk_fma_f32 v[150:151], v[150:151], v[212:213], v[230:231] op_sel_hi:[1,0,1] neg_lo:[0,0,1] neg_hi:[0,0,1]
  v_pk_mul_f32 v[224:225], v[136:137], v[136:137]
  v_pk_mul_f32 v[226:227], v[138:139], v[138:139]
  v_pk_mul_f32 v[228:229], v[140:141], v[140:141]
  v_pk_mul_f32 v[230:231], v[142:143], v[142:143]
  v_pk_fma_f32 v[224:225], v[224:225], v[28:29], v[28:29] op_sel:[0,1,0] op_sel_hi:[1,1,0]
  v_pk_fma_f32 v[226:227], v[226:227], v[28:29], v[28:29] op_sel:[0,1,0] op_sel_hi:[1,1,0]
  v_pk_fma_f32 v[228:229], v[228:229], v[28:29], v[28:29] op_sel:[0,1,0] op_sel_hi:[1,1,0]
  v_pk_fma_f32 v[230:231], v[230:231], v[28:29], v[28:29] op_sel:[0,1,0] op_sel_hi:[1,1,0]
  v_pk_mul_f32 v[224:225], v[224:225], v[136:137]
  v_pk_mul_f32 v[226:227], v[226:227], v[138:139]
  v_pk_mul_f32 v[228:229], v[228:229], v[140:141]
  v_pk_mul_f32 v[230:231], v[230:231], v[142:143]
  v_exp_f32 v224, v224
  v_exp_f32 v225, v225
  v_exp_f32 v226, v226
  v_exp_f32 v227, v227
  v_exp_f32 v228, v228
  v_exp_f32 v229, v229
  v_exp_f32 v230, v230
  v_exp_f32 v231, v231
  v_pk_add_f32 v[224:225], v[224:225], 1.0 op_sel_hi:[1,0]
  v_pk_add_f32 v[226:227], v[226:227], 1.0 op_sel_hi:[1,0]
  v_pk_add_f32 v[228:229], v[228:229], 1.0 op_sel_hi:[1,0]
  v_pk_add_f32 v[230:231], v[230:231], 1.0 op_sel_hi:[1,0]
  v_rcp_f32 v224, v224
  v_rcp_f32 v225, v225
  v_rcp_f32 v226, v226
  v_rcp_f32 v227, v227
  v_rcp_f32 v228, v228
  v_rcp_f32 v229, v229
  v_rcp_f32 v230, v230
  v_rcp_f32 v231, v231
  v_pk_mul_f32 v[136:137], v[136:137], v[224:225]
  v_pk_mul_f32 v[138:139], v[138:139], v[226:227]
  v_pk_mul_f32 v[140:141], v[140:141], v[228:229]
  v_pk_mul_f32 v[142:143], v[142:143], v[230:231]
  v_pk_mul_f32 v[224:225], v[144:145], v[144:145]
  v_pk_mul_f32 v[226:227], v[146:147], v[146:147]
  v_pk_mul_f32 v[228:229], v[148:149], v[148:149]
  v_pk_mul_f32 v[230:231], v[150:151], v[150:151]
  v_pk_fma_f32 v[224:225], v[224:225], v[28:29], v[28:29] op_sel:[0,1,0] op_sel_hi:[1,1,0]
  v_pk_fma_f32 v[226:227], v[226:227], v[28:29], v[28:29] op_sel:[0,1,0] op_sel_hi:[1,1,0]
  v_pk_fma_f32 v[228:229], v[228:229], v[28:29], v[28:29] op_sel:[0,1,0] op_sel_hi:[1,1,0]
  v_pk_fma_f32 v[230:231], v[230:231], v[28:29], v[28:29] op_sel:[0,1,0] op_sel_hi:[1,1,0]
  v_pk_mul_f32 v[224:225], v[224:225], v[144:145]
  v_pk_mul_f32 v[226:227], v[226:227], v[146:147]
  v_pk_mul_f32 v[228:229], v[228:229], v[148:149]
  v_pk_mul_f32 v[230:231], v[230:231], v[150:151]
  v_exp_f32 v224, v224
  v_exp_f32 v225, v225
  v_exp_f32 v226, v226
  v_exp_f32 v227, v227
  v_exp_f32 v228, v228
  v_exp_f32 v229, v229
  v_exp_f32 v230, v230
  v_exp_f32 v231, v231
  v_pk_add_f32 v[224:225], v[224:225], 1.0 op_sel_hi:[1,0]
  v_pk_add_f32 v[226:227], v[226:227], 1.0 op_sel_hi:[1,0]
  v_pk_add_f32 v[228:229], v[228:229], 1.0 op_sel_hi:[1,0]
  v_pk_add_f32 v[230:231], v[230:231], 1.0 op_sel_hi:[1,0]
  v_rcp_f32 v224, v224
  v_rcp_f32 v225, v225
  v_rcp_f32 v226, v226
  v_rcp_f32 v227, v227
  v_rcp_f32 v228, v228
  v_rcp_f32 v229, v229
  v_rcp_f32 v230, v230
  v_rcp_f32 v231, v231
  v_pk_mul_f32 v[144:145], v[144:145], v[224:225]
  v_pk_mul_f32 v[146:147], v[146:147], v[226:227]
  v_pk_mul_f32 v[148:149], v[148:149], v[228:229]
  v_pk_mul_f32 v[150:151], v[150:151], v[230:231]
  v_cvt_pk_bf16_f32 v216, v136, v137
  v_cvt_pk_bf16_f32 v217, v138, v139
  v_cvt_pk_bf16_f32 v218, v140, v141
  v_cvt_pk_bf16_f32 v219, v142, v143
  v_cvt_pk_bf16_f32 v220, v144, v145
  v_cvt_pk_bf16_f32 v221, v146, v147
  v_cvt_pk_bf16_f32 v222, v148, v149
  v_cvt_pk_bf16_f32 v223, v150, v151
  v_permlane16_swap_b32 v216, v218
  v_permlane16_swap_b32 v217, v219
  v_permlane16_swap_b32 v220, v222
  v_permlane16_swap_b32 v221, v223
  s_lshl_b32 s28, s22, 11
  s_add_u32 s28, s28, 16384
  s_add_u32 s29, s28, 65536
  v_add_u32 v250, s29, v12
  v_add_u32 v251, s29, v13
  ds_write_b128 v250, v[216:219]
  ds_write_b128 v251, v[220:223]
  s_add_u32 s27, s24, 1572864
  s_add_u32 s97, s27, s38
  s_add_u32 s97, s97, s28
  s_cmp_eq_u32 s23, 0
  s_cbranch_scc1 XS_72
  buffer_store_dwordx4 v[216:219], v12, s[4:7], s97 offen
XD_73:
  v_pk_mul_f32 v[224:225], v[100:101], v[188:189] op_sel:[0,1] op_sel_hi:[1,1]
  v_pk_mul_f32 v[226:227], v[102:103], v[188:189] op_sel:[0,1] op_sel_hi:[1,1]
  v_pk_fma_f32 v[152:153], v[152:153], v[188:189], v[224:225] op_sel_hi:[1,0,1] neg_lo:[0,0,1] neg_hi:[0,0,1]
  v_pk_fma_f32 v[154:155], v[154:155], v[188:189], v[226:227] op_sel_hi:[1,0,1] neg_lo:[0,0,1] neg_hi:[0,0,1]
  v_pk_mul_f32 v[224:225], v[100:101], v[204:205] op_sel:[0,1] op_sel_hi:[1,1]
  v_pk_mul_f32 v[226:227], v[102:103], v[204:205] op_sel:[0,1] op_sel_hi:[1,1]
  v_pk_fma_f32 v[156:157], v[156:157], v[204:205], v[224:225] op_sel_hi:[1,0,1] neg_lo:[0,0,1] neg_hi:[0,0,1]
  v_pk_fma_f32 v[158:159], v[158:159], v[204:205], v[226:227] op_sel_hi:[1,0,1] neg_lo:[0,0,1] neg_hi:[0,0,1]
  v_pk_mul_f32 v[224:225], v[152:153], v[152:153]
  v_pk_mul_f32 v[226:227], v[154:155], v[154:155]
  v_pk_mul_f32 v[228:229], v[156:157], v[156:157]
  v_pk_mul_f32 v[230:231], v[158:159], v[158:159]
  v_pk_fma_f32 v[224:225], v[224:225], v[28:29], v[28:29] op_sel:[0,1,0] op_sel_hi:[1,1,0]
  v_pk_fma_f32 v[226:227], v[226:227], v[28:29], v[28:29] op_sel:[0,1,0] op_sel_hi:[1,1,0]
  v_pk_fma_f32 v[228:229], v[228:229], v[28:29], v[28:29] op_sel:[0,1,0] op_sel_hi:[1,1,0]
  v_pk_fma_f32 v[230:231], v[230:231], v[28:29], v[28:29] op_sel:[0,1,0] op_sel_hi:[1,1,0]
  v_pk_mul_f32 v[224:225], v[224:225], v[152:153]
  v_pk_mul_f32 v[226:227], v[226:227], v[154:155]
  v_pk_mul_f32 v[228:229], v[228:229], v[156:157]
  v_pk_mul_f32 v[230:231], v[230:231], v[158:159]
  v_exp_f32 v224, v224
  v_exp_f32 v225, v225
  v_exp_f32 v226, v226
  v_exp_f32 v227, v227
  v_exp_f32 v228, v228
  v_exp_f32 v229, v229
  v_exp_f32 v230, v230
  v_exp_f32 v231, v231
  v_pk_add_f32 v[224:225], v[224:225], 1.0 op_sel_hi:[1,0]
  v_pk_add_f32 v[226:227], v[226:227], 1.0 op_sel_hi:[1,0]
  v_pk_add_f32 v[228:229], v[228:229], 1.0 op_sel_hi:[1,0]
  v_pk_add_f32 v[230:231], v[230:231], 1.0 op_sel_hi:[1,0]
  v_rcp_f32 v224, v224
  v_rcp_f32 v225, v225
  v_rcp_f32 v226, v226
  v_rcp_f32 v227, v227
  v_rcp_f32 v228, v228
  v_rcp_f32 v229, v229
  s_cmp_eq_u32 s23, 0
  s_cbranch_scc1 XS_74
  buffer_store_dwordx4 v[220:223], v13, s[4:7], s97 offen
XD_75:
  v_rcp_f32 v230, v230
  v_rcp_f32 v231, v231
  v_pk_mul_f32 v[152:153], v[152:153], v[224:225]
  v_pk_mul_f32 v[154:155], v[154:155], v[226:227]
  v_pk_mul_f32 v[156:157], v[156:157], v[228:229]
  v_pk_mul_f32 v[158:159], v[158:159], v[230:231]
  v_cvt_pk_bf16_f32 v192, v152, v153
  v_cvt_pk_bf16_f32 v193, v154, v155
  v_cvt_pk_bf16_f32 v194, v156, v157
  v_cvt_pk_bf16_f32 v195, v158, v159
  s_nop 0
  v_permlane16_swap_b32 v192, v194
  v_permlane16_swap_b32 v193, v195
  s_lshr_b32 s28, s22, 1
  s_lshl_b32 s28, s28, 11
  s_add_u32 s28, s28, 24576
  s_add_u32 s29, s28, 65536
  v_add_u32 v250, s29, v239
  ds_write_b128 v250, v[192:195]
  s_add_u32 s27, s24, 1572864
  s_add_u32 s26, s27, s38
  s_add_u32 s26, s26, s28
  s_cmp_eq_u32 s23, 0
  s_cbranch_scc1 XS_76
  buffer_store_dwordx4 v[192:195], v239, s[4:7], s26 offen
XD_77:
  s_add_u32 s75, s24, 1572864
  s_add_u32 s39, s75, 229376
  s_add_u32 s75, s75, s38
  s_lshl_b32 s26, s22, 13
  s_add_u32 s75, s75, s26
  s_lshr_b32 s56, s22, 1
  s_lshl_b32 s56, s56, 12
  s_waitcnt lgkmcnt(0)
  s_add_u32 s74, s68, 2048
  v_lshlrev_b32 v251, 7, v1
  buffer_load_dwordx4 a[116:119], v2, s[4:7], s25 offen offset:1024
  buffer_load_dwordx4 a[120:123], v2, s[4:7], s25 offen offset:2048
  s_waitcnt vmcnt(2)
  s_mov_b64 exec, 15
  s_cmp_eq_u32 s23, 0
  s_cbranch_scc1 XS_78
  buffer_store_dword v254, v251, s[4:7], s74 offen
XD_79:
  s_mov_b64 exec, -1
  s_barrier
  s_add_u32 s26, s56, 65536
  v_add_u32 v244, s26, v4
  v_add_u32 v245, s26, v5
  v_add_u32 v246, s26, v6
  v_add_u32 v247, s26, v7
  s_load_dwordx16 s[80:95], s[76:77], 2048
  s_waitcnt lgkmcnt(0)
  s_and_b64 s[80:81], s[80:81], s[82:83]
  s_and_b64 s[84:85], s[84:85], s[86:87]
  s_and_b64 s[88:89], s[88:89], s[90:91]
  s_and_b64 s[92:93], s[92:93], s[94:95]
  s_and_b64 s[80:81], s[80:81], s[84:85]
  s_and_b64 s[88:89], s[88:89], s[92:93]
  s_and_b64 s[80:81], s[80:81], s[88:89]
  s_and_b32 s96, s80, s81
  s_load_dwordx16 s[80:95], s[78:79], 2048
  s_waitcnt lgkmcnt(0)
  s_and_b64 s[80:81], s[80:81], s[82:83]
  s_and_b64 s[84:85], s[84:85], s[86:87]
  s_and_b64 s[88:89], s[88:89], s[90:91]
  s_and_b64 s[92:93], s[92:93], s[94:95]
  s_and_b64 s[80:81], s[80:81], s[84:85]
  s_and_b64 s[88:89], s[88:89], s[92:93]
  s_and_b64 s[80:81], s[80:81], s[88:89]
  s_and_b32 s96, s96, s80
  s_and_b32 s96, s96, s81
  s_cmp_eq_u32 s96, 1
  s_cbranch_scc0 SQ_80
SQok_81:
  s_lshl_b32 s26, s22, 13
  s_sub_u32 s72, s75, s26
  s_lshl_b32 s26, s22, 10
  s_add_u32 s72, s72, s26
  s_add_u32 s72, s72, 28672
  s_cmp_ge_u32 s72, s39
  s_cselect_b32 s27, 229376, 0
  s_sub_u32 s72, s72, s27
  s_add_u32 m0, s26, 94208
  s_nop 0
  buffer_load_dwordx4 v2, s[4:7], s72 offen sc1 lds
  s_add_u32 s72, s75, 32768
  s_cmp_ge_u32 s72, s39
  s_cselect_b32 s27, 229376, 0
  s_sub_u32 s72, s72, s27
  s_lshl_b32 s26, s22, 13
  s_add_u32 m0, s26, 98304
  s_nop 0
  buffer_load_dwordx4 v2, s[4:7], s72 offen offset:0 sc1 lds
  buffer_load_dwordx4 v2, s[4:7], s72 offen offset:1024 sc1 lds
  buffer_load_dwordx4 v2, s[4:7], s72 offen offset:2048 sc1 lds
  buffer_load_dwordx4 v2, s[4:7], s72 offen offset:3072 sc1 lds
  s_add_u32 s72, s75, 36864
  s_cmp_ge_u32 s72, s39
  s_cselect_b32 s27, 229376, 0
  s_sub_u32 s72, s72, s27
  s_lshl_b32 s26, s22, 13
  s_add_u32 m0, s26, 102400
  s_nop 0
  buffer_load_dwordx4 v2, s[4:7], s72 offen offset:0 sc1 lds
  buffer_load_dwordx4 v2, s[4:7], s72 offen offset:1024 sc1 lds
  buffer_load_dwordx4 v2, s[4:7], s72 offen offset:2048 sc1 lds
  buffer_load_dwordx4 v2, s[4:7], s72 offen offset:3072 sc1 lds
  ds_read_b128 v[188:191], v244 offset:0
  ds_read_b128 v[192:195], v245 offset:0
  ds_read_b128 v[196:199], v246 offset:0
  ds_read_b128 v[200:203], v247 offset:0
  ds_read_b128 v[204:207], v244 offset:8192
  ds_read_b128 v[208:211], v245 offset:8192
  ds_read_b128 v[212:215], v246 offset:8192
  ds_read_b128 v[216:219], v247 offset:8192
  s_waitcnt lgkmcnt(4)
  v_mfma_f32_16x16x32_bf16 v[32:35], a[128:131], v[188:191], v[32:35]
  ds_read_b128 v[220:223], v244 offset:16384
  v_mfma_f32_16x16x32_bf16 v[36:39], a[128:131], v[192:195], v[36:39]
  ds_read_b128 v[224:227], v245 offset:16384
  v_mfma_f32_16x16x32_bf16 v[40:43], a[128:131], v[196:199], v[40:43]
  ds_read_b128 v[228:231], v246 offset:16384
  v_mfma_f32_16x16x32_bf16 v[44:47], a[128:131], v[200:203], v[44:47]
  ds_read_b128 v[232:235], v247 offset:16384
  s_add_u32 s72, s75, 65536
  s_cmp_ge_u32 s72, s39
  s_cselect_b32 s27, 229376, 0
  s_sub_u32 s72, s72, s27
  s_lshl_b32 s26, s22, 13
  s_add_u32 m0, s26, 0
  s_nop 0
  buffer_load_dwordx4 v2, s[4:7], s72 offen offset:0 sc1 lds
  v_mfma_f32_16x16x32_bf16 v[104:107], a[132:135], v[188:191], 0
  v_mfma_f32_16x16x32_bf16 v[108:111], a[132:135], v[192:195], 0
  v_mfma_f32_16x16x32_bf16 v[112:115], a[132:135], v[196:199], 0
  v_mfma_f32_16x16x32_bf16 v[116:119], a[132:135], v[200:203], 0
  buffer_load_dwordx4 v2, s[4:7], s72 offen offset:1024 sc1 lds
  s_waitcnt vmcnt(10)
  s_barrier
  s_waitcnt lgkmcnt(4)
  v_mfma_f32_16x16x32_bf16 v[32:35], a[136:139], v[204:207], v[32:35]
  ds_read_b128 v[188:191], v244 offset:24576
  v_mfma_f32_16x16x32_bf16 v[36:39], a[136:139], v[208:211], v[36:39]
  ds_read_b128 v[192:195], v245 offset:24576
  v_mfma_f32_16x16x32_bf16 v[40:43], a[136:139], v[212:215], v[40:43]
  ds_read_b128 v[196:199], v246 offset:24576
  v_mfma_f32_16x16x32_bf16 v[44:47], a[136:139], v[216:219], v[44:47]
  ds_read_b128 v[200:203], v247 offset:24576
  buffer_load_dwordx4 v2, s[4:7], s72 offen offset:2048 sc1 lds
  v_mfma_f32_16x16x32_bf16 v[104:107], a[140:143], v[204:207], v[104:107]
  v_mfma_f32_16x16x32_bf16 v[108:111], a[140:143], v[208:211], v[108:111]
  v_mfma_f32_16x16x32_bf16 v[112:115], a[140:143], v[212:215], v[112:115]
  v_mfma_f32_16x16x32_bf16 v[116:119], a[140:143], v[216:219], v[116:119]
  buffer_load_dwordx4 v2, s[4:7], s72 offen offset:3072 sc1 lds
  s_waitcnt vmcnt(4)
  s_barrier
  s_add_u32 s26, s56, 98304
  v_add_u32 v248, s26, v4
  v_add_u32 v249, s26, v5
  v_add_u32 v252, s26, v6
  v_add_u32 v255, s26, v7
  s_waitcnt lgkmcnt(4)
  v_mfma_f32_16x16x32_bf16 v[32:35], a[144:147], v[220:223], v[32:35]
  ds_read_b128 v[204:207], v248 offset:0
  v_mfma_f32_16x16x32_bf16 v[36:39], a[144:147], v[224:227], v[36:39]
  ds_read_b128 v[208:211], v249 offset:0
  v_mfma_f32_16x16x32_bf16 v[40:43], a[144:147], v[228:231], v[40:43]
  ds_read_b128 v[212:215], v252 offset:0
  v_mfma_f32_16x16x32_bf16 v[44:47], a[144:147], v[232:235], v[44:47]
  ds_read_b128 v[216:219], v255 offset:0
  s_add_u32 s72, s75, 69632
  s_cmp_ge_u32 s72, s39
  s_cselect_b32 s27, 229376, 0
  s_sub_u32 s72, s72, s27
  s_lshl_b32 s26, s22, 13
  s_add_u32 m0, s26, 4096
  s_nop 0
  buffer_load_dwordx4 v2, s[4:7], s72 offen offset:0 sc1 lds
  v_mfma_f32_16x16x32_bf16 v[104:107], a[148:151], v[220:223], v[104:107]
  v_mfma_f32_16x16x32_bf16 v[108:111], a[148:151], v[224:227], v[108:111]
  v_mfma_f32_16x16x32_bf16 v[112:115], a[148:151], v[228:231], v[112:115]
  v_mfma_f32_16x16x32_bf16 v[116:119], a[148:151], v[232:235], v[116:119]
  buffer_load_dwordx4 v2, s[4:7], s72 offen offset:1024 sc1 lds
  s_waitcnt lgkmcnt(4)
  v_mfma_f32_16x16x32_bf16 v[32:35], a[152:155], v[188:191], v[32:35]
  ds_read_b128 v[220:223], v248 offset:8192
  v_mfma_f32_16x16x32_bf16 v[36:39], a[152:155], v[192:195], v[36:39]
  ds_read_b128 v[224:227], v249 offset:8192
  v_mfma_f32_16x16x32_bf16 v[40:43], a[152:155], v[196:199], v[40:43]
  ds_read_b128 v[228:231], v252 offset:8192
  v_mfma_f32_16x16x32_bf16 v[44:47], a[152:155], v[200:203], v[44:47]
  ds_read_b128 v[232:235], v255 offset:8192
  buffer_load_dwordx4 v2, s[4:7], s72 offen offset:2048 sc1 lds
  v_mfma_f32_16x16x32_bf16 v[104:107], a[156:159], v[188:191], v[104:107]
  v_mfma_f32_16x16x32_bf16 v[108:111], a[156:159], v[192:195], v[108:111]
  v_mfma_f32_16x16x32_bf16 v[112:115], a[156:159], v[196:199], v[112:115]
  v_mfma_f32_16x16x32_bf16 v[116:119], a[156:159], v[200:203], v[116:119]
  buffer_load_dwordx4 v2, s[4:7], s72 offen offset:3072 sc1 lds
  s_waitcnt lgkmcnt(4)
  v_mfma_f32_16x16x32_bf16 v[32:35], a[160:163], v[204:207], v[32:35]
  ds_read_b128 v[188:191], v248 offset:16384
  v_mfma_f32_16x16x32_bf16 v[36:39], a[160:163], v[208:211], v[36:39]
  ds_read_b128 v[192:195], v249 offset:16384
  v_mfma_f32_16x16x32_bf16 v[40:43], a[160:163], v[212:215], v[40:43]
  ds_read_b128 v[196:199], v252 offset:16384
  v_mfma_f32_16x16x32_bf16 v[44:47], a[160:163], v[216:219], v[44:47]
  ds_read_b128 v[200:203], v255 offset:16384
  s_add_u32 s72, s75, 98304
  s_cmp_ge_u32 s72, s39
  s_cselect_b32 s27, 229376, 0
  s_sub_u32 s72, s72, s27
  s_lshl_b32 s26, s22, 13
  s_add_u32 m0, s26, 32768
  s_nop 0
  buffer_load_dwordx4 v2, s[4:7], s72 offen offset:0 sc1 lds
  v_mfma_f32_16x16x32_bf16 v[104:107], a[164:167], v[204:207], v[104:107]
  v_mfma_f32_16x16x32_bf16 v[108:111], a[164:167], v[208:211], v[108:111]
  v_mfma_f32_16x16x32_bf16 v[112:115], a[164:167], v[212:215], v[112:115]
  v_mfma_f32_16x16x32_bf16 v[116:119], a[164:167], v[216:219], v[116:119]
  buffer_load_dwordx4 v2, s[4:7], s72 offen offset:1024 sc1 lds
  s_waitcnt lgkmcnt(4)
  v_mfma_f32_16x16x32_bf16 v[32:35], a[168:171], v[220:223], v[32:35]
  ds_read_b128 v[204:207], v248 offset:24576
  v_mfma_f32_16x16x32_bf16 v[36:39], a[168:171], v[224:227], v[36:39]
  ds_read_b128 v[208:211], v249 offset:24576
  v_mfma_f32_16x16x32_bf16 v[40:43], a[168:171], v[228:231], v[40:43]
  ds_read_b128 v[212:215], v252 offset:24576
  v_mfma_f32_16x16x32_bf16 v[44:47], a[168:171], v[232:235], v[44:47]
  ds_read_b128 v[216:219], v255 offset:24576
  buffer_load_dwordx4 v2, s[4:7], s72 offen offset:2048 sc1 lds
  v_mfma_f32_16x16x32_bf16 v[104:107], a[172:175], v[220:223], v[104:107]
  v_mfma_f32_16x16x32_bf16 v[108:111], a[172:175], v[224:227], v[108:111]
  v_mfma_f32_16x16x32_bf16 v[112:115], a[172:175], v[228:231], v[112:115]
  v_mfma_f32_16x16x32_bf16 v[116:119], a[172:175], v[232:235], v[116:119]
  buffer_load_dwordx4 v2, s[4:7], s72 offen offset:3072 sc1 lds
  s_waitcnt vmcnt(4)
  s_barrier
  s_add_u32 s26, s56, 0
  v_add_u32 v244, s26, v4
  v_add_u32 v245, s26, v5
  v_add_u32 v246, s26, v6
  v_add_u32 v247, s26, v7
  s_waitcnt lgkmcnt(4)
  v_mfma_f32_16x16x32_bf16 v[32:35], a[176:179], v[188:191], v[32:35]
  ds_read_b128 v[220:223], v244 offset:0
  v_mfma_f32_16x16x32_bf16 v[36:39], a[176:179], v[192:195], v[36:39]
  ds_read_b128 v[224:227], v245 offset:0
  v_mfma_f32_16x16x32_bf16 v[40:43], a[176:179], v[196:199], v[40:43]
  ds_read_b128 v[228:231], v246 offset:0
  v_mfma_f32_16x16x32_bf16 v[44:47], a[176:179], v[200:203], v[44:47]
  ds_read_b128 v[232:235], v247 offset:0
  s_add_u32 s72, s75, 102400
  s_cmp_ge_u32 s72, s39
  s_cselect_b32 s27, 229376, 0
  s_sub_u32 s72, s72, s27
  s_lshl_b32 s26, s22, 13
  s_add_u32 m0, s26, 36864
  s_nop 0
  buffer_load_dwordx4 v2, s[4:7], s72 offen offset:0 sc1 lds
  v_mfma_f32_16x16x32_bf16 v[104:107], a[180:183], v[188:191], v[104:107]
  v_mfma_f32_16x16x32_bf16 v[108:111], a[180:183], v[192:195], v[108:111]
  v_mfma_f32_16x16x32_bf16 v[112:115], a[180:183], v[196:199], v[112:115]
  v_mfma_f32_16x16x32_bf16 v[116:119], a[180:183], v[200:203], v[116:119]
  buffer_load_dwordx4 v2, s[4:7], s72 offen offset:1024 sc1 lds
  s_waitcnt lgkmcnt(4)
  v_mfma_f32_16x16x32_bf16 v[32:35], a[184:187], v[204:207], v[32:35]
  ds_read_b128 v[188:191], v244 offset:8192
  v_mfma_f32_16x16x32_bf16 v[36:39], a[184:187], v[208:211], v[36:39]
  ds_read_b128 v[192:195], v245 offset:8192
  v_mfma_f32_16x16x32_bf16 v[40:43], a[184:187], v[212:215], v[40:43]
  ds_read_b128 v[196:199], v246 offset:8192
  v_mfma_f32_16x16x32_bf16 v[44:47], a[184:187], v[216:219], v[44:47]
  ds_read_b128 v[200:203], v247 offset:8192
  buffer_load_dwordx4 v2, s[4:7], s72 offen offset:2048 sc1 lds
  v_mfma_f32_16x16x32_bf16 v[104:107], a[188:191], v[204:207], v[104:107]
  v_mfma_f32_16x16x32_bf16 v[108:111], a[188:191], v[208:211], v[108:111]
  v_mfma_f32_16x16x32_bf16 v[112:115], a[188:191], v[212:215], v[112:115]
  v_mfma_f32_16x16x32_bf16 v[116:119], a[188:191], v[216:219], v[116:119]
  buffer_load_dwordx4 v2, s[4:7], s72 offen offset:3072 sc1 lds
  s_waitcnt lgkmcnt(4)
  v_mfma_f32_16x16x32_bf16 v[32:35], a[192:195], v[220:223], v[32:35]
  ds_read_b128 v[204:207], v244 offset:16384
  v_mfma_f32_16x16x32_bf16 v[36:39], a[192:195], v[224:227], v[36:39]
  ds_read_b128 v[208:211], v245 offset:16384
  v_mfma_f32_16x16x32_bf16 v[40:43], a[192:195], v[228:231], v[40:43]
  ds_read_b128 v[212:215], v246 offset:16384
  v_mfma_f32_16x16x32_bf16 v[44:47], a[192:195], v[232:235], v[44:47]
  ds_read_b128 v[216:219], v247 offset:16384
  s_add_u32 s72, s75, 131072
  s_cmp_ge_u32 s72, s39
  s_cselect_b32 s27, 229376, 0
  s_sub_u32 s72, s72, s27
  s_lshl_b32 s26, s22, 13
  s_add_u32 m0, s26, 65536
  s_nop 0
  buffer_load_dwordx4 v2, s[4:7], s72 offen offset:0 sc1 lds
  v_mfma_f32_16x16x32_bf16 v[104:107], a[196:199], v[220:223], v[104:107]
  v_mfma_f32_16x16x32_bf16 v[108:111], a[196:199], v[224:227], v[108:111]
  v_mfma_f32_16x16x32_bf16 v[112:115], a[196:199], v[228:231], v[112:115]
  v_mfma_f32_16x16x32_bf16 v[116:119], a[196:199], v[232:235], v[116:119]
  buffer_load_dwordx4 v2, s[4:7], s72 offen offset:1024 sc1 lds
  s_waitcnt lgkmcnt(4)
  v_mfma_f32_16x16x32_bf16 v[32:35], a[200:203], v[188:191], v[32:35]
  ds_read_b128 v[220:223], v244 offset:24576
  v_mfma_f32_16x16x32_bf16 v[36:39], a[200:203], v[192:195], v[36:39]
  ds_read_b128 v[224:227], v245 offset:24576
  v_mfma_f32_16x16x32_bf16 v[40:43], a[200:203], v[196:199], v[40:43]
  ds_read_b128 v[228:231], v246 offset:24576
  v_mfma_f32_16x16x32_bf16 v[44:47], a[200:203], v[200:203], v[44:47]
  ds_read_b128 v[232:235], v247 offset:24576
  buffer_load_dwordx4 v2, s[4:7], s72 offen offset:2048 sc1 lds
  v_mfma_f32_16x16x32_bf16 v[104:107], a[204:207], v[188:191], v[104:107]
  v_mfma_f32_16x16x32_bf16 v[108:111], a[204:207], v[192:195], v[108:111]
  v_mfma_f32_16x16x32_bf16 v[112:115], a[204:207], v[196:199], v[112:115]
  v_mfma_f32_16x16x32_bf16 v[116:119], a[204:207], v[200:203], v[116:119]
  buffer_load_dwordx4 v2, s[4:7], s72 offen offset:3072 sc1 lds
  s_waitcnt vmcnt(4)
  s_barrier
  s_add_u32 s26, s56, 32768
  v_add_u32 v248, s26, v4
  v_add_u32 v249, s26, v5
  v_add_u32 v252, s26, v6
  v_add_u32 v255, s26, v7
  s_waitcnt lgkmcnt(4)
  v_mfma_f32_16x16x32_bf16 v[32:35], a[208:211], v[204:207], v[32:35]
  ds_read_b128 v[188:191], v248 offset:0
  v_mfma_f32_16x16x32_bf16 v[36:39], a[208:211], v[208:211], v[36:39]
  ds_read_b128 v[192:195], v249 offset:0
  v_mfma_f32_16x16x32_bf16 v[40:43], a[208:211], v[212:215], v[40:43]
  ds_read_b128 v[196:199], v252 offset:0
  v_mfma_f32_16x16x32_bf16 v[44:47], a[208:211], v[216:219], v[44:47]
  ds_read_b128 v[200:203], v255 offset:0
  s_add_u32 s72, s75, 135168
  s_cmp_ge_u32 s72, s39
  s_cselect_b32 s27, 229376, 0
  s_sub_u32 s72, s72, s27
  s_lshl_b32 s26, s22, 13
  s_add_u32 m0, s26, 69632
  s_nop 0
  buffer_load_dwordx4 v2, s[4:7], s72 offen offset:0 sc1 lds
  v_mfma_f32_16x16x32_bf16 v[104:107], a[212:215], v[204:207], v[104:107]
  v_mfma_f32_16x16x32_bf16 v[108:111], a[212:215], v[208:211], v[108:111]
  v_mfma_f32_16x16x32_bf16 v[112:115], a[212:215], v[212:215], v[112:115]
  v_mfma_f32_16x16x32_bf16 v[116:119], a[212:215], v[216:219], v[116:119]
  buffer_load_dwordx4 v2, s[4:7], s72 offen offset:1024 sc1 lds
  s_waitcnt lgkmcnt(4)
  v_mfma_f32_16x16x32_bf16 v[32:35], a[216:219], v[220:223], v[32:35]
  ds_read_b128 v[204:207], v248 offset:8192
  v_mfma_f32_16x16x32_bf16 v[36:39], a[216:219], v[224:227], v[36:39]
  ds_read_b128 v[208:211], v249 offset:8192
  v_mfma_f32_16x16x32_bf16 v[40:43], a[216:219], v[228:231], v[40:43]
  ds_read_b128 v[212:215], v252 offset:8192
  v_mfma_f32_16x16x32_bf16 v[44:47], a[216:219], v[232:235], v[44:47]
  ds_read_b128 v[216:219], v255 offset:8192
  buffer_load_dwordx4 v2, s[4:7], s72 offen offset:2048 sc1 lds
  v_mfma_f32_16x16x32_bf16 v[104:107], a[220:223], v[220:223], v[104:107]
  v_mfma_f32_16x16x32_bf16 v[108:111], a[220:223], v[224:227], v[108:111]
  v_mfma_f32_16x16x32_bf16 v[112:115], a[220:223], v[228:231], v[112:115]
  v_mfma_f32_16x16x32_bf16 v[116:119], a[220:223], v[232:235], v[116:119]
  buffer_load_dwordx4 v2, s[4:7], s72 offen offset:3072 sc1 lds
  s_waitcnt lgkmcnt(4)
  v_mfma_f32_16x16x32_bf16 v[32:35], a[224:227], v[188:191], v[32:35]
  ds_read_b128 v[220:223], v248 offset:16384
  v_mfma_f32_16x16x32_bf16 v[36:39], a[224:227], v[192:195], v[36:39]
  ds_read_b128 v[224:227], v249 offset:16384
  v_mfma_f32_16x16x32_bf16 v[40:43], a[224:227], v[196:199], v[40:43]
  ds_read_b128 v[228:231], v252 offset:16384
  v_mfma_f32_16x16x32_bf16 v[44:47], a[224:227], v[200:203], v[44:47]
  ds_read_b128 v[232:235], v255 offset:16384
  s_add_u32 s72, s75, 163840
  s_cmp_ge_u32 s72, s39
  s_cselect_b32 s27, 229376, 0
  s_sub_u32 s72, s72, s27
  s_lshl_b32 s26, s22, 13
  s_add_u32 m0, s26, 98304
  s_nop 0
  buffer_load_dwordx4 v2, s[4:7], s72 offen offset:0 sc1 lds
  v_mfma_f32_16x16x32_bf16 v[104:107], a[228:231], v[188:191], v[104:107]
  v_mfma_f32_16x16x32_bf16 v[108:111], a[228:231], v[192:195], v[108:111]
  v_mfma_f32_16x16x32_bf16 v[112:115], a[228:231], v[196:199], v[112:115]
  v_mfma_f32_16x16x32_bf16 v[116:119], a[228:231], v[200:203], v[116:119]
  buffer_load_dwordx4 v2, s[4:7], s72 offen offset:1024 sc1 lds
  s_waitcnt lgkmcnt(4)
  v_mfma_f32_16x16x32_bf16 v[32:35], a[232:235], v[204:207], v[32:35]
  ds_read_b128 v[188:191], v248 offset:24576
  v_mfma_f32_16x16x32_bf16 v[36:39], a[232:235], v[208:211], v[36:39]
  ds_read_b128 v[192:195], v249 offset:24576
  v_mfma_f32_16x16x32_bf16 v[40:43], a[232:235], v[212:215], v[40:43]
  ds_read_b128 v[196:199], v252 offset:24576
  v_mfma_f32_16x16x32_bf16 v[44:47], a[232:235], v[216:219], v[44:47]
  ds_read_b128 v[200:203], v255 offset:24576
  buffer_load_dwordx4 v2, s[4:7], s72 offen offset:2048 sc1 lds
  v_mfma_f32_16x16x32_bf16 v[104:107], a[236:239], v[204:207], v[104:107]
  v_mfma_f32_16x16x32_bf16 v[108:111], a[236:239], v[208:211], v[108:111]
  v_mfma_f32_16x16x32_bf16 v[112:115], a[236:239], v[212:215], v[112:115]
  v_mfma_f32_16x16x32_bf16 v[116:119], a[236:239], v[216:219], v[116:119]
  buffer_load_dwordx4 v2, s[4:7], s72 offen offset:3072 sc1 lds
  s_waitcnt vmcnt(4)
  s_barrier
  s_add_u32 s26, s56, 65536
  v_add_u32 v244, s26, v4
  v_add_u32 v245, s26, v5
  v_add_u32 v246, s26, v6
  v_add_u32 v247, s26, v7
  s_waitcnt lgkmcnt(4)
  v_mfma_f32_16x16x32_bf16 v[32:35], a[240:243], v[220:223], v[32:35]
  ds_read_b128 v[204:207], v244 offset:0
  v_mfma_f32_16x16x32_bf16 v[36:39], a[240:243], v[224:227], v[36:39]
  ds_read_b128 v[208:211], v245 offset:0
  v_mfma_f32_16x16x32_bf16 v[40:43], a[240:243], v[228:231], v[40:43]
  ds_read_b128 v[212:215], v246 offset:0
  v_mfma_f32_16x16x32_bf16 v[44:47], a[240:243], v[232:235], v[44:47]
  ds_read_b128 v[216:219], v247 offset:0
  s_add_u32 s72, s75, 167936
  s_cmp_ge_u32 s72, s39
  s_cselect_b32 s27, 229376, 0
  s_sub_u32 s72, s72, s27
  s_lshl_b32 s26, s22, 13
  s_add_u32 m0, s26, 102400
  s_nop 0
  buffer_load_dwordx4 v2, s[4:7], s72 offen offset:0 sc1 lds
  v_mfma_f32_16x16x32_bf16 v[104:107], a[244:247], v[220:223], v[104:107]
  v_mfma_f32_16x16x32_bf16 v[108:111], a[244:247], v[224:227], v[108:111]
  v_mfma_f32_16x16x32_bf16 v[112:115], a[244:247], v[228:231], v[112:115]
  v_mfma_f32_16x16x32_bf16 v[116:119], a[244:247], v[232:235], v[116:119]
  buffer_load_dwordx4 v2, s[4:7], s72 offen offset:1024 sc1 lds
  s_waitcnt lgkmcnt(4)
  v_mfma_f32_16x16x32_bf16 v[32:35], a[248:251], v[188:191], v[32:35]
  ds_read_b128 v[220:223], v244 offset:8192
  v_mfma_f32_16x16x32_bf16 v[36:39], a[248:251], v[192:195], v[36:39]
  ds_read_b128 v[224:227], v245 offset:8192
  v_mfma_f32_16x16x32_bf16 v[40:43], a[248:251], v[196:199], v[40:43]
  ds_read_b128 v[228:231], v246 offset:8192
  v_mfma_f32_16x16x32_bf16 v[44:47], a[248:251], v[200:203], v[44:47]
  ds_read_b128 v[232:235], v247 offset:8192
  buffer_load_dwordx4 v2, s[4:7], s72 offen offset:2048 sc1 lds
  v_mfma_f32_16x16x32_bf16 v[104:107], a[252:255], v[188:191], v[104:107]
  v_mfma_f32_16x16x32_bf16 v[108:111], a[252:255], v[192:195], v[108:111]
  v_mfma_f32_16x16x32_bf16 v[112:115], a[252:255], v[196:199], v[112:115]
  v_mfma_f32_16x16x32_bf16 v[116:119], a[252:255], v[200:203], v[116:119]
  buffer_load_dwordx4 v2, s[4:7], s72 offen offset:3072 sc1 lds
  s_waitcnt lgkmcnt(4)
  v_mfma_f32_16x16x32_bf16 v[32:35], a[0:3], v[204:207], v[32:35]
  ds_read_b128 v[188:191], v244 offset:16384
  v_mfma_f32_16x16x32_bf16 v[36:39], a[0:3], v[208:211], v[36:39]
  ds_read_b128 v[192:195], v245 offset:16384
  v_mfma_f32_16x16x32_bf16 v[40:43], a[0:3], v[212:215], v[40:43]
  ds_read_b128 v[196:199], v246 offset:16384
  v_mfma_f32_16x16x32_bf16 v[44:47], a[0:3], v[216:219], v[44:47]
  ds_read_b128 v[200:203], v247 offset:16384
  s_add_u32 s72, s75, 196608
  s_cmp_ge_u32 s72, s39
  s_cselect_b32 s27, 229376, 0
  s_sub_u32 s72, s72, s27
  s_lshl_b32 s26, s22, 13
  s_add_u32 m0, s26, 0
  s_nop 0
  buffer_load_dwordx4 v2, s[4:7], s72 offen offset:0 sc1 lds
  v_mfma_f32_16x16x32_bf16 v[104:107], a[4:7], v[204:207], v[104:107]
  v_mfma_f32_16x16x32_bf16 v[108:111], a[4:7], v[208:211], v[108:111]
  v_mfma_f32_16x16x32_bf16 v[112:115], a[4:7], v[212:215], v[112:115]
  v_mfma_f32_16x16x32_bf16 v[116:119], a[4:7], v[216:219], v[116:119]
  buffer_load_dwordx4 v2, s[4:7], s72 offen offset:1024 sc1 lds
  s_waitcnt lgkmcnt(4)
  v_mfma_f32_16x16x32_bf16 v[32:35], a[8:11], v[220:223], v[32:35]
  ds_read_b128 v[204:207], v244 offset:24576
  v_mfma_f32_16x16x32_bf16 v[36:39], a[8:11], v[224:227], v[36:39]
  ds_read_b128 v[208:211], v245 offset:24576
  v_mfma_f32_16x16x32_bf16 v[40:43], a[8:11], v[228:231], v[40:43]
  ds_read_b128 v[212:215], v246 offset:24576
  v_mfma_f32_16x16x32_bf16 v[44:47], a[8:11], v[232:235], v[44:47]
  ds_read_b128 v[216:219], v247 offset:24576
  buffer_load_dwordx4 v2, s[4:7], s72 offen offset:2048 sc1 lds
  v_mfma_f32_16x16x32_bf16 v[104:107], a[12:15], v[220:223], v[104:107]
  v_mfma_f32_16x16x32_bf16 v[108:111], a[12:15], v[224:227], v[108:111]
  v_mfma_f32_16x16x32_bf16 v[112:115], a[12:15], v[228:231], v[112:115]
  v_mfma_f32_16x16x32_bf16 v[116:119], a[12:15], v[232:235], v[116:119]
  buffer_load_dwordx4 v2, s[4:7], s72 offen offset:3072 sc1 lds
  s_waitcnt vmcnt(4)
  s_barrier
  s_add_u32 s26, s56, 98304
  v_add_u32 v248, s26, v4
  v_add_u32 v249, s26, v5
  v_add_u32 v252, s26, v6
  v_add_u32 v255, s26, v7
  s_waitcnt lgkmcnt(4)
  v_mfma_f32_16x16x32_bf16 v[32:35], a[16:19], v[188:191], v[32:35]
  ds_read_b128 v[220:223], v248 offset:0
  v_mfma_f32_16x16x32_bf16 v[36:39], a[16:19], v[192:195], v[36:39]
  ds_read_b128 v[224:227], v249 offset:0
  v_mfma_f32_16x16x32_bf16 v[40:43], a[16:19], v[196:199], v[40:43]
  ds_read_b128 v[228:231], v252 offset:0
  v_mfma_f32_16x16x32_bf16 v[44:47], a[16:19], v[200:203], v[44:47]
  ds_read_b128 v[232:235], v255 offset:0
  s_add_u32 s72, s75, 200704
  s_cmp_ge_u32 s72, s39
  s_cselect_b32 s27, 229376, 0
  s_sub_u32 s72, s72, s27
  s_lshl_b32 s26, s22, 13
  s_add_u32 m0, s26, 4096
  s_nop 0
  buffer_load_dwordx4 v2, s[4:7], s72 offen offset:0 sc1 lds
  v_mfma_f32_16x16x32_bf16 v[104:107], a[20:23], v[188:191], v[104:107]
  v_mfma_f32_16x16x32_bf16 v[108:111], a[20:23], v[192:195], v[108:111]
  v_mfma_f32_16x16x32_bf16 v[112:115], a[20:23], v[196:199], v[112:115]
  v_mfma_f32_16x16x32_bf16 v[116:119], a[20:23], v[200:203], v[116:119]
  buffer_load_dwordx4 v2, s[4:7], s72 offen offset:1024 sc1 lds
  s_add_u32 s74, s33, 2560
  v_lshlrev_b32 v251, 7, v1
  s_mov_b64 exec, 15
  buffer_load_dword v250, v251, s[4:7], s74 offen
  s_mov_b64 exec, -1
  s_waitcnt lgkmcnt(4)
  v_mfma_f32_16x16x32_bf16 v[32:35], a[24:27], v[204:207], v[32:35]
  ds_read_b128 v[188:191], v248 offset:8192
  v_mfma_f32_16x16x32_bf16 v[36:39], a[24:27], v[208:211], v[36:39]
  ds_read_b128 v[192:195], v249 offset:8192
  v_mfma_f32_16x16x32_bf16 v[40:43], a[24:27], v[212:215], v[40:43]
  ds_read_b128 v[196:199], v252 offset:8192
  v_mfma_f32_16x16x32_bf16 v[44:47], a[24:27], v[216:219], v[44:47]
  ds_read_b128 v[200:203], v255 offset:8192
  buffer_load_dwordx4 v2, s[4:7], s72 offen offset:2048 sc1 lds
  v_mfma_f32_16x16x32_bf16 v[104:107], a[28:31], v[204:207], v[104:107]
  v_mfma_f32_16x16x32_bf16 v[108:111], a[28:31], v[208:211], v[108:111]
  v_mfma_f32_16x16x32_bf16 v[112:115], a[28:31], v[212:215], v[112:115]
  v_mfma_f32_16x16x32_bf16 v[116:119], a[28:31], v[216:219], v[116:119]
  buffer_load_dwordx4 v2, s[4:7], s72 offen offset:3072 sc1 lds
  s_waitcnt lgkmcnt(4)
  v_mfma_f32_16x16x32_bf16 v[32:35], a[32:35], v[220:223], v[32:35]
  ds_read_b128 v[204:207], v248 offset:16384
  v_mfma_f32_16x16x32_bf16 v[36:39], a[32:35], v[224:227], v[36:39]
  ds_read_b128 v[208:211], v249 offset:16384
  v_mfma_f32_16x16x32_bf16 v[40:43], a[32:35], v[228:231], v[40:43]
  ds_read_b128 v[212:215], v252 offset:16384
  v_mfma_f32_16x16x32_bf16 v[44:47], a[32:35], v[232:235], v[44:47]
  ds_read_b128 v[216:219], v255 offset:16384
  buffer_load_dwordx4 a[124:127], v2, s[4:7], s25 offen offset:3072
  v_mfma_f32_16x16x32_bf16 v[104:107], a[36:39], v[220:223], v[104:107]
  v_mfma_f32_16x16x32_bf16 v[108:111], a[36:39], v[224:227], v[108:111]
  v_mfma_f32_16x16x32_bf16 v[112:115], a[36:39], v[228:231], v[112:115]
  v_mfma_f32_16x16x32_bf16 v[116:119], a[36:39], v[232:235], v[116:119]
  s_add_u32 s25, s25, 4096
  buffer_load_dwordx4 a[128:131], v2, s[4:7], s25 offen offset:0
  s_waitcnt lgkmcnt(4)
  v_mfma_f32_16x16x32_bf16 v[32:35], a[40:43], v[188:191], v[32:35]
  ds_read_b128 v[220:223], v248 offset:24576
  v_mfma_f32_16x16x32_bf16 v[36:39], a[40:43], v[192:195], v[36:39]
  ds_read_b128 v[224:227], v249 offset:24576
  v_mfma_f32_16x16x32_bf16 v[40:43], a[40:43], v[196:199], v[40:43]
  ds_read_b128 v[228:231], v252 offset:24576
  v_mfma_f32_16x16x32_bf16 v[44:47], a[40:43], v[200:203], v[44:47]
  ds_read_b128 v[232:235], v255 offset:24576
  buffer_load_dwordx4 a[132:135], v2, s[4:7], s25 offen offset:1024
  v_mfma_f32_16x16x32_bf16 v[104:107], a[44:47], v[188:191], v[104:107]
  v_mfma_f32_16x16x32_bf16 v[108:111], a[44:47], v[192:195], v[108:111]
  v_mfma_f32_16x16x32_bf16 v[112:115], a[44:47], v[196:199], v[112:115]
  v_mfma_f32_16x16x32_bf16 v[116:119], a[44:47], v[200:203], v[116:119]
  buffer_load_dwordx4 a[136:139], v2, s[4:7], s25 offen offset:2048
  s_waitcnt vmcnt(4)
  s_barrier
  s_add_u32 s26, s56, 0
  v_add_u32 v244, s26, v4
  v_add_u32 v245, s26, v5
  v_add_u32 v246, s26, v6
  v_add_u32 v247, s26, v7
  s_waitcnt lgkmcnt(4)
  v_mfma_f32_16x16x32_bf16 v[32:35], a[48:51], v[204:207], v[32:35]
  ds_read_b128 v[188:191], v244 offset:0
  v_mfma_f32_16x16x32_bf16 v[36:39], a[48:51], v[208:211], v[36:39]
  ds_read_b128 v[192:195], v245 offset:0
  v_mfma_f32_16x16x32_bf16 v[40:43], a[48:51], v[212:215], v[40:43]
  ds_read_b128 v[196:199], v246 offset:0
  v_mfma_f32_16x16x32_bf16 v[44:47], a[48:51], v[216:219], v[44:47]
  ds_read_b128 v[200:203], v247 offset:0
  buffer_load_dwordx4 a[140:143], v2, s[4:7], s25 offen offset:3072
  v_mfma_f32_16x16x32_bf16 v[104:107], a[52:55], v[204:207], v[104:107]
  v_mfma_f32_16x16x32_bf16 v[108:111], a[52:55], v[208:211], v[108:111]
  v_mfma_f32_16x16x32_bf16 v[112:115], a[52:55], v[212:215], v[112:115]
  v_mfma_f32_16x16x32_bf16 v[116:119], a[52:55], v[216:219], v[116:119]
  s_add_u32 s25, s25, 4096
  buffer_load_dwordx4 a[144:147], v2, s[4:7], s25 offen offset:0
  s_waitcnt lgkmcnt(4)
  v_mfma_f32_16x16x32_bf16 v[32:35], a[56:59], v[220:223], v[32:35]
  ds_read_b128 v[204:207], v244 offset:8192
  v_mfma_f32_16x16x32_bf16 v[36:39], a[56:59], v[224:227], v[36:39]
  ds_read_b128 v[208:211], v245 offset:8192
  v_mfma_f32_16x16x32_bf16 v[40:43], a[56:59], v[228:231], v[40:43]
  ds_read_b128 v[212:215], v246 offset:8192
  v_mfma_f32_16x16x32_bf16 v[44:47], a[56:59], v[232:235], v[44:47]
  ds_read_b128 v[216:219], v247 offset:8192
  buffer_load_dwordx4 a[148:151], v2, s[4:7], s25 offen offset:1024
  v_mfma_f32_16x16x32_bf16 v[104:107], a[60:63], v[220:223], v[104:107]
  v_mfma_f32_16x16x32_bf16 v[108:111], a[60:63], v[224:227], v[108:111]
  v_mfma_f32_16x16x32_bf16 v[112:115], a[60:63], v[228:231], v[112:115]
  v_mfma_f32_16x16x32_bf16 v[116:119], a[60:63], v[232:235], v[116:119]
  buffer_load_dwordx4 a[152:155], v2, s[4:7], s25 offen offset:2048
  s_waitcnt lgkmcnt(4)
  v_mfma_f32_16x16x32_bf16 v[32:35], a[64:67], v[188:191], v[32:35]
  ds_read_b128 v[220:223], v244 offset:16384
  v_mfma_f32_16x16x32_bf16 v[36:39], a[64:67], v[192:195], v[36:39]
  ds_read_b128 v[224:227], v245 offset:16384
  v_mfma_f32_16x16x32_bf16 v[40:43], a[64:67], v[196:199], v[40:43]
  ds_read_b128 v[228:231], v246 offset:16384
  v_mfma_f32_16x16x32_bf16 v[44:47], a[64:67], v[200:203], v[44:47]
  ds_read_b128 v[232:235], v247 offset:16384
  buffer_load_dwordx4 a[156:159], v2, s[4:7], s25 offen offset:3072
  v_mfma_f32_16x16x32_bf16 v[104:107], a[68:71], v[188:191], v[104:107]
  v_mfma_f32_16x16x32_bf16 v[108:111], a[68:71], v[192:195], v[108:111]
  v_mfma_f32_16x16x32_bf16 v[112:115], a[68:71], v[196:199], v[112:115]
  v_mfma_f32_16x16x32_bf16 v[116:119], a[68:71], v[200:203], v[116:119]
  s_add_u32 s25, s25, 4096
  buffer_load_dwordx4 a[160:163], v2, s[4:7], s25 offen offset:0
  s_waitcnt lgkmcnt(4)
  v_mfma_f32_16x16x32_bf16 v[32:35], a[72:75], v[204:207], v[32:35]
  ds_read_b128 v[188:191], v244 offset:24576
  v_mfma_f32_16x16x32_bf16 v[36:39], a[72:75], v[208:211], v[36:39]
  ds_read_b128 v[192:195], v245 offset:24576
  v_mfma_f32_16x16x32_bf16 v[40:43], a[72:75], v[212:215], v[40:43]
  ds_read_b128 v[196:199], v246 offset:24576
  v_mfma_f32_16x16x32_bf16 v[44:47], a[72:75], v[216:219], v[44:47]
  ds_read_b128 v[200:203], v247 offset:24576
  v_mfma_f32_16x16x32_bf16 v[104:107], a[76:79], v[204:207], v[104:107]
  v_mfma_f32_16x16x32_bf16 v[108:111], a[76:79], v[208:211], v[108:111]
  v_mfma_f32_16x16x32_bf16 v[112:115], a[76:79], v[212:215], v[112:115]
  v_mfma_f32_16x16x32_bf16 v[116:119], a[76:79], v[216:219], v[116:119]
  s_waitcnt lgkmcnt(4)
  v_mfma_f32_16x16x32_bf16 v[32:35], a[80:83], v[220:223], v[32:35]
  v_mfma_f32_16x16x32_bf16 v[36:39], a[80:83], v[224:227], v[36:39]
  v_mfma_f32_16x16x32_bf16 v[40:43], a[80:83], v[228:231], v[40:43]
  v_mfma_f32_16x16x32_bf16 v[44:47], a[80:83], v[232:235], v[44:47]
  v_mfma_f32_16x16x32_bf16 v[104:107], a[84:87], v[220:223], v[104:107]
  v_mfma_f32_16x16x32_bf16 v[108:111], a[84:87], v[224:227], v[108:111]
  v_mfma_f32_16x16x32_bf16 v[112:115], a[84:87], v[228:231], v[112:115]
  v_mfma_f32_16x16x32_bf16 v[116:119], a[84:87], v[232:235], v[116:119]
  s_waitcnt lgkmcnt(0)
  v_mfma_f32_16x16x32_bf16 v[32:35], a[88:91], v[188:191], v[32:35]
  v_mfma_f32_16x16x32_bf16 v[36:39], a[88:91], v[192:195], v[36:39]
  v_mfma_f32_16x16x32_bf16 v[40:43], a[88:91], v[196:199], v[40:43]
  v_mfma_f32_16x16x32_bf16 v[44:47], a[88:91], v[200:203], v[44:47]
  v_mfma_f32_16x16x32_bf16 v[104:107], a[92:95], v[188:191], v[104:107]
  v_mfma_f32_16x16x32_bf16 v[108:111], a[92:95], v[192:195], v[108:111]
  v_mfma_f32_16x16x32_bf16 v[112:115], a[92:95], v[196:199], v[112:115]
  v_mfma_f32_16x16x32_bf16 v[116:119], a[92:95], v[200:203], v[116:119]
  s_lshl_b32 s26, s22, 12
  s_add_u32 s27, s26, 98304
  v_add_u32 v250, s27, v2
  s_xor_b32 s26, s26, 8192
  s_add_u32 s27, s26, 98304
  v_add_u32 v251, s27, v2
  ds_write_b128 v250, v[104:107] offset:0
  ds_write_b128 v250, v[108:111] offset:1024
  ds_write_b128 v250, v[112:115] offset:2048
  ds_write_b128 v250, v[116:119] offset:3072
  s_waitcnt lgkmcnt(0)
  s_barrier
  ds_read_b128 v[120:123], v251 offset:2048
  ds_read_b128 v[124:127], v251 offset:3072
  ds_read_b128 v[128:131], v251 offset:0
  ds_read_b128 v[132:135], v251 offset:1024
  s_waitcnt lgkmcnt(3)
  v_pk_add_f32 v[32:33], v[32:33], v[120:121]
  v_pk_add_f32 v[34:35], v[34:35], v[122:123]
  s_waitcnt lgkmcnt(2)
  v_pk_add_f32 v[36:37], v[36:37], v[124:125]
  v_pk_add_f32 v[38:39], v[38:39], v[126:127]
  s_waitcnt lgkmcnt(1)
  v_pk_add_f32 v[40:41], v[40:41], v[128:129]
  v_pk_add_f32 v[42:43], v[42:43], v[130:131]
  s_waitcnt lgkmcnt(0)
  v_pk_add_f32 v[44:45], v[44:45], v[132:133]
  v_pk_add_f32 v[46:47], v[46:47], v[134:135]
  v_cvt_pk_bf16_f32 v176, v32, v33
  v_cvt_pk_bf16_f32 v177, v34, v35
  v_cvt_pk_bf16_f32 v178, v36, v37
  v_cvt_pk_bf16_f32 v179, v38, v39
  v_cvt_pk_bf16_f32 v180, v40, v41
  v_cvt_pk_bf16_f32 v181, v42, v43
  v_cvt_pk_bf16_f32 v182, v44, v45
  v_cvt_pk_bf16_f32 v183, v46, v47
  v_permlane16_swap_b32 v176, v178
  v_permlane16_swap_b32 v177, v179
  v_permlane16_swap_b32 v180, v182
  v_permlane16_swap_b32 v181, v183
  s_add_u32 s26, s3, 1835008
  s_cmp_eq_u32 s23, 0
  s_cbranch_scc1 XS_84
  buffer_store_dwordx4 v[176:179], v12, s[4:7], s26 offen
  buffer_store_dwordx4 v[180:183], v13, s[4:7], s26 offen
XD_85:
  s_add_u32 s74, s68, 2560
  v_lshlrev_b32 v251, 7, v1
  buffer_load_dwordx4 a[164:167], v2, s[4:7], s25 offen offset:1024
  buffer_load_dwordx4 a[168:171], v2, s[4:7], s25 offen offset:2048
  s_waitcnt vmcnt(2)
  s_mov_b64 exec, 15
  s_cmp_eq_u32 s23, 0
  s_cbranch_scc1 XS_86
  buffer_store_dword v254, v251, s[4:7], s74 offen
XD_87:
  s_mov_b64 exec, -1
  s_load_dwordx16 s[80:95], s[76:77], 2560
  s_waitcnt lgkmcnt(0)
  s_and_b64 s[80:81], s[80:81], s[82:83]
  s_and_b64 s[84:85], s[84:85], s[86:87]
  s_and_b64 s[88:89], s[88:89], s[90:91]
  s_and_b64 s[92:93], s[92:93], s[94:95]
  s_and_b64 s[80:81], s[80:81], s[84:85]
  s_and_b64 s[88:89], s[88:89], s[92:93]
  s_and_b64 s[80:81], s[80:81], s[88:89]
  s_and_b32 s96, s80, s81
  s_cmp_eq_u32 s96, 1
  s_cbranch_scc0 SQ_88
SQok_89:
  s_add_u32 s72, s24, 1835008
  s_lshl_b32 s26, s22, 12
  s_add_u32 s72, s72, s26
  s_mov_b32 s73, s26
  s_add_u32 m0, s73, 0
  s_nop 0
  buffer_load_dwordx4 v2, s[4:7], s72 offen offset:0 sc1 lds
  buffer_load_dwordx4 v2, s[4:7], s72 offen offset:1024 sc1 lds
  buffer_load_dwordx4 v2, s[4:7], s72 offen offset:2048 sc1 lds
  buffer_load_dwordx4 v2, s[4:7], s72 offen offset:3072 sc1 lds
  s_add_u32 s72, s72, 16384
  s_add_u32 m0, s73, 16384
  s_nop 0
  buffer_load_dwordx4 v2, s[4:7], s72 offen offset:0 sc1 lds
  buffer_load_dwordx4 v2, s[4:7], s72 offen offset:1024 sc1 lds
  buffer_load_dwordx4 v2, s[4:7], s72 offen offset:2048 sc1 lds
  buffer_load_dwordx4 v2, s[4:7], s72 offen offset:3072 sc1 lds
  s_add_u32 s72, s72, 16384
  s_add_u32 m0, s73, 32768
  s_nop 0
  buffer_load_dwordx4 v2, s[4:7], s72 offen offset:0 sc1 lds
  buffer_load_dwordx4 v2, s[4:7], s72 offen offset:1024 sc1 lds
  buffer_load_dwordx4 v2, s[4:7], s72 offen offset:2048 sc1 lds
  buffer_load_dwordx4 v2, s[4:7], s72 offen offset:3072 sc1 lds
  s_waitcnt vmcnt(8)
  s_barrier
  ds_read_b128 v[188:191], v4 offset:0
  ds_read_b128 v[192:195], v5 offset:0
  ds_read_b128 v[196:199], v6 offset:0
  ds_read_b128 v[200:203], v7 offset:0
  ds_read_b128 v[204:207], v4 offset:4096
  ds_read_b128 v[208:211], v5 offset:4096
  ds_read_b128 v[212:215], v6 offset:4096
  ds_read_b128 v[216:219], v7 offset:4096
  s_waitcnt lgkmcnt(4)
  v_mfma_f32_16x16x32_bf16 v[104:107], v[188:191], a[96:99], 0
  ds_read_b128 v[220:223], v4 offset:8192
  v_mfma_f32_16x16x32_bf16 v[108:111], v[192:195], a[96:99], 0
  ds_read_b128 v[224:227], v5 offset:8192
  v_mfma_f32_16x16x32_bf16 v[112:115], v[196:199], a[96:99], 0
  ds_read_b128 v[228:231], v6 offset:8192
  v_mfma_f32_16x16x32_bf16 v[116:119], v[200:203], a[96:99], 0
  ds_read_b128 v[232:235], v7 offset:8192
  s_add_u32 s72, s72, 16384
  s_add_u32 m0, s73, 49152
  s_nop 0
  buffer_load_dwordx4 v2, s[4:7], s72 offen offset:0 sc1 lds
  v_mfma_f32_16x16x32_bf16 v[120:123], v[188:191], a[100:103], 0
  v_mfma_f32_16x16x32_bf16 v[124:127], v[192:195], a[100:103], 0
  v_mfma_f32_16x16x32_bf16 v[128:131], v[196:199], a[100:103], 0
  v_mfma_f32_16x16x32_bf16 v[132:135], v[200:203], a[100:103], 0
  buffer_load_dwordx4 v2, s[4:7], s72 offen offset:1024 sc1 lds
  v_mfma_f32_16x16x32_bf16 v[152:155], v[24:27], v[188:191], 0
  v_mfma_f32_16x16x32_bf16 v[156:159], v[188:191], v[188:191], 0
  s_waitcnt lgkmcnt(4)
  v_mfma_f32_16x16x32_bf16 v[104:107], v[204:207], a[104:107], v[104:107]
  ds_read_b128 v[188:191], v4 offset:12288
  v_mfma_f32_16x16x32_bf16 v[108:111], v[208:211], a[104:107], v[108:111]
  ds_read_b128 v[192:195], v5 offset:12288
  buffer_load_dwordx4 v2, s[4:7], s72 offen offset:2048 sc1 lds
  v_mfma_f32_16x16x32_bf16 v[112:115], v[212:215], a[104:107], v[112:115]
  ds_read_b128 v[196:199], v6 offset:12288
  v_mfma_f32_16x16x32_bf16 v[116:119], v[216:219], a[104:107], v[116:119]
  ds_read_b128 v[200:203], v7 offset:12288
  v_mfma_f32_16x16x32_bf16 v[120:123], v[204:207], a[108:111], v[120:123]
  v_mfma_f32_16x16x32_bf16 v[124:127], v[208:211], a[108:111], v[124:127]
  buffer_load_dwordx4 v2, s[4:7], s72 offen offset:3072 sc1 lds
  v_mfma_f32_16x16x32_bf16 v[128:131], v[212:215], a[108:111], v[128:131]
  v_mfma_f32_16x16x32_bf16 v[132:135], v[216:219], a[108:111], v[132:135]
  v_mfma_f32_16x16x32_bf16 v[152:155], v[24:27], v[204:207], v[152:155]
  v_mfma_f32_16x16x32_bf16 v[156:159], v[204:207], v[204:207], v[156:159]
  buffer_load_dwordx4 a[172:175], v2, s[4:7], s25 offen offset:3072
  s_waitcnt vmcnt(9)
  s_barrier
  s_waitcnt lgkmcnt(4)
  v_mfma_f32_16x16x32_bf16 v[104:107], v[220:223], a[112:115], v[104:107]
  ds_read_b128 v[204:207], v4 offset:16384
  v_mfma_f32_16x16x32_bf16 v[108:111], v[224:227], a[112:115], v[108:111]
  ds_read_b128 v[208:211], v5 offset:16384
  v_mfma_f32_16x16x32_bf16 v[112:115], v[228:231], a[112:115], v[112:115]
  ds_read_b128 v[212:215], v6 offset:16384
  v_mfma_f32_16x16x32_bf16 v[116:119], v[232:235], a[112:115], v[116:119]
  ds_read_b128 v[216:219], v7 offset:16384
  s_add_u32 s25, s25, 4096
  buffer_load_dwordx4 a[176:179], v2, s[4:7], s25 offen offset:0
  v_mfma_f32_16x16x32_bf16 v[120:123], v[220:223], a[116:119], v[120:123]
  v_mfma_f32_16x16x32_bf16 v[124:127], v[224:227], a[116:119], v[124:127]
  v_mfma_f32_16x16x32_bf16 v[128:131], v[228:231], a[116:119], v[128:131]
  v_mfma_f32_16x16x32_bf16 v[132:135], v[232:235], a[116:119], v[132:135]
  buffer_load_dwordx4 a[180:183], v2, s[4:7], s25 offen offset:1024
  v_mfma_f32_16x16x32_bf16 v[152:155], v[24:27], v[220:223], v[152:155]
  v_mfma_f32_16x16x32_bf16 v[156:159], v[220:223], v[220:223], v[156:159]
  s_waitcnt lgkmcnt(4)
  v_mfma_f32_16x16x32_bf16 v[104:107], v[188:191], a[120:123], v[104:107]
  ds_read_b128 v[220:223], v4 offset:20480
  v_mfma_f32_16x16x32_bf16 v[108:111], v[192:195], a[120:123], v[108:111]
  ds_read_b128 v[224:227], v5 offset:20480
  buffer_load_dwordx4 a[184:187], v2, s[4:7], s25 offen offset:2048
  v_mfma_f32_16x16x32_bf16 v[112:115], v[196:199], a[120:123], v[112:115]
  ds_read_b128 v[228:231], v6 offset:20480
  v_mfma_f32_16x16x32_bf16 v[116:119], v[200:203], a[120:123], v[116:119]
  ds_read_b128 v[232:235], v7 offset:20480
  v_mfma_f32_16x16x32_bf16 v[120:123], v[188:191], a[124:127], v[120:123]
  v_mfma_f32_16x16x32_bf16 v[124:127], v[192:195], a[124:127], v[124:127]
  buffer_load_dwordx4 a[188:191], v2, s[4:7], s25 offen offset:3072
  v_mfma_f32_16x16x32_bf16 v[128:131], v[196:199], a[124:127], v[128:131]
  v_mfma_f32_16x16x32_bf16 v[132:135], v[200:203], a[124:127], v[132:135]
  v_mfma_f32_16x16x32_bf16 v[152:155], v[24:27], v[188:191], v[152:155]
  v_mfma_f32_16x16x32_bf16 v[156:159], v[188:191], v[188:191], v[156:159]
  s_add_u32 s25, s25, 4096
  buffer_load_dwordx4 a[192:195], v2, s[4:7], s25 offen offset:0
  s_waitcnt lgkmcnt(4)
  v_mfma_f32_16x16x32_bf16 v[104:107], v[204:207], a[128:131], v[104:107]
  ds_read_b128 v[188:191], v4 offset:24576
  v_mfma_f32_16x16x32_bf16 v[108:111], v[208:211], a[128:131], v[108:111]
  ds_read_b128 v[192:195], v5 offset:24576
  v_mfma_f32_16x16x32_bf16 v[112:115], v[212:215], a[128:131], v[112:115]
  ds_read_b128 v[196:199], v6 offset:24576
  v_mfma_f32_16x16x32_bf16 v[116:119], v[216:219], a[128:131], v[116:119]
  ds_read_b128 v[200:203], v7 offset:24576
  buffer_load_dwordx4 a[196:199], v2, s[4:7], s25 offen offset:1024
  v_mfma_f32_16x16x32_bf16 v[120:123], v[204:207], a[132:135], v[120:123]
  v_mfma_f32_16x16x32_bf16 v[124:127], v[208:211], a[132:135], v[124:127]
  v_mfma_f32_16x16x32_bf16 v[128:131], v[212:215], a[132:135], v[128:131]
  v_mfma_f32_16x16x32_bf16 v[132:135], v[216:219], a[132:135], v[132:135]
  buffer_load_dwordx4 a[200:203], v2, s[4:7], s25 offen offset:2048
  v_mfma_f32_16x16x32_bf16 v[152:155], v[24:27], v[204:207], v[152:155]
  v_mfma_f32_16x16x32_bf16 v[156:159], v[204:207], v[204:207], v[156:159]
  s_waitcnt lgkmcnt(4)
  v_mfma_f32_16x16x32_bf16 v[104:107], v[220:223], a[136:139], v[104:107]
  ds_read_b128 v[204:207], v4 offset:28672
  v_mfma_f32_16x16x32_bf16 v[108:111], v[224:227], a[136:139], v[108:111]
  ds_read_b128 v[208:211], v5 offset:28672
  buffer_load_dwordx4 a[204:207], v2, s[4:7], s25 offen offset:3072
  v_mfma_f32_16x16x32_bf16 v[112:115], v[228:231], a[136:139], v[112:115]
  ds_read_b128 v[212:215], v6 offset:28672
  v_mfma_f32_16x16x32_bf16 v[116:119], v[232:235], a[136:139], v[116:119]
  ds_read_b128 v[216:219], v7 offset:28672
  v_mfma_f32_16x16x32_bf16 v[120:123], v[220:223], a[140:143], v[120:123]
  v_mfma_f32_16x16x32_bf16 v[124:127], v[224:227], a[140:143], v[124:127]
  s_add_u32 s25, s25, 4096
  buffer_load_dwordx4 a[208:211], v2, s[4:7], s25 offen offset:0
  v_mfma_f32_16x16x32_bf16 v[128:131], v[228:231], a[140:143], v[128:131]
  v_mfma_f32_16x16x32_bf16 v[132:135], v[232:235], a[140:143], v[132:135]
  v_mfma_f32_16x16x32_bf16 v[152:155], v[24:27], v[220:223], v[152:155]
  v_mfma_f32_16x16x32_bf16 v[156:159], v[220:223], v[220:223], v[156:159]
  buffer_load_dwordx4 a[212:215], v2, s[4:7], s25 offen offset:1024
  s_waitcnt vmcnt(15)
  s_barrier
  s_waitcnt lgkmcnt(4)
  v_mfma_f32_16x16x32_bf16 v[104:107], v[188:191], a[144:147], v[104:107]
  ds_read_b128 v[220:223], v4 offset:32768
  v_mfma_f32_16x16x32_bf16 v[108:111], v[192:195], a[144:147], v[108:111]
  ds_read_b128 v[224:227], v5 offset:32768
  v_mfma_f32_16x16x32_bf16 v[112:115], v[196:199], a[144:147], v[112:115]
  ds_read_b128 v[228:231], v6 offset:32768
  v_mfma_f32_16x16x32_bf16 v[116:119], v[200:203], a[144:147], v[116:119]
  ds_read_b128 v[232:235], v7 offset:32768
  buffer_load_dwordx4 a[216:219], v2, s[4:7], s25 offen offset:2048
  v_mfma_f32_16x16x32_bf16 v[120:123], v[188:191], a[148:151], v[120:123]
  v_mfma_f32_16x16x32_bf16 v[124:127], v[192:195], a[148:151], v[124:127]
  v_mfma_f32_16x16x32_bf16 v[128:131], v[196:199], a[148:151], v[128:131]
  v_mfma_f32_16x16x32_bf16 v[132:135], v[200:203], a[148:151], v[132:135]
  buffer_load_dwordx4 a[220:223], v2, s[4:7], s25 offen offset:3072
  v_mfma_f32_16x16x32_bf16 v[152:155], v[24:27], v[188:191], v[152:155]
  v_mfma_f32_16x16x32_bf16 v[156:159], v[188:191], v[188:191], v[156:159]
  s_waitcnt lgkmcnt(4)
  v_mfma_f32_16x16x32_bf16 v[104:107], v[204:207], a[152:155], v[104:107]
  ds_read_b128 v[188:191], v4 offset:36864
  v_mfma_f32_16x16x32_bf16 v[108:111], v[208:211], a[152:155], v[108:111]
  ds_read_b128 v[192:195], v5 offset:36864
  s_add_u32 s25, s25, 4096
  buffer_load_dwordx4 a[224:227], v2, s[4:7], s25 offen offset:0
  v_mfma_f32_16x16x32_bf16 v[112:115], v[212:215], a[152:155], v[112:115]
  ds_read_b128 v[196:199], v6 offset:36864
  v_mfma_f32_16x16x32_bf16 v[116:119], v[216:219], a[152:155], v[116:119]
  ds_read_b128 v[200:203], v7 offset:36864
  v_mfma_f32_16x16x32_bf16 v[120:123], v[204:207], a[156:159], v[120:123]
  v_mfma_f32_16x16x32_bf16 v[124:127], v[208:211], a[156:159], v[124:127]
  buffer_load_dwordx4 a[228:231], v2, s[4:7], s25 offen offset:1024
  v_mfma_f32_16x16x32_bf16 v[128:131], v[212:215], a[156:159], v[128:131]
  v_mfma_f32_16x16x32_bf16 v[132:135], v[216:219], a[156:159], v[132:135]
  v_mfma_f32_16x16x32_bf16 v[152:155], v[24:27], v[204:207], v[152:155]
  v_mfma_f32_16x16x32_bf16 v[156:159], v[204:207], v[204:207], v[156:159]
  buffer_load_dwordx4 a[232:235], v2, s[4:7], s25 offen offset:2048
  s_waitcnt vmcnt(13) lgkmcnt(4)
  v_mfma_f32_16x16x32_bf16 v[104:107], v[220:223], a[160:163], v[104:107]
  ds_read_b128 v[204:207], v4 offset:40960
  v_mfma_f32_16x16x32_bf16 v[108:111], v[224:227], a[160:163], v[108:111]
  ds_read_b128 v[208:211], v5 offset:40960
  v_mfma_f32_16x16x32_bf16 v[112:115], v[228:231], a[160:163], v[112:115]
  ds_read_b128 v[212:215], v6 offset:40960
  v_mfma_f32_16x16x32_bf16 v[116:119], v[232:235], a[160:163], v[116:119]
  ds_read_b128 v[216:219], v7 offset:40960
  buffer_load_dwordx4 a[236:239], v2, s[4:7], s25 offen offset:3072
  v_mfma_f32_16x16x32_bf16 v[120:123], v[220:223], a[164:167], v[120:123]
  v_mfma_f32_16x16x32_bf16 v[124:127], v[224:227], a[164:167], v[124:127]
  v_mfma_f32_16x16x32_bf16 v[128:131], v[228:231], a[164:167], v[128:131]
  v_mfma_f32_16x16x32_bf16 v[132:135], v[232:235], a[164:167], v[132:135]
  s_add_u32 s25, s25, 4096
  buffer_load_dwordx4 a[240:243], v2, s[4:7], s25 offen offset:0
  v_mfma_f32_16x16x32_bf16 v[152:155], v[24:27], v[220:223], v[152:155]
  v_mfma_f32_16x16x32_bf16 v[156:159], v[220:223], v[220:223], v[156:159]
  s_waitcnt lgkmcnt(4)
  v_mfma_f32_16x16x32_bf16 v[104:107], v[188:191], a[168:171], v[104:107]
  ds_read_b128 v[220:223], v4 offset:45056
  v_mfma_f32_16x16x32_bf16 v[108:111], v[192:195], a[168:171], v[108:111]
  ds_read_b128 v[224:227], v5 offset:45056
  buffer_load_dwordx4 a[244:247], v2, s[4:7], s25 offen offset:1024
  v_mfma_f32_16x16x32_bf16 v[112:115], v[196:199], a[168:171], v[112:115]
  ds_read_b128 v[228:231], v6 offset:45056
  v_mfma_f32_16x16x32_bf16 v[116:119], v[200:203], a[168:171], v[116:119]
  ds_read_b128 v[232:235], v7 offset:45056
  v_mfma_f32_16x16x32_bf16 v[120:123], v[188:191], a[172:175], v[120:123]
  v_mfma_f32_16x16x32_bf16 v[124:127], v[192:195], a[172:175], v[124:127]
  buffer_load_dwordx4 a[248:251], v2, s[4:7], s25 offen offset:2048
  v_mfma_f32_16x16x32_bf16 v[128:131], v[196:199], a[172:175], v[128:131]
  v_mfma_f32_16x16x32_bf16 v[132:135], v[200:203], a[172:175], v[132:135]
  v_mfma_f32_16x16x32_bf16 v[152:155], v[24:27], v[188:191], v[152:155]
  v_mfma_f32_16x16x32_bf16 v[156:159], v[188:191], v[188:191], v[156:159]
  buffer_load_dwordx4 a[252:255], v2, s[4:7], s25 offen offset:3072
  s_barrier
  s_waitcnt lgkmcnt(4)
  v_mfma_f32_16x16x32_bf16 v[104:107], v[204:207], a[176:179], v[104:107]
  ds_read_b128 v[188:191], v4 offset:49152
  v_mfma_f32_16x16x32_bf16 v[108:111], v[208:211], a[176:179], v[108:111]
  ds_read_b128 v[192:195], v5 offset:49152
  v_mfma_f32_16x16x32_bf16 v[112:115], v[212:215], a[176:179], v[112:115]
  ds_read_b128 v[196:199], v6 offset:49152
  v_mfma_f32_16x16x32_bf16 v[116:119], v[216:219], a[176:179], v[116:119]
  ds_read_b128 v[200:203], v7 offset:49152
  s_add_u32 s25, s25, 4096
  buffer_load_dwordx4 a[0:3], v2, s[4:7], s25 offen offset:0
  v_mfma_f32_16x16x32_bf16 v[120:123], v[204:207], a[180:183], v[120:123]
  v_mfma_f32_16x16x32_bf16 v[124:127], v[208:211], a[180:183], v[124:127]
  v_mfma_f32_16x16x32_bf16 v[128:131], v[212:215], a[180:183], v[128:131]
  v_mfma_f32_16x16x32_bf16 v[132:135], v[216:219], a[180:183], v[132:135]
  buffer_load_dwordx4 a[4:7], v2, s[4:7], s25 offen offset:1024
  v_mfma_f32_16x16x32_bf16 v[152:155], v[24:27], v[204:207], v[152:155]
  v_mfma_f32_16x16x32_bf16 v[156:159], v[204:207], v[204:207], v[156:159]
  s_waitcnt vmcnt(13) lgkmcnt(4)
  v_mfma_f32_16x16x32_bf16 v[104:107], v[220:223], a[184:187], v[104:107]
  ds_read_b128 v[204:207], v4 offset:53248
  v_mfma_f32_16x16x32_bf16 v[108:111], v[224:227], a[184:187], v[108:111]
  ds_read_b128 v[208:211], v5 offset:53248
  buffer_load_dwordx4 a[8:11], v2, s[4:7], s25 offen offset:2048
  v_mfma_f32_16x16x32_bf16 v[112:115], v[228:231], a[184:187], v[112:115]
  ds_read_b128 v[212:215], v6 offset:53248
  v_mfma_f32_16x16x32_bf16 v[116:119], v[232:235], a[184:187], v[116:119]
  ds_read_b128 v[216:219], v7 offset:53248
  v_mfma_f32_16x16x32_bf16 v[120:123], v[220:223], a[188:191], v[120:123]
  v_mfma_f32_16x16x32_bf16 v[124:127], v[224:227], a[188:191], v[124:127]
  buffer_load_dwordx4 a[12:15], v2, s[4:7], s25 offen offset:3072
  v_mfma_f32_16x16x32_bf16 v[128:131], v[228:231], a[188:191], v[128:131]
  v_mfma_f32_16x16x32_bf16 v[132:135], v[232:235], a[188:191], v[132:135]
  v_mfma_f32_16x16x32_bf16 v[152:155], v[24:27], v[220:223], v[152:155]
  v_mfma_f32_16x16x32_bf16 v[156:159], v[220:223], v[220:223], v[156:159]
  s_add_u32 s25, s25, 4096
  buffer_load_dwordx4 a[16:19], v2, s[4:7], s25 offen offset:0
  s_waitcnt lgkmcnt(4)
  v_mfma_f32_16x16x32_bf16 v[104:107], v[188:191], a[192:195], v[104:107]
  ds_read_b128 v[220:223], v4 offset:57344
  v_mfma_f32_16x16x32_bf16 v[108:111], v[192:195], a[192:195], v[108:111]
  ds_read_b128 v[224:227], v5 offset:57344
  v_mfma_f32_16x16x32_bf16 v[112:115], v[196:199], a[192:195], v[112:115]
  ds_read_b128 v[228:231], v6 offset:57344
  v_mfma_f32_16x16x32_bf16 v[116:119], v[200:203], a[192:195], v[116:119]
  ds_read_b128 v[232:235], v7 offset:57344
  buffer_load_dwordx4 a[20:23], v2, s[4:7], s25 offen offset:1024
  v_mfma_f32_16x16x32_bf16 v[120:123], v[188:191], a[196:199], v[120:123]
  v_mfma_f32_16x16x32_bf16 v[124:127], v[192:195], a[196:199], v[124:127]
  v_mfma_f32_16x16x32_bf16 v[128:131], v[196:199], a[196:199], v[128:131]
  v_mfma_f32_16x16x32_bf16 v[132:135], v[200:203], a[196:199], v[132:135]
  buffer_load_dwordx4 a[24:27], v2, s[4:7], s25 offen offset:2048
  v_mfma_f32_16x16x32_bf16 v[152:155], v[24:27], v[188:191], v[152:155]
  v_mfma_f32_16x16x32_bf16 v[156:159], v[188:191], v[188:191], v[156:159]
  s_waitcnt lgkmcnt(4)
  v_mfma_f32_16x16x32_bf16 v[104:107], v[204:207], a[200:203], v[104:107]
  ds_read_b128 v[188:191], v4 offset:61440
  v_mfma_f32_16x16x32_bf16 v[108:111], v[208:211], a[200:203], v[108:111]
  ds_read_b128 v[192:195], v5 offset:61440
  buffer_load_dwordx4 a[28:31], v2, s[4:7], s25 offen offset:3072
  v_mfma_f32_16x16x32_bf16 v[112:115], v[212:215], a[200:203], v[112:115]
  ds_read_b128 v[196:199], v6 offset:61440
  v_mfma_f32_16x16x32_bf16 v[116:119], v[216:219], a[200:203], v[116:119]
  ds_read_b128 v[200:203], v7 offset:61440
  v_mfma_f32_16x16x32_bf16 v[120:123], v[204:207], a[204:207], v[120:123]
  v_mfma_f32_16x16x32_bf16 v[124:127], v[208:211], a[204:207], v[124:127]
  s_add_u32 s25, s25, 4096
  buffer_load_dwordx4 a[32:35], v2, s[4:7], s25 offen offset:0
  v_mfma_f32_16x16x32_bf16 v[128:131], v[212:215], a[204:207], v[128:131]
  v_mfma_f32_16x16x32_bf16 v[132:135], v[216:219], a[204:207], v[132:135]
  v_mfma_f32_16x16x32_bf16 v[152:155], v[24:27], v[204:207], v[152:155]
  v_mfma_f32_16x16x32_bf16 v[156:159], v[204:207], v[204:207], v[156:159]
  buffer_load_dwordx4 a[36:39], v2, s[4:7], s25 offen offset:1024
  s_waitcnt vmcnt(13) lgkmcnt(4)
  v_mfma_f32_16x16x32_bf16 v[104:107], v[220:223], a[208:211], v[104:107]
  v_mfma_f32_16x16x32_bf16 v[108:111], v[224:227], a[208:211], v[108:111]
  v_mfma_f32_16x16x32_bf16 v[112:115], v[228:231], a[208:211], v[112:115]
  v_mfma_f32_16x16x32_bf16 v[116:119], v[232:235], a[208:211], v[116:119]
  buffer_load_dwordx4 a[40:43], v2, s[4:7], s25 offen offset:2048
  v_mfma_f32_16x16x32_bf16 v[120:123], v[220:223], a[212:215], v[120:123]
  v_mfma_f32_16x16x32_bf16 v[124:127], v[224:227], a[212:215], v[124:127]
  v_mfma_f32_16x16x32_bf16 v[128:131], v[228:231], a[212:215], v[128:131]
  v_mfma_f32_16x16x32_bf16 v[132:135], v[232:235], a[212:215], v[132:135]
  buffer_load_dwordx4 a[44:47], v2, s[4:7], s25 offen offset:3072
  v_mfma_f32_16x16x32_bf16 v[152:155], v[24:27], v[220:223], v[152:155]
  v_mfma_f32_16x16x32_bf16 v[156:159], v[220:223], v[220:223], v[156:159]
  s_waitcnt lgkmcnt(0)
  v_mfma_f32_16x16x32_bf16 v[104:107], v[188:191], a[216:219], v[104:107]
  v_mfma_f32_16x16x32_bf16 v[108:111], v[192:195], a[216:219], v[108:111]
  s_add_u32 s25, s25, 4096
  buffer_load_dwordx4 a[48:51], v2, s[4:7], s25 offen offset:0
  v_mfma_f32_16x16x32_bf16 v[112:115], v[196:199], a[216:219], v[112:115]
  v_mfma_f32_16x16x32_bf16 v[116:119], v[200:203], a[216:219], v[116:119]
  v_mfma_f32_16x16x32_bf16 v[120:123], v[188:191], a[220:223], v[120:123]
  v_mfma_f32_16x16x32_bf16 v[124:127], v[192:195], a[220:223], v[124:127]
  buffer_load_dwordx4 a[52:55], v2, s[4:7], s25 offen offset:1024
  v_mfma_f32_16x16x32_bf16 v[128:131], v[196:199], a[220:223], v[128:131]
  v_mfma_f32_16x16x32_bf16 v[132:135], v[200:203], a[220:223], v[132:135]
  v_mfma_f32_16x16x32_bf16 v[152:155], v[24:27], v[188:191], v[152:155]
  v_mfma_f32_16x16x32_bf16 v[156:159], v[188:191], v[188:191], v[156:159]
  buffer_load_dwordx4 a[56:59], v2, s[4:7], s25 offen offset:2048
  s_nop 6
  v_cndmask_b32_e64 v224, v156, v157, s[40:41]
  v_mul_f32 v225, s60, v152
  v_cndmask_b32_e64 v224, v224, v158, s[42:43]
  v_cndmask_b32_e64 v224, v224, v159, s[44:45]
  v_mul_f32 v224, s60, v224
  v_fma_f32 v224, -v225, v225, v224
  v_max_f32 v224, 0, v224
  v_add_f32 v226, s61, v224
  v_rsq_f32 v230, v226
  v_subrev_u32 v232, 131072, v14
  v_mul_f32 v231, v230, v225
  v_lshrrev_b32 v232, 2, v232
  v_add_u32 v232, 132096, v232
  v_mov_b32 v228, v230
  v_mov_b32 v229, v231
  s_mov_b64 exec, s[46:47]
  ds_write_b128 v14, v[228:231]
  ds_write_b32 v232, v228
  ds_write_b32 v232, v229 offset:256
  s_mov_b64 exec, -1
  s_waitcnt lgkmcnt(0)
  s_barrier
  ds_read_b128 v[176:179], v18
  ds_read_b128 v[192:195], v18 offset:256
  ds_read_b128 v[180:183], v19
  ds_read_b128 v[196:199], v19 offset:256
  ds_read_b128 v[184:187], v20
  ds_read_b128 v[200:203], v20 offset:256
  ds_read_b128 v[188:191], v21
  ds_read_b128 v[204:207], v21 offset:256
  s_waitcnt lgkmcnt(0)
  v_pk_mul_f32 v[224:225], v[192:193], v[76:77] op_sel_hi:[1,0]
  v_pk_mul_f32 v[226:227], v[194:195], v[76:77] op_sel_hi:[1,0]
  v_pk_mul_f32 v[228:229], v[196:197], v[76:77] op_sel_hi:[1,0]
  v_pk_mul_f32 v[230:231], v[198:199], v[76:77] op_sel_hi:[1,0]
  v_pk_fma_f32 v[104:105], v[176:177], v[104:105], v[224:225] neg_lo:[0,0,1] neg_hi:[0,0,1]
  v_pk_fma_f32 v[106:107], v[178:179], v[106:107], v[226:227] neg_lo:[0,0,1] neg_hi:[0,0,1]
  v_pk_fma_f32 v[108:109], v[180:181], v[108:109], v[228:229] neg_lo:[0,0,1] neg_hi:[0,0,1]
  v_pk_fma_f32 v[110:111], v[182:183], v[110:111], v[230:231] neg_lo:[0,0,1] neg_hi:[0,0,1]
  v_pk_mul_f32 v[224:225], v[200:201], v[76:77] op_sel_hi:[1,0]
  v_pk_mul_f32 v[226:227], v[202:203], v[76:77] op_sel_hi:[1,0]
  v_pk_mul_f32 v[228:229], v[204:205], v[76:77] op_sel_hi:[1,0]
  v_pk_mul_f32 v[230:231], v[206:207], v[76:77] op_sel_hi:[1,0]
  buffer_load_dwordx4 a[60:63], v2, s[4:7], s25 offen offset:3072
  v_pk_fma_f32 v[112:113], v[184:185], v[112:113], v[224:225] neg_lo:[0,0,1] neg_hi:[0,0,1]
  v_pk_fma_f32 v[114:115], v[186:187], v[114:115], v[226:227] neg_lo:[0,0,1] neg_hi:[0,0,1]
  v_pk_fma_f32 v[116:117], v[188:189], v[116:117], v[228:229] neg_lo:[0,0,1] neg_hi:[0,0,1]
  v_pk_fma_f32 v[118:119], v[190:191], v[118:119], v[230:231] neg_lo:[0,0,1] neg_hi:[0,0,1]
  v_pk_mul_f32 v[224:225], v[192:193], v[80:81] op_sel_hi:[1,0]
  v_pk_mul_f32 v[226:227], v[194:195], v[80:81] op_sel_hi:[1,0]
  v_pk_mul_f32 v[228:229], v[196:197], v[80:81] op_sel_hi:[1,0]
  v_pk_mul_f32 v[230:231], v[198:199], v[80:81] op_sel_hi:[1,0]
  v_pk_fma_f32 v[120:121], v[176:177], v[120:121], v[224:225] neg_lo:[0,0,1] neg_hi:[0,0,1]
  v_pk_fma_f32 v[122:123], v[178:179], v[122:123], v[226:227] neg_lo:[0,0,1] neg_hi:[0,0,1]
  v_pk_fma_f32 v[124:125], v[180:181], v[124:125], v[228:229] neg_lo:[0,0,1] neg_hi:[0,0,1]
  v_pk_fma_f32 v[126:127], v[182:183], v[126:127], v[230:231] neg_lo:[0,0,1] neg_hi:[0,0,1]
  v_pk_mul_f32 v[224:225], v[200:201], v[80:81] op_sel_hi:[1,0]
  v_pk_mul_f32 v[226:227], v[202:203], v[80:81] op_sel_hi:[1,0]
  s_add_u32 s25, s25, 4096
  buffer_load_dwordx4 a[64:67], v2, s[4:7], s25 offen offset:0
  v_pk_mul_f32 v[228:229], v[204:205], v[80:81] op_sel_hi:[1,0]
  v_pk_mul_f32 v[230:231], v[206:207], v[80:81] op_sel_hi:[1,0]
  v_pk_fma_f32 v[128:129], v[184:185], v[128:129], v[224:225] neg_lo:[0,0,1] neg_hi:[0,0,1]
  v_pk_fma_f32 v[130:131], v[186:187], v[130:131], v[226:227] neg_lo:[0,0,1] neg_hi:[0,0,1]
  v_pk_fma_f32 v[132:133], v[188:189], v[132:133], v[228:229] neg_lo:[0,0,1] neg_hi:[0,0,1]
  v_pk_fma_f32 v[134:135], v[190:191], v[134:135], v[230:231] neg_lo:[0,0,1] neg_hi:[0,0,1]
  v_pk_mul_f32 v[224:225], v[104:105], v[30:31] op_sel_hi:[1,0]
  v_pk_mul_f32 v[226:227], v[106:107], v[30:31] op_sel_hi:[1,0]
  v_pk_mul_f32 v[228:229], v[108:109], v[30:31] op_sel_hi:[1,0]
  v_pk_mul_f32 v[230:231], v[110:111], v[30:31] op_sel_hi:[1,0]
  v_exp_f32_e64 v224, v224 clamp
  v_exp_f32_e64 v225, v225 clamp
  buffer_load_dwordx4 a[68:71], v2, s[4:7], s25 offen offset:1024
  v_exp_f32_e64 v226, v226 clamp
  v_exp_f32_e64 v227, v227 clamp
  v_exp_f32_e64 v228, v228 clamp
  v_exp_f32_e64 v229, v229 clamp
  v_exp_f32_e64 v230, v230 clamp
  v_exp_f32_e64 v231, v231 clamp
  v_max_f32 v104, 0, v104
  v_max_f32 v105, 0, v105
  v_max_f32 v106, 0, v106
  buffer_load_dwordx4 a[72:75], v2, s[4:7], s25 offen offset:2048
  v_max_f32 v107, 0, v107
  v_max_f32 v108, 0, v108
  v_max_f32 v109, 0, v109
  v_max_f32 v110, 0, v110
  v_max_f32 v111, 0, v111
  v_pk_add_f32 v[224:225], v[224:225], v[30:31] op_sel:[0,1] op_sel_hi:[1,1]
  v_pk_add_f32 v[226:227], v[226:227], v[30:31] op_sel:[0,1] op_sel_hi:[1,1]
  v_pk_add_f32 v[228:229], v[228:229], v[30:31] op_sel:[0,1] op_sel_hi:[1,1]
  v_pk_add_f32 v[230:231], v[230:231], v[30:31] op_sel:[0,1] op_sel_hi:[1,1]
  v_pk_add_f32 v[104:105], v[104:105], v[224:225]
  v_pk_add_f32 v[106:107], v[106:107], v[226:227]
  v_pk_add_f32 v[108:109], v[108:109], v[228:229]
  v_pk_add_f32 v[110:111], v[110:111], v[230:231]
  v_pk_mul_f32 v[224:225], v[112:113], v[30:31] op_sel_hi:[1,0]
  buffer_load_dwordx4 a[76:79], v2, s[4:7], s25 offen offset:3072
  v_pk_mul_f32 v[226:227], v[114:115], v[30:31] op_sel_hi:[1,0]
  v_pk_mul_f32 v[228:229], v[116:117], v[30:31] op_sel_hi:[1,0]
  v_pk_mul_f32 v[230:231], v[118:119], v[30:31] op_sel_hi:[1,0]
  v_exp_f32_e64 v224, v224 clamp
  v_exp_f32_e64 v225, v225 clamp
  v_exp_f32_e64 v226, v226 clamp
  v_exp_f32_e64 v227, v227 clamp
  v_exp_f32_e64 v228, v228 clamp
  v_exp_f32_e64 v229, v229 clamp
  s_add_u32 s25, s25, 4096
  buffer_load_dwordx4 a[80:83], v2, s[4:7], s25 offen offset:0
  v_exp_f32_e64 v230, v230 clamp
  v_exp_f32_e64 v231, v231 clamp
  v_max_f32 v112, 0, v112
  v_max_f32 v113, 0, v113
  v_max_f32 v114, 0, v114
  v_max_f32 v115, 0, v115
  v_max_f32 v116, 0, v116
  v_max_f32 v117, 0, v117
  v_max_f32 v118, 0, v118
  v_max_f32 v119, 0, v119
  v_pk_add_f32 v[224:225], v[224:225], v[30:31] op_sel:[0,1] op_sel_hi:[1,1]
  v_pk_add_f32 v[226:227], v[226:227], v[30:31] op_sel:[0,1] op_sel_hi:[1,1]
  buffer_load_dwordx4 a[84:87], v2, s[4:7], s25 offen offset:1024
  v_pk_add_f32 v[228:229], v[228:229], v[30:31] op_sel:[0,1] op_sel_hi:[1,1]
  v_pk_add_f32 v[230:231], v[230:231], v[30:31] op_sel:[0,1] op_sel_hi:[1,1]
  v_pk_add_f32 v[112:113], v[112:113], v[224:225]
  v_pk_add_f32 v[114:115], v[114:115], v[226:227]
  v_pk_add_f32 v[116:117], v[116:117], v[228:229]
  v_pk_add_f32 v[118:119], v[118:119], v[230:231]
  v_cvt_pk_bf16_f32 v176, v104, v105
  v_cvt_pk_bf16_f32 v177, v106, v107
  v_cvt_pk_bf16_f32 v184, v120, v121
  v_cvt_pk_bf16_f32 v185, v122, v123
  v_cvt_pk_bf16_f32 v178, v108, v109
  v_cvt_pk_bf16_f32 v179, v110, v111
  v_cvt_pk_bf16_f32 v186, v124, v125
  v_cvt_pk_bf16_f32 v187, v126, v127
  v_cvt_pk_bf16_f32 v180, v112, v113
  v_cvt_pk_bf16_f32 v181, v114, v115
  v_cvt_pk_bf16_f32 v188, v128, v129
  v_cvt_pk_bf16_f32 v189, v130, v131
  v_cvt_pk_bf16_f32 v182, v116, v117
  v_cvt_pk_bf16_f32 v183, v118, v119
  v_cvt_pk_bf16_f32 v190, v132, v133
  v_cvt_pk_bf16_f32 v191, v134, v135
  v_mfma_f32_16x16x32_bf16 v[192:195], v[176:179], v[184:187], 0
  v_mfma_f32_16x16x32_bf16 v[196:199], v[176:179], v[24:27], 0
  v_mfma_f32_16x16x32_bf16 v[192:195], v[180:183], v[188:191], v[192:195]
  buffer_load_dwordx4 a[88:91], v2, s[4:7], s25 offen offset:2048
  v_mfma_f32_16x16x32_bf16 v[196:199], v[180:183], v[24:27], v[196:199]
  s_nop 7
  v_cndmask_b32_e64 v196, v196, v197, s[40:41]
  v_cndmask_b32_e64 v196, v196, v198, s[42:43]
  v_cndmask_b32_e64 v196, v196, v199, s[44:45]
  s_mul_i32 s26, s36, 1280
  s_add_u32 s26, s26, s64
  s_add_u32 s26, s26, 0
  s_cmp_eq_u32 s23, 0
  s_cbranch_scc1 XS_92
  buffer_store_dwordx4 v[192:195], v2, s[4:7], s26 offen
  buffer_store_dword v196, v3, s[4:7], s26 offen offset:1024
XD_93:
  ds_read_b128 v[188:191], v4 offset:0
  ds_read_b128 v[192:195], v5 offset:0
  ds_read_b128 v[196:199], v6 offset:0
  ds_read_b128 v[200:203], v7 offset:0
  ds_read_b128 v[204:207], v4 offset:4096
  ds_read_b128 v[208:211], v5 offset:4096
  ds_read_b128 v[212:215], v6 offset:4096
  ds_read_b128 v[216:219], v7 offset:4096
  s_waitcnt lgkmcnt(4)
  v_mfma_f32_16x16x32_bf16 v[136:139], a[224:227], v[188:191], 0
  ds_read_b128 v[220:223], v4 offset:8192
  v_mfma_f32_16x16x32_bf16 v[140:143], a[224:227], v[192:195], 0
  ds_read_b128 v[224:227], v5 offset:8192
  v_mfma_f32_16x16x32_bf16 v[144:147], a[224:227], v[196:199], 0
  ds_read_b128 v[228:231], v6 offset:8192
  buffer_load_dwordx4 a[92:95], v2, s[4:7], s25 offen offset:3072
  v_mfma_f32_16x16x32_bf16 v[148:151], a[224:227], v[200:203], 0
  ds_read_b128 v[232:235], v7 offset:8192
  s_waitcnt lgkmcnt(4)
  v_mfma_f32_16x16x32_bf16 v[136:139], a[228:231], v[204:207], v[136:139]
  ds_read_b128 v[188:191], v4 offset:12288
  v_mfma_f32_16x16x32_bf16 v[140:143], a[228:231], v[208:211], v[140:143]
  ds_read_b128 v[192:195], v5 offset:12288
  s_add_u32 s25, s25, 4096
  buffer_load_dwordx4 a[96:99], v2, s[4:7], s25 offen offset:0
  v_mfma_f32_16x16x32_bf16 v[144:147], a[228:231], v[212:215], v[144:147]
  ds_read_b128 v[196:199], v6 offset:12288
  v_mfma_f32_16x16x32_bf16 v[148:151], a[228:231], v[216:219], v[148:151]
  ds_read_b128 v[200:203], v7 offset:12288
  s_add_u32 s74, s33, 3072
  v_lshlrev_b32 v251, 7, v1
  s_mov_b64 exec, 15
  buffer_load_dword v250, v251, s[4:7], s74 offen
  s_mov_b64 exec, -1
  s_waitcnt lgkmcnt(4)
  v_mfma_f32_16x16x32_bf16 v[136:139], a[232:235], v[220:223], v[136:139]
  ds_read_b128 v[204:207], v4 offset:16384
  buffer_load_dwordx4 a[100:103], v2, s[4:7], s25 offen offset:1024
  v_mfma_f32_16x16x32_bf16 v[140:143], a[232:235], v[224:227], v[140:143]
  ds_read_b128 v[208:211], v5 offset:16384
  v_mfma_f32_16x16x32_bf16 v[144:147], a[232:235], v[228:231], v[144:147]
  ds_read_b128 v[212:215], v6 offset:16384
  v_mfma_f32_16x16x32_bf16 v[148:151], a[232:235], v[232:235], v[148:151]
  ds_read_b128 v[216:219], v7 offset:16384
  buffer_load_dwordx4 a[104:107], v2, s[4:7], s25 offen offset:2048
  s_waitcnt lgkmcnt(4)
  v_mfma_f32_16x16x32_bf16 v[136:139], a[236:239], v[188:191], v[136:139]
  ds_read_b128 v[220:223], v4 offset:20480
  v_mfma_f32_16x16x32_bf16 v[140:143], a[236:239], v[192:195], v[140:143]
  ds_read_b128 v[224:227], v5 offset:20480
  v_mfma_f32_16x16x32_bf16 v[144:147], a[236:239], v[196:199], v[144:147]
  ds_read_b128 v[228:231], v6 offset:20480
  v_mfma_f32_16x16x32_bf16 v[148:151], a[236:239], v[200:203], v[148:151]
  ds_read_b128 v[232:235], v7 offset:20480
  buffer_load_dwordx4 a[108:111], v2, s[4:7], s25 offen offset:3072
  s_cmp_lg_u32 s36, s22
  s_cbranch_scc1 K1_94
  s_add_u32 s26, s64, 0
  buffer_load_dwordx4 v[104:107], v2, s[4:7], s26 offen sc1
  buffer_load_dword v120, v3, s[4:7], s26 offen offset:1024 sc1
  s_add_u32 s26, s26, 1280
  buffer_load_dwordx4 v[108:111], v2, s[4:7], s26 offen sc1
  buffer_load_dword v121, v3, s[4:7], s26 offen offset:1024 sc1
  s_add_u32 s26, s26, 1280
  buffer_load_dwordx4 v[112:115], v2, s[4:7], s26 offen sc1
  buffer_load_dword v122, v3, s[4:7], s26 offen offset:1024 sc1
  s_add_u32 s26, s26, 1280
  buffer_load_dwordx4 v[116:119], v2, s[4:7], s26 offen sc1
  buffer_load_dword v123, v3, s[4:7], s26 offen offset:1024 sc1
K1_94:
  s_waitcnt lgkmcnt(4)
  v_mfma_f32_16x16x32_bf16 v[136:139], a[240:243], v[204:207], v[136:139]
  ds_read_b128 v[188:191], v4 offset:24576
  v_mfma_f32_16x16x32_bf16 v[140:143], a[240:243], v[208:211], v[140:143]
  ds_read_b128 v[192:195], v5 offset:24576
  v_mfma_f32_16x16x32_bf16 v[144:147], a[240:243], v[212:215], v[144:147]
  ds_read_b128 v[196:199], v6 offset:24576
  s_add_u32 s25, s25, 4096
  buffer_load_dwordx4 a[112:115], v2, s[4:7], s25 offen offset:0
  v_mfma_f32_16x16x32_bf16 v[148:151], a[240:243], v[216:219], v[148:151]
  ds_read_b128 v[200:203], v7 offset:24576
  s_waitcnt vmcnt(27) lgkmcnt(4)
  v_mfma_f32_16x16x32_bf16 v[136:139], a[244:247], v[220:223], v[136:139]
  ds_read_b128 v[204:207], v4 offset:28672
  v_mfma_f32_16x16x32_bf16 v[140:143], a[244:247], v[224:227], v[140:143]
  ds_read_b128 v[208:211], v5 offset:28672
  buffer_load_dwordx4 a[116:119], v2, s[4:7], s25 offen offset:1024
  v_mfma_f32_16x16x32_bf16 v[144:147], a[244:247], v[228:231], v[144:147]
  ds_read_b128 v[212:215], v6 offset:28672
  v_mfma_f32_16x16x32_bf16 v[148:151], a[244:247], v[232:235], v[148:151]
  ds_read_b128 v[216:219], v7 offset:28672
  s_waitcnt lgkmcnt(4)
  v_mfma_f32_16x16x32_bf16 v[136:139], a[248:251], v[188:191], v[136:139]
  ds_read_b128 v[220:223], v4 offset:32768
  buffer_load_dwordx4 a[120:123], v2, s[4:7], s25 offen offset:2048
  v_mfma_f32_16x16x32_bf16 v[140:143], a[248:251], v[192:195], v[140:143]
  ds_read_b128 v[224:227], v5 offset:32768
  v_mfma_f32_16x16x32_bf16 v[144:147], a[248:251], v[196:199], v[144:147]
  ds_read_b128 v[228:231], v6 offset:32768
  v_mfma_f32_16x16x32_bf16 v[148:151], a[248:251], v[200:203], v[148:151]
  ds_read_b128 v[232:235], v7 offset:32768
  buffer_load_dwordx4 a[124:127], v2, s[4:7], s25 offen offset:3072
  s_waitcnt lgkmcnt(4)
  v_mfma_f32_16x16x32_bf16 v[136:139], a[252:255], v[204:207], v[136:139]
  ds_read_b128 v[188:191], v4 offset:36864
  v_mfma_f32_16x16x32_bf16 v[140:143], a[252:255], v[208:211], v[140:143]
  ds_read_b128 v[192:195], v5 offset:36864
  v_mfma_f32_16x16x32_bf16 v[144:147], a[252:255], v[212:215], v[144:147]
  ds_read_b128 v[196:199], v6 offset:36864
  v_mfma_f32_16x16x32_bf16 v[148:151], a[252:255], v[216:219], v[148:151]
  ds_read_b128 v[200:203], v7 offset:36864
  s_add_u32 s25, s25, 4096
  buffer_load_dwordx4 a[128:131], v2, s[4:7], s25 offen offset:0
  s_waitcnt lgkmcnt(4)
  v_mfma_f32_16x16x32_bf16 v[136:139], a[0:3], v[220:223], v[136:139]
  ds_read_b128 v[204:207], v4 offset:40960
  v_mfma_f32_16x16x32_bf16 v[140:143], a[0:3], v[224:227], v[140:143]
  ds_read_b128 v[208:211], v5 offset:40960
  v_mfma_f32_16x16x32_bf16 v[144:147], a[0:3], v[228:231], v[144:147]
  ds_read_b128 v[212:215], v6 offset:40960
  buffer_load_dwordx4 a[132:135], v2, s[4:7], s25 offen offset:1024
  v_mfma_f32_16x16x32_bf16 v[148:151], a[0:3], v[232:235], v[148:151]
  ds_read_b128 v[216:219], v7 offset:40960
  s_cmp_lg_u32 s36, s22
  s_cbranch_scc1 K2_95
  s_waitcnt vmcnt(6)
  v_max_u32 v250, v104, v105
  v_max3_u32 v250, v250, v106, v107
  v_max3_u32 v250, v250, v108, v109
  v_max3_u32 v250, v250, v110, v111
  v_max3_u32 v250, v250, v112, v113
  v_max3_u32 v250, v250, v114, v115
  v_max3_u32 v250, v250, v116, v117
  v_max3_u32 v250, v250, v118, v119
  v_max3_u32 v250, v250, v120, v121
  v_max3_u32 v250, v250, v122, v123
  v_cmp_eq_u32 vcc, -1, v250
  s_cbranch_vccz K2ok_96
  s_add_u32 s26, s64, 0
  buffer_load_dwordx4 v[104:107], v2, s[4:7], s26 offen sc1
  buffer_load_dword v120, v3, s[4:7], s26 offen offset:1024 sc1
  s_add_u32 s26, s26, 1280
  buffer_load_dwordx4 v[108:111], v2, s[4:7], s26 offen sc1
  buffer_load_dword v121, v3, s[4:7], s26 offen offset:1024 sc1
  s_add_u32 s26, s26, 1280
  buffer_load_dwordx4 v[112:115], v2, s[4:7], s26 offen sc1
  buffer_load_dword v122, v3, s[4:7], s26 offen offset:1024 sc1
  s_add_u32 s26, s26, 1280
  buffer_load_dwordx4 v[116:119], v2, s[4:7], s26 offen sc1
  buffer_load_dword v123, v3, s[4:7], s26 offen offset:1024 sc1
  s_waitcnt vmcnt(0)
  v_max_u32 v250, v104, v105
  v_max3_u32 v250, v250, v106, v107
  v_max3_u32 v250, v250, v108, v109
  v_max3_u32 v250, v250, v110, v111
  v_max3_u32 v250, v250, v112, v113
  v_max3_u32 v250, v250, v114, v115
  v_max3_u32 v250, v250, v116, v117
  v_max3_u32 v250, v250, v118, v119
  v_max3_u32 v250, v250, v120, v121
  v_max3_u32 v250, v250, v122, v123
  v_cmp_eq_u32 vcc, -1, v250
  s_cbranch_vccnz SP_97
SPok_98:
K2ok_96:
  v_pk_add_f32 v[104:105], v[104:105], v[108:109]
  v_pk_add_f32 v[112:113], v[112:113], v[116:117]
  v_pk_add_f32 v[106:107], v[106:107], v[110:111]
  v_pk_add_f32 v[114:115], v[114:115], v[118:119]
  v_add_f32 v120, v120, v121
  v_add_f32 v122, v122, v123
  v_pk_add_f32 v[104:105], v[104:105], v[112:113]
  v_pk_add_f32 v[106:107], v[106:107], v[114:115]
  v_add_f32 v126, v120, v122
  v_cvt_pk_bf16_f32 v124, v104, v105
  v_cvt_pk_bf16_f32 v125, v106, v107
  v_mov_b32 v127, 0
  s_add_u32 s26, s65, 262144
  buffer_store_dwordx4 v[124:127], v2, s[4:7], s26 offen sc1
K2_95:
  s_waitcnt lgkmcnt(4)
  v_mfma_f32_16x16x32_bf16 v[136:139], a[4:7], v[188:191], v[136:139]
  ds_read_b128 v[220:223], v4 offset:45056
  v_mfma_f32_16x16x32_bf16 v[140:143], a[4:7], v[192:195], v[140:143]
  ds_read_b128 v[224:227], v5 offset:45056
  buffer_load_dwordx4 a[136:139], v2, s[4:7], s25 offen offset:2048
  v_mfma_f32_16x16x32_bf16 v[144:147], a[4:7], v[196:199], v[144:147]
  ds_read_b128 v[228:231], v6 offset:45056
  v_mfma_f32_16x16x32_bf16 v[148:151], a[4:7], v[200:203], v[148:151]
  ds_read_b128 v[232:235], v7 offset:45056
  s_waitcnt lgkmcnt(4)
  v_mfma_f32_16x16x32_bf16 v[136:139], a[8:11], v[204:207], v[136:139]
  ds_read_b128 v[188:191], v4 offset:49152
  buffer_load_dwordx4 a[140:143], v2, s[4:7], s25 offen offset:3072
  v_mfma_f32_16x16x32_bf16 v[140:143], a[8:11], v[208:211], v[140:143]
  ds_read_b128 v[192:195], v5 offset:49152
  v_mfma_f32_16x16x32_bf16 v[144:147], a[8:11], v[212:215], v[144:147]
  ds_read_b128 v[196:199], v6 offset:49152
  v_mfma_f32_16x16x32_bf16 v[148:151], a[8:11], v[216:219], v[148:151]
  ds_read_b128 v[200:203], v7 offset:49152
  s_add_u32 s25, s25, 4096
  buffer_load_dwordx4 a[144:147], v2, s[4:7], s25 offen offset:0
  s_waitcnt lgkmcnt(4)
  v_mfma_f32_16x16x32_bf16 v[136:139], a[12:15], v[220:223], v[136:139]
  ds_read_b128 v[204:207], v4 offset:53248
  v_mfma_f32_16x16x32_bf16 v[140:143], a[12:15], v[224:227], v[140:143]
  ds_read_b128 v[208:211], v5 offset:53248
  v_mfma_f32_16x16x32_bf16 v[144:147], a[12:15], v[228:231], v[144:147]
  ds_read_b128 v[212:215], v6 offset:53248
  v_mfma_f32_16x16x32_bf16 v[148:151], a[12:15], v[232:235], v[148:151]
  ds_read_b128 v[216:219], v7 offset:53248
  buffer_load_dwordx4 a[148:151], v2, s[4:7], s25 offen offset:1024
  s_waitcnt lgkmcnt(4)
  v_mfma_f32_16x16x32_bf16 v[136:139], a[16:19], v[188:191], v[136:139]
  ds_read_b128 v[220:223], v4 offset:57344
  v_mfma_f32_16x16x32_bf16 v[140:143], a[16:19], v[192:195], v[140:143]
  ds_read_b128 v[224:227], v5 offset:57344
  v_mfma_f32_16x16x32_bf16 v[144:147], a[16:19], v[196:199], v[144:147]
  ds_read_b128 v[228:231], v6 offset:57344
  buffer_load_dwordx4 a[152:155], v2, s[4:7], s25 offen offset:2048
  v_mfma_f32_16x16x32_bf16 v[148:151], a[16:19], v[200:203], v[148:151]
  ds_read_b128 v[232:235], v7 offset:57344
  s_waitcnt vmcnt(29) lgkmcnt(4)
  v_mfma_f32_16x16x32_bf16 v[136:139], a[20:23], v[204:207], v[136:139]
  ds_read_b128 v[188:191], v4 offset:61440
  v_mfma_f32_16x16x32_bf16 v[140:143], a[20:23], v[208:211], v[140:143]
  ds_read_b128 v[192:195], v5 offset:61440
  buffer_load_dwordx4 a[156:159], v2, s[4:7], s25 offen offset:3072
  v_mfma_f32_16x16x32_bf16 v[144:147], a[20:23], v[212:215], v[144:147]
  ds_read_b128 v[196:199], v6 offset:61440
  v_mfma_f32_16x16x32_bf16 v[148:151], a[20:23], v[216:219], v[148:151]
  ds_read_b128 v[200:203], v7 offset:61440
  s_waitcnt lgkmcnt(4)
  v_mfma_f32_16x16x32_bf16 v[136:139], a[24:27], v[220:223], v[136:139]
  s_add_u32 s25, s25, 4096
  buffer_load_dwordx4 a[160:163], v2, s[4:7], s25 offen offset:0
  v_mfma_f32_16x16x32_bf16 v[140:143], a[24:27], v[224:227], v[140:143]
  v_mfma_f32_16x16x32_bf16 v[144:147], a[24:27], v[228:231], v[144:147]
  v_mfma_f32_16x16x32_bf16 v[148:151], a[24:27], v[232:235], v[148:151]
  buffer_load_dwordx4 a[164:167], v2, s[4:7], s25 offen offset:1024
  s_waitcnt lgkmcnt(0)
  v_mfma_f32_16x16x32_bf16 v[136:139], a[28:31], v[188:191], v[136:139]
  v_mfma_f32_16x16x32_bf16 v[140:143], a[28:31], v[192:195], v[140:143]
  v_mfma_f32_16x16x32_bf16 v[144:147], a[28:31], v[196:199], v[144:147]
  v_mfma_f32_16x16x32_bf16 v[148:151], a[28:31], v[200:203], v[148:151]
  buffer_load_dwordx4 a[168:171], v2, s[4:7], s25 offen offset:2048
  ds_read_b128 v[200:203], v14
  ds_read_b128 v[204:207], v15
  ds_read_b128 v[208:211], v16
  ds_read_b128 v[212:215], v17
  s_waitcnt lgkmcnt(0)
  v_pk_mul_f32 v[224:225], v[72:73], v[200:201] op_sel:[0,1] op_sel_hi:[1,1]
  v_pk_mul_f32 v[226:227], v[74:75], v[200:201] op_sel:[0,1] op_sel_hi:[1,1]
  v_pk_mul_f32 v[228:229], v[72:73], v[204:205] op_sel:[0,1] op_sel_hi:[1,1]
  v_pk_mul_f32 v[230:231], v[74:75], v[204:205] op_sel:[0,1] op_sel_hi:[1,1]
  v_pk_fma_f32 v[136:137], v[136:137], v[200:201], v[224:225] op_sel_hi:[1,0,1] neg_lo:[0,0,1] neg_hi:[0,0,1]
  v_pk_fma_f32 v[138:139], v[138:139], v[200:201], v[226:227] op_sel_hi:[1,0,1] neg_lo:[0,0,1] neg_hi:[0,0,1]
  v_pk_fma_f32 v[140:141], v[140:141], v[204:205], v[228:229] op_sel_hi:[1,0,1] neg_lo:[0,0,1] neg_hi:[0,0,1]
  v_pk_fma_f32 v[142:143], v[142:143], v[204:205], v[230:231] op_sel_hi:[1,0,1] neg_lo:[0,0,1] neg_hi:[0,0,1]
  v_pk_mul_f32 v[224:225], v[72:73], v[208:209] op_sel:[0,1] op_sel_hi:[1,1]
  v_pk_mul_f32 v[226:227], v[74:75], v[208:209] op_sel:[0,1] op_sel_hi:[1,1]
  buffer_load_dwordx4 a[172:175], v2, s[4:7], s25 offen offset:3072
  v_pk_mul_f32 v[228:229], v[72:73], v[212:213] op_sel:[0,1] op_sel_hi:[1,1]
  v_pk_mul_f32 v[230:231], v[74:75], v[212:213] op_sel:[0,1] op_sel_hi:[1,1]
  v_pk_fma_f32 v[144:145], v[144:145], v[208:209], v[224:225] op_sel_hi:[1,0,1] neg_lo:[0,0,1] neg_hi:[0,0,1]
  v_pk_fma_f32 v[146:147], v[146:147], v[208:209], v[226:227] op_sel_hi:[1,0,1] neg_lo:[0,0,1] neg_hi:[0,0,1]
  v_pk_fma_f32 v[148:149], v[148:149], v[212:213], v[228:229] op_sel_hi:[1,0,1] neg_lo:[0,0,1] neg_hi:[0,0,1]
  v_pk_fma_f32 v[150:151], v[150:151], v[212:213], v[230:231] op_sel_hi:[1,0,1] neg_lo:[0,0,1] neg_hi:[0,0,1]
  v_pk_mul_f32 v[224:225], v[136:137], v[30:31] op_sel_hi:[1,0]
  v_pk_mul_f32 v[226:227], v[138:139], v[30:31] op_sel_hi:[1,0]
  v_pk_mul_f32 v[228:229], v[140:141], v[30:31] op_sel_hi:[1,0]
  v_pk_mul_f32 v[230:231], v[142:143], v[30:31] op_sel_hi:[1,0]
  v_exp_f32_e64 v224, v224 clamp
  v_exp_f32_e64 v225, v225 clamp
  s_add_u32 s25, s25, 4096
  buffer_load_dwordx4 a[176:179], v2, s[4:7], s25 offen offset:0
  v_exp_f32_e64 v226, v226 clamp
  v_exp_f32_e64 v227, v227 clamp
  v_exp_f32_e64 v228, v228 clamp
  v_exp_f32_e64 v229, v229 clamp
  v_exp_f32_e64 v230, v230 clamp
  v_exp_f32_e64 v231, v231 clamp
  v_max_f32 v136, 0, v136
  v_max_f32 v137, 0, v137
  v_max_f32 v138, 0, v138
  buffer_load_dwordx4 a[180:183], v2, s[4:7], s25 offen offset:1024
  v_max_f32 v139, 0, v139
  v_max_f32 v140, 0, v140
  v_max_f32 v141, 0, v141
  v_max_f32 v142, 0, v142
  v_max_f32 v143, 0, v143
  v_pk_add_f32 v[224:225], v[224:225], v[30:31] op_sel:[0,1] op_sel_hi:[1,1]
  v_pk_add_f32 v[226:227], v[226:227], v[30:31] op_sel:[0,1] op_sel_hi:[1,1]
  v_pk_add_f32 v[228:229], v[228:229], v[30:31] op_sel:[0,1] op_sel_hi:[1,1]
  v_pk_add_f32 v[230:231], v[230:231], v[30:31] op_sel:[0,1] op_sel_hi:[1,1]
  v_pk_add_f32 v[136:137], v[136:137], v[224:225]
  v_pk_add_f32 v[138:139], v[138:139], v[226:227]
  v_pk_add_f32 v[140:141], v[140:141], v[228:229]
  v_pk_add_f32 v[142:143], v[142:143], v[230:231]
  v_pk_mul_f32 v[224:225], v[144:145], v[30:31] op_sel_hi:[1,0]
  buffer_load_dwordx4 a[184:187], v2, s[4:7], s25 offen offset:2048
  v_pk_mul_f32 v[226:227], v[146:147], v[30:31] op_sel_hi:[1,0]
  v_pk_mul_f32 v[228:229], v[148:149], v[30:31] op_sel_hi:[1,0]
  v_pk_mul_f32 v[230:231], v[150:151], v[30:31] op_sel_hi:[1,0]
  v_exp_f32_e64 v224, v224 clamp
  v_exp_f32_e64 v225, v225 clamp
  v_exp_f32_e64 v226, v226 clamp
  v_exp_f32_e64 v227, v227 clamp
  v_exp_f32_e64 v228, v228 clamp
  v_exp_f32_e64 v229, v229 clamp
  buffer_load_dwordx4 a[188:191], v2, s[4:7], s25 offen offset:3072
  v_exp_f32_e64 v230, v230 clamp
  v_exp_f32_e64 v231, v231 clamp
  v_max_f32 v144, 0, v144
  v_max_f32 v145, 0, v145
  v_max_f32 v146, 0, v146
  v_max_f32 v147, 0, v147
  v_max_f32 v148, 0, v148
  v_max_f32 v149, 0, v149
  v_max_f32 v150, 0, v150
  v_max_f32 v151, 0, v151
  v_pk_add_f32 v[224:225], v[224:225], v[30:31] op_sel:[0,1] op_sel_hi:[1,1]
  v_pk_add_f32 v[226:227], v[226:227], v[30:31] op_sel:[0,1] op_sel_hi:[1,1]
  s_add_u32 s25, s25, 4096
  buffer_load_dwordx4 a[192:195], v2, s[4:7], s25 offen offset:0
  v_pk_add_f32 v[228:229], v[228:229], v[30:31] op_sel:[0,1] op_sel_hi:[1,1]
  v_pk_add_f32 v[230:231], v[230:231], v[30:31] op_sel:[0,1] op_sel_hi:[1,1]
  v_pk_add_f32 v[144:145], v[144:145], v[224:225]
  v_pk_add_f32 v[146:147], v[146:147], v[226:227]
  v_pk_add_f32 v[148:149], v[148:149], v[228:229]
  v_pk_add_f32 v[150:151], v[150:151], v[230:231]
  v_cvt_pk_bf16_f32 v64, v136, v137
  v_cvt_pk_bf16_f32 v65, v138, v139
  v_cvt_pk_bf16_f32 v66, v140, v141
  v_cvt_pk_bf16_f32 v67, v142, v143
  v_cvt_pk_bf16_f32 v68, v144, v145
  v_cvt_pk_bf16_f32 v69, v146, v147
  v_cvt_pk_bf16_f32 v70, v148, v149
  v_cvt_pk_bf16_f32 v71, v150, v151
  buffer_load_dwordx4 a[196:199], v2, s[4:7], s25 offen offset:1024
  buffer_load_dwordx4 a[200:203], v2, s[4:7], s25 offen offset:2048
  buffer_load_dwordx4 a[204:207], v2, s[4:7], s25 offen offset:3072
  s_add_u32 s25, s25, 4096
  buffer_load_dwordx4 a[208:211], v2, s[4:7], s25 offen offset:0
  s_add_u32 s26, s66, 262144
  buffer_load_dwordx4 v[176:179], v2, s[4:7], s26 offen offset:0 sc1
  buffer_load_dwordx4 v[180:183], v2, s[4:7], s26 offen offset:1024 sc1
  buffer_load_dwordx4 v[184:187], v2, s[4:7], s26 offen offset:2048 sc1
  buffer_load_dwordx4 v[188:191], v2, s[4:7], s26 offen offset:3072 sc1
  s_add_u32 s26, s26, 4096
  buffer_load_dwordx4 v[192:195], v2, s[4:7], s26 offen offset:0 sc1
  buffer_load_dwordx4 v[196:199], v2, s[4:7], s26 offen offset:1024 sc1
  buffer_load_dwordx4 v[200:203], v2, s[4:7], s26 offen offset:2048 sc1
  buffer_load_dwordx4 v[204:207], v2, s[4:7], s26 offen offset:3072 sc1
  s_waitcnt vmcnt(0)
  v_max_u32 v250, v176, v177
  v_max3_u32 v250, v250, v178, v180
  v_max3_u32 v250, v250, v181, v182
  v_max3_u32 v250, v250, v184, v185
  v_max3_u32 v250, v250, v186, v188
  v_max3_u32 v250, v250, v189, v190
  v_max3_u32 v250, v250, v192, v193
  v_max3_u32 v250, v250, v194, v196
  v_max3_u32 v250, v250, v197, v198
  v_max3_u32 v250, v250, v200, v201
  v_max3_u32 v250, v250, v202, v204
  v_max3_u32 v250, v250, v205, v206
  v_cmp_eq_u32 vcc, -1, v250
  s_cbranch_vccnz SP_101
SPok_102:
  v_mfma_f32_16x16x16_bf16 v[208:211], v[78:79], v[176:177], 0
  v_mfma_f32_16x16x16_bf16 v[208:211], v[78:79], v[180:181], v[208:211]
  v_mfma_f32_16x16x16_bf16 v[208:211], v[78:79], v[184:185], v[208:211]
  v_mfma_f32_16x16x16_bf16 v[208:211], v[78:79], v[188:189], v[208:211]
  v_mfma_f32_16x16x16_bf16 v[208:211], v[78:79], v[192:193], v[208:211]
  v_mfma_f32_16x16x16_bf16 v[208:211], v[78:79], v[196:197], v[208:211]
  v_mfma_f32_16x16x16_bf16 v[208:211], v[78:79], v[200:201], v[208:211]
  v_mfma_f32_16x16x16_bf16 v[208:211], v[78:79], v[204:205], v[208:211]
  v_add_f32 v212, v178, v182
  v_add_f32 v213, v186, v190
  v_add_f32 v214, v194, v198
  v_add_f32 v215, v202, v206
  v_add_f32 v212, v212, v213
  v_add_f32 v214, v214, v215
  v_add_f32 v212, v212, v214
  v_mov_b32_dpp v180, v212 quad_perm:[0,0,0,0] row_mask:0xf bank_mask:0xf
  v_mov_b32_dpp v181, v212 quad_perm:[1,1,1,1] row_mask:0xf bank_mask:0xf
  v_mov_b32_dpp v182, v212 quad_perm:[2,2,2,2] row_mask:0xf bank_mask:0xf
  v_mov_b32_dpp v183, v212 quad_perm:[3,3,3,3] row_mask:0xf bank_mask:0xf
  v_cvt_pk_bf16_f32 v220, v208, v209
  v_cvt_pk_bf16_f32 v221, v210, v211
  v_cvt_pk_bf16_f32 v222, v180, v181
  v_cvt_pk_bf16_f32 v223, v182, v183
  s_nop 1
  v_mfma_f32_16x16x16_bf16 v[120:123], v[222:223], v[64:65], 0
  v_mfma_f32_16x16x16_bf16 v[124:127], v[222:223], v[66:67], 0
  v_mfma_f32_16x16x16_bf16 v[128:131], v[222:223], v[68:69], 0
  v_mfma_f32_16x16x16_bf16 v[132:135], v[222:223], v[70:71], 0
  v_mfma_f32_16x16x16_bf16 v[104:107], v[220:221], v[64:65], 0
  v_mfma_f32_16x16x16_bf16 v[108:111], v[220:221], v[66:67], 0
  v_mfma_f32_16x16x16_bf16 v[112:115], v[220:221], v[68:69], 0
  v_mfma_f32_16x16x16_bf16 v[116:119], v[220:221], v[70:71], 0
  s_nop 0
  v_add_f32 v120, s59, v120
  v_add_f32 v124, s59, v124
  v_add_f32 v128, s59, v128
  v_add_f32 v132, s59, v132
  v_rcp_f32 v120, v120
  v_rcp_f32 v124, v124
  v_rcp_f32 v128, v128
  v_rcp_f32 v132, v132
  v_pk_mul_f32 v[104:105], v[104:105], v[120:121] op_sel_hi:[1,0]
  v_pk_mul_f32 v[106:107], v[106:107], v[120:121] op_sel_hi:[1,0]
  v_pk_mul_f32 v[108:109], v[108:109], v[124:125] op_sel_hi:[1,0]
  v_pk_mul_f32 v[110:111], v[110:111], v[124:125] op_sel_hi:[1,0]
  v_pk_mul_f32 v[112:113], v[112:113], v[128:129] op_sel_hi:[1,0]
  v_pk_mul_f32 v[114:115], v[114:115], v[128:129] op_sel_hi:[1,0]
  v_pk_mul_f32 v[116:117], v[116:117], v[132:133] op_sel_hi:[1,0]
  v_pk_mul_f32 v[118:119], v[118:119], v[132:133] op_sel_hi:[1,0]
  v_cvt_pk_bf16_f32 v176, v104, v105
  v_cvt_pk_bf16_f32 v177, v106, v107
  v_cvt_pk_bf16_f32 v178, v108, v109
  v_cvt_pk_bf16_f32 v179, v110, v111
  v_cvt_pk_bf16_f32 v180, v112, v113
  v_cvt_pk_bf16_f32 v181, v114, v115
  v_cvt_pk_bf16_f32 v182, v116, v117
  v_cvt_pk_bf16_f32 v183, v118, v119
  v_permlane16_swap_b32 v176, v178
  v_permlane16_swap_b32 v177, v179
  v_permlane16_swap_b32 v180, v182
  v_permlane16_swap_b32 v181, v183
  s_add_u32 s26, s3, 0
  s_cmp_eq_u32 s23, 0
  s_cbranch_scc1 XS_105
  buffer_store_dwordx4 v[176:179], v12, s[4:7], s26 offen
  buffer_store_dwordx4 v[180:183], v13, s[4:7], s26 offen
XD_106:
  s_barrier
  s_add_u32 s74, s68, 3072
  v_lshlrev_b32 v251, 7, v1
  buffer_load_dwordx4 a[212:215], v2, s[4:7], s25 offen offset:1024
  buffer_load_dwordx4 a[216:219], v2, s[4:7], s25 offen offset:2048
  s_waitcnt vmcnt(2)
  s_mov_b64 exec, 15
  s_cmp_eq_u32 s23, 0
  s_cbranch_scc1 XS_107
  buffer_store_dword v254, v251, s[4:7], s74 offen
XD_108:
  s_mov_b64 exec, -1
  s_load_dwordx16 s[80:95], s[76:77], 3072
  s_waitcnt lgkmcnt(0)
  s_and_b64 s[80:81], s[80:81], s[82:83]
  s_and_b64 s[84:85], s[84:85], s[86:87]
  s_and_b64 s[88:89], s[88:89], s[90:91]
  s_and_b64 s[92:93], s[92:93], s[94:95]
  s_and_b64 s[80:81], s[80:81], s[84:85]
  s_and_b64 s[88:89], s[88:89], s[92:93]
  s_and_b64 s[80:81], s[80:81], s[88:89]
  s_and_b32 s96, s80, s81
  s_cmp_eq_u32 s96, 1
  s_cbranch_scc0 SQ_109
SQok_110:
  s_add_u32 s72, s24, 0
  s_lshl_b32 s26, s22, 12
  s_add_u32 s72, s72, s26
  s_mov_b32 s73, s26
  s_add_u32 m0, s73, 0
  s_nop 0
  buffer_load_dwordx4 v2, s[4:7], s72 offen offset:0 sc1 lds
  buffer_load_dwordx4 v2, s[4:7], s72 offen offset:1024 sc1 lds
  buffer_load_dwordx4 v2, s[4:7], s72 offen offset:2048 sc1 lds
  buffer_load_dwordx4 v2, s[4:7], s72 offen offset:3072 sc1 lds
  s_add_u32 s72, s72, 16384
  s_add_u32 m0, s73, 16384
  s_nop 0
  buffer_load_dwordx4 v2, s[4:7], s72 offen offset:0 sc1 lds
  buffer_load_dwordx4 v2, s[4:7], s72 offen offset:1024 sc1 lds
  buffer_load_dwordx4 v2, s[4:7], s72 offen offset:2048 sc1 lds
  buffer_load_dwordx4 v2, s[4:7], s72 offen offset:3072 sc1 lds
  s_add_u32 s72, s72, 16384
  s_add_u32 m0, s73, 32768
  s_nop 0
  buffer_load_dwordx4 v2, s[4:7], s72 offen offset:0 sc1 lds
  buffer_load_dwordx4 v2, s[4:7], s72 offen offset:1024 sc1 lds
  buffer_load_dwordx4 v2, s[4:7], s72 offen offset:2048 sc1 lds
  buffer_load_dwordx4 v2, s[4:7], s72 offen offset:3072 sc1 lds
  s_waitcnt vmcnt(8)
  s_barrier
  ds_read_b128 v[188:191], v4 offset:0
  ds_read_b128 v[192:195], v5 offset:0
  ds_read_b128 v[196:199], v6 offset:0
  ds_read_b128 v[200:203], v7 offset:0
  ds_read_b128 v[204:207], v4 offset:4096
  ds_read_b128 v[208:211], v5 offset:4096
  ds_read_b128 v[212:215], v6 offset:4096
  ds_read_b128 v[216:219], v7 offset:4096
  s_waitcnt lgkmcnt(4)
  v_mfma_f32_16x16x32_bf16 v[32:35], a[32:35], v[188:191], v[32:35]
  ds_read_b128 v[220:223], v4 offset:8192
  v_mfma_f32_16x16x32_bf16 v[36:39], a[32:35], v[192:195], v[36:39]
  ds_read_b128 v[224:227], v5 offset:8192
  v_mfma_f32_16x16x32_bf16 v[40:43], a[32:35], v[196:199], v[40:43]
  ds_read_b128 v[228:231], v6 offset:8192
  v_mfma_f32_16x16x32_bf16 v[44:47], a[32:35], v[200:203], v[44:47]
  ds_read_b128 v[232:235], v7 offset:8192
  s_add_u32 s72, s72, 16384
  s_add_u32 m0, s73, 49152
  s_nop 0
  buffer_load_dwordx4 v2, s[4:7], s72 offen offset:0 sc1 lds
  s_waitcnt lgkmcnt(4)
  v_mfma_f32_16x16x32_bf16 v[32:35], a[36:39], v[204:207], v[32:35]
  ds_read_b128 v[188:191], v4 offset:12288
  v_mfma_f32_16x16x32_bf16 v[36:39], a[36:39], v[208:211], v[36:39]
  ds_read_b128 v[192:195], v5 offset:12288
  v_mfma_f32_16x16x32_bf16 v[40:43], a[36:39], v[212:215], v[40:43]
  ds_read_b128 v[196:199], v6 offset:12288
  v_mfma_f32_16x16x32_bf16 v[44:47], a[36:39], v[216:219], v[44:47]
  ds_read_b128 v[200:203], v7 offset:12288
  buffer_load_dwordx4 v2, s[4:7], s72 offen offset:1024 sc1 lds
  s_add_u32 s74, s33, 3584
  v_lshlrev_b32 v251, 7, v1
  s_mov_b64 exec, 15
  buffer_load_dword v250, v251, s[4:7], s74 offen
  s_mov_b64 exec, -1
  s_waitcnt vmcnt(7)
  s_barrier
  s_waitcnt lgkmcnt(4)
  v_mfma_f32_16x16x32_bf16 v[32:35], a[40:43], v[220:223], v[32:35]
  ds_read_b128 v[204:207], v4 offset:16384
  v_mfma_f32_16x16x32_bf16 v[36:39], a[40:43], v[224:227], v[36:39]
  ds_read_b128 v[208:211], v5 offset:16384
  v_mfma_f32_16x16x32_bf16 v[40:43], a[40:43], v[228:231], v[40:43]
  ds_read_b128 v[212:215], v6 offset:16384
  v_mfma_f32_16x16x32_bf16 v[44:47], a[40:43], v[232:235], v[44:47]
  ds_read_b128 v[216:219], v7 offset:16384
  buffer_load_dwordx4 v2, s[4:7], s72 offen offset:2048 sc1 lds
  s_waitcnt lgkmcnt(4)
  v_mfma_f32_16x16x32_bf16 v[32:35], a[44:47], v[188:191], v[32:35]
  ds_read_b128 v[220:223], v4 offset:20480
  v_mfma_f32_16x16x32_bf16 v[36:39], a[44:47], v[192:195], v[36:39]
  ds_read_b128 v[224:227], v5 offset:20480
  v_mfma_f32_16x16x32_bf16 v[40:43], a[44:47], v[196:199], v[40:43]
  ds_read_b128 v[228:231], v6 offset:20480
  v_mfma_f32_16x16x32_bf16 v[44:47], a[44:47], v[200:203], v[44:47]
  ds_read_b128 v[232:235], v7 offset:20480
  buffer_load_dwordx4 v2, s[4:7], s72 offen offset:3072 sc1 lds
  s_waitcnt lgkmcnt(4)
  v_mfma_f32_16x16x32_bf16 v[32:35], a[48:51], v[204:207], v[32:35]
  ds_read_b128 v[188:191], v4 offset:24576
  v_mfma_f32_16x16x32_bf16 v[36:39], a[48:51], v[208:211], v[36:39]
  ds_read_b128 v[192:195], v5 offset:24576
  v_mfma_f32_16x16x32_bf16 v[40:43], a[48:51], v[212:215], v[40:43]
  ds_read_b128 v[196:199], v6 offset:24576
  v_mfma_f32_16x16x32_bf16 v[44:47], a[48:51], v[216:219], v[44:47]
  ds_read_b128 v[200:203], v7 offset:24576
  buffer_load_dwordx4 a[220:223], v2, s[4:7], s25 offen offset:3072
  s_waitcnt lgkmcnt(4)
  v_mfma_f32_16x16x32_bf16 v[32:35], a[52:55], v[220:223], v[32:35]
  ds_read_b128 v[204:207], v4 offset:28672
  v_mfma_f32_16x16x32_bf16 v[36:39], a[52:55], v[224:227], v[36:39]
  ds_read_b128 v[208:211], v5 offset:28672
  v_mfma_f32_16x16x32_bf16 v[40:43], a[52:55], v[228:231], v[40:43]
  ds_read_b128 v[212:215], v6 offset:28672
  v_mfma_f32_16x16x32_bf16 v[44:47], a[52:55], v[232:235], v[44:47]
  ds_read_b128 v[216:219], v7 offset:28672
  s_add_u32 s25, s25, 4096
  buffer_load_dwordx4 a[224:227], v2, s[4:7], s25 offen offset:0
  s_waitcnt vmcnt(7)
  s_barrier
  s_waitcnt lgkmcnt(4)
  v_mfma_f32_16x16x32_bf16 v[32:35], a[56:59], v[188:191], v[32:35]
  ds_read_b128 v[220:223], v4 offset:32768
  v_mfma_f32_16x16x32_bf16 v[36:39], a[56:59], v[192:195], v[36:39]
  ds_read_b128 v[224:227], v5 offset:32768
  v_mfma_f32_16x16x32_bf16 v[40:43], a[56:59], v[196:199], v[40:43]
  ds_read_b128 v[228:231], v6 offset:32768
  v_mfma_f32_16x16x32_bf16 v[44:47], a[56:59], v[200:203], v[44:47]
  ds_read_b128 v[232:235], v7 offset:32768
  buffer_load_dwordx4 a[228:231], v2, s[4:7], s25 offen offset:1024
  s_waitcnt lgkmcnt(4)
  v_mfma_f32_16x16x32_bf16 v[32:35], a[60:63], v[204:207], v[32:35]
  ds_read_b128 v[188:191], v4 offset:36864
  v_mfma_f32_16x16x32_bf16 v[36:39], a[60:63], v[208:211], v[36:39]
  ds_read_b128 v[192:195], v5 offset:36864
  v_mfma_f32_16x16x32_bf16 v[40:43], a[60:63], v[212:215], v[40:43]
  ds_read_b128 v[196:199], v6 offset:36864
  v_mfma_f32_16x16x32_bf16 v[44:47], a[60:63], v[216:219], v[44:47]
  ds_read_b128 v[200:203], v7 offset:36864
  buffer_load_dwordx4 a[232:235], v2, s[4:7], s25 offen offset:2048
  s_waitcnt lgkmcnt(4)
  v_mfma_f32_16x16x32_bf16 v[32:35], a[64:67], v[220:223], v[32:35]
  ds_read_b128 v[204:207], v4 offset:40960
  v_mfma_f32_16x16x32_bf16 v[36:39], a[64:67], v[224:227], v[36:39]
  ds_read_b128 v[208:211], v5 offset:40960
  v_mfma_f32_16x16x32_bf16 v[40:43], a[64:67], v[228:231], v[40:43]
  ds_read_b128 v[212:215], v6 offset:40960
  v_mfma_f32_16x16x32_bf16 v[44:47], a[64:67], v[232:235], v[44:47]
  ds_read_b128 v[216:219], v7 offset:40960
  buffer_load_dwordx4 a[236:239], v2, s[4:7], s25 offen offset:3072
  s_waitcnt lgkmcnt(4)
  v_mfma_f32_16x16x32_bf16 v[32:35], a[68:71], v[188:191], v[32:35]
  ds_read_b128 v[220:223], v4 offset:45056
  v_mfma_f32_16x16x32_bf16 v[36:39], a[68:71], v[192:195], v[36:39]
  ds_read_b128 v[224:227], v5 offset:45056
  v_mfma_f32_16x16x32_bf16 v[40:43], a[68:71], v[196:199], v[40:43]
  ds_read_b128 v[228:231], v6 offset:45056
  v_mfma_f32_16x16x32_bf16 v[44:47], a[68:71], v[200:203], v[44:47]
  ds_read_b128 v[232:235], v7 offset:45056
  s_add_u32 s25, s25, 4096
  buffer_load_dwordx4 a[240:243], v2, s[4:7], s25 offen offset:0
  s_waitcnt vmcnt(6)
  s_barrier
  s_waitcnt lgkmcnt(4)
  v_mfma_f32_16x16x32_bf16 v[32:35], a[72:75], v[204:207], v[32:35]
  ds_read_b128 v[188:191], v4 offset:49152
  v_mfma_f32_16x16x32_bf16 v[36:39], a[72:75], v[208:211], v[36:39]
  ds_read_b128 v[192:195], v5 offset:49152
  v_mfma_f32_16x16x32_bf16 v[40:43], a[72:75], v[212:215], v[40:43]
  ds_read_b128 v[196:199], v6 offset:49152
  v_mfma_f32_16x16x32_bf16 v[44:47], a[72:75], v[216:219], v[44:47]
  ds_read_b128 v[200:203], v7 offset:49152
  s_waitcnt lgkmcnt(4)
  v_mfma_f32_16x16x32_bf16 v[32:35], a[76:79], v[220:223], v[32:35]
  ds_read_b128 v[204:207], v4 offset:53248
  v_mfma_f32_16x16x32_bf16 v[36:39], a[76:79], v[224:227], v[36:39]
  ds_read_b128 v[208:211], v5 offset:53248
  v_mfma_f32_16x16x32_bf16 v[40:43], a[76:79], v[228:231], v[40:43]
  ds_read_b128 v[212:215], v6 offset:53248
  v_mfma_f32_16x16x32_bf16 v[44:47], a[76:79], v[232:235], v[44:47]
  ds_read_b128 v[216:219], v7 offset:53248
  s_waitcnt lgkmcnt(4)
  v_mfma_f32_16x16x32_bf16 v[32:35], a[80:83], v[188:191], v[32:35]
  ds_read_b128 v[220:223], v4 offset:57344
  v_mfma_f32_16x16x32_bf16 v[36:39], a[80:83], v[192:195], v[36:39]
  ds_read_b128 v[224:227], v5 offset:57344
  v_mfma_f32_16x16x32_bf16 v[40:43], a[80:83], v[196:199], v[40:43]
  ds_read_b128 v[228:231], v6 offset:57344
  v_mfma_f32_16x16x32_bf16 v[44:47], a[80:83], v[200:203], v[44:47]
  ds_read_b128 v[232:235], v7 offset:57344
  s_waitcnt lgkmcnt(4)
  v_mfma_f32_16x16x32_bf16 v[32:35], a[84:87], v[204:207], v[32:35]
  ds_read_b128 v[188:191], v4 offset:61440
  v_mfma_f32_16x16x32_bf16 v[36:39], a[84:87], v[208:211], v[36:39]
  ds_read_b128 v[192:195], v5 offset:61440
  v_mfma_f32_16x16x32_bf16 v[40:43], a[84:87], v[212:215], v[40:43]
  ds_read_b128 v[196:199], v6 offset:61440
  v_mfma_f32_16x16x32_bf16 v[44:47], a[84:87], v[216:219], v[44:47]
  ds_read_b128 v[200:203], v7 offset:61440
  s_waitcnt lgkmcnt(4)
  v_mfma_f32_16x16x32_bf16 v[32:35], a[88:91], v[220:223], v[32:35]
  v_mfma_f32_16x16x32_bf16 v[36:39], a[88:91], v[224:227], v[36:39]
  v_mfma_f32_16x16x32_bf16 v[40:43], a[88:91], v[228:231], v[40:43]
  v_mfma_f32_16x16x32_bf16 v[44:47], a[88:91], v[232:235], v[44:47]
  s_waitcnt lgkmcnt(0)
  v_mfma_f32_16x16x32_bf16 v[32:35], a[92:95], v[188:191], v[32:35]
  v_mfma_f32_16x16x32_bf16 v[36:39], a[92:95], v[192:195], v[36:39]
  v_mfma_f32_16x16x32_bf16 v[40:43], a[92:95], v[196:199], v[40:43]
  v_mfma_f32_16x16x32_bf16 v[44:47], a[92:95], v[200:203], v[44:47]
  s_barrier
  s_nop 3
  v_cvt_pk_bf16_f32 v176, v32, v33
  v_cvt_pk_bf16_f32 v177, v34, v35
  v_cvt_pk_bf16_f32 v178, v36, v37
  v_cvt_pk_bf16_f32 v179, v38, v39
  v_cvt_pk_bf16_f32 v180, v40, v41
  v_cvt_pk_bf16_f32 v181, v42, v43
  v_cvt_pk_bf16_f32 v182, v44, v45
  v_cvt_pk_bf16_f32 v183, v46, v47
  v_permlane16_swap_b32 v176, v178
  v_permlane16_swap_b32 v177, v179
  v_permlane16_swap_b32 v180, v182
  v_permlane16_swap_b32 v181, v183
  s_add_u32 s26, s3, 1835008
  s_cmp_eq_u32 s23, 0
  s_cbranch_scc1 XS_113
  buffer_store_dwordx4 v[176:179], v12, s[4:7], s26 offen
  buffer_store_dwordx4 v[180:183], v13, s[4:7], s26 offen
XD_114:
  s_add_u32 s74, s68, 3584
  v_lshlrev_b32 v251, 7, v1
  buffer_load_dwordx4 a[244:247], v2, s[4:7], s25 offen offset:1024
  buffer_load_dwordx4 a[248:251], v2, s[4:7], s25 offen offset:2048
  s_waitcnt vmcnt(2)
  s_mov_b64 exec, 15
  s_cmp_eq_u32 s23, 0
  s_cbranch_scc1 XS_115
  buffer_store_dword v254, v251, s[4:7], s74 offen
XD_116:
  s_mov_b64 exec, -1
  s_load_dwordx16 s[80:95], s[76:77], 3584
  s_waitcnt lgkmcnt(0)
  s_and_b64 s[80:81], s[80:81], s[82:83]
  s_and_b64 s[84:85], s[84:85], s[86:87]
  s_and_b64 s[88:89], s[88:89], s[90:91]
  s_and_b64 s[92:93], s[92:93], s[94:95]
  s_and_b64 s[80:81], s[80:81], s[84:85]
  s_and_b64 s[88:89], s[88:89], s[92:93]
  s_and_b64 s[80:81], s[80:81], s[88:89]
  s_and_b32 s96, s80, s81
  s_cmp_eq_u32 s96, 1
  s_cbranch_scc0 SQ_117
SQok_118:
  s_add_u32 s72, s24, 1835008
  s_lshl_b32 s26, s22, 12
  s_add_u32 s72, s72, s26
  s_mov_b32 s73, s26
  s_add_u32 m0, s73, 0
  s_nop 0
  buffer_load_dwordx4 v2, s[4:7], s72 offen offset:0 sc1 lds
  buffer_load_dwordx4 v2, s[4:7], s72 offen offset:1024 sc1 lds
  buffer_load_dwordx4 v2, s[4:7], s72 offen offset:2048 sc1 lds
  buffer_load_dwordx4 v2, s[4:7], s72 offen offset:3072 sc1 lds
  s_add_u32 s72, s72, 16384
  s_add_u32 m0, s73, 16384
  s_nop 0
  buffer_load_dwordx4 v2, s[4:7], s72 offen offset:0 sc1 lds
  buffer_load_dwordx4 v2, s[4:7], s72 offen offset:1024 sc1 lds
  buffer_load_dwordx4 v2, s[4:7], s72 offen offset:2048 sc1 lds
  buffer_load_dwordx4 v2, s[4:7], s72 offen offset:3072 sc1 lds
  s_add_u32 s72, s72, 16384
  s_add_u32 m0, s73, 32768
  s_nop 0
  buffer_load_dwordx4 v2, s[4:7], s72 offen offset:0 sc1 lds
  buffer_load_dwordx4 v2, s[4:7], s72 offen offset:1024 sc1 lds
  buffer_load_dwordx4 v2, s[4:7], s72 offen offset:2048 sc1 lds
  buffer_load_dwordx4 v2, s[4:7], s72 offen offset:3072 sc1 lds
  s_waitcnt vmcnt(8)
  s_barrier
  ds_read_b128 v[188:191], v4 offset:0
  ds_read_b128 v[192:195], v5 offset:0
  ds_read_b128 v[196:199], v6 offset:0
  ds_read_b128 v[200:203], v7 offset:0
  ds_read_b128 v[204:207], v4 offset:4096
  ds_read_b128 v[208:211], v5 offset:4096
  ds_read_b128 v[212:215], v6 offset:4096
  ds_read_b128 v[216:219], v7 offset:4096
  s_waitcnt lgkmcnt(4)
  v_mfma_f32_16x16x32_bf16 v[104:107], a[96:99], v[188:191], 0
  ds_read_b128 v[220:223], v4 offset:8192
  v_mfma_f32_16x16x32_bf16 v[108:111], a[96:99], v[192:195], 0
  ds_read_b128 v[224:227], v5 offset:8192
  v_mfma_f32_16x16x32_bf16 v[112:115], a[96:99], v[196:199], 0
  ds_read_b128 v[228:231], v6 offset:8192
  v_mfma_f32_16x16x32_bf16 v[116:119], a[96:99], v[200:203], 0
  ds_read_b128 v[232:235], v7 offset:8192
  s_add_u32 s72, s72, 16384
  s_add_u32 m0, s73, 49152
  s_nop 0
  buffer_load_dwordx4 v2, s[4:7], s72 offen offset:0 sc1 lds
  v_mfma_f32_16x16x32_bf16 v[152:155], v[24:27], v[188:191], 0
  v_mfma_f32_16x16x32_bf16 v[156:159], v[188:191], v[188:191], 0
  s_waitcnt lgkmcnt(4)
  v_mfma_f32_16x16x32_bf16 v[104:107], a[100:103], v[204:207], v[104:107]
  ds_read_b128 v[188:191], v4 offset:12288
  v_mfma_f32_16x16x32_bf16 v[108:111], a[100:103], v[208:211], v[108:111]
  ds_read_b128 v[192:195], v5 offset:12288
  buffer_load_dwordx4 v2, s[4:7], s72 offen offset:1024 sc1 lds
  v_mfma_f32_16x16x32_bf16 v[112:115], a[100:103], v[212:215], v[112:115]
  ds_read_b128 v[196:199], v6 offset:12288
  v_mfma_f32_16x16x32_bf16 v[116:119], a[100:103], v[216:219], v[116:119]
  ds_read_b128 v[200:203], v7 offset:12288
  v_mfma_f32_16x16x32_bf16 v[152:155], v[24:27], v[204:207], v[152:155]
  v_mfma_f32_16x16x32_bf16 v[156:159], v[204:207], v[204:207], v[156:159]
  buffer_load_dwordx4 v2, s[4:7], s72 offen offset:2048 sc1 lds
  s_add_u32 s74, s33, 4096
  v_lshlrev_b32 v251, 7, v1
  s_mov_b64 exec, 15
  buffer_load_dword v250, v251, s[4:7], s74 offen
  s_mov_b64 exec, -1
  s_waitcnt vmcnt(8)
  s_barrier
  s_waitcnt lgkmcnt(4)
  v_mfma_f32_16x16x32_bf16 v[104:107], a[104:107], v[220:223], v[104:107]
  ds_read_b128 v[204:207], v4 offset:16384
  v_mfma_f32_16x16x32_bf16 v[108:111], a[104:107], v[224:227], v[108:111]
  ds_read_b128 v[208:211], v5 offset:16384
  v_mfma_f32_16x16x32_bf16 v[112:115], a[104:107], v[228:231], v[112:115]
  ds_read_b128 v[212:215], v6 offset:16384
  v_mfma_f32_16x16x32_bf16 v[116:119], a[104:107], v[232:235], v[116:119]
  ds_read_b128 v[216:219], v7 offset:16384
  buffer_load_dwordx4 v2, s[4:7], s72 offen offset:3072 sc1 lds
  v_mfma_f32_16x16x32_bf16 v[152:155], v[24:27], v[220:223], v[152:155]
  v_mfma_f32_16x16x32_bf16 v[156:159], v[220:223], v[220:223], v[156:159]
  s_waitcnt lgkmcnt(4)
  v_mfma_f32_16x16x32_bf16 v[104:107], a[108:111], v[188:191], v[104:107]
  ds_read_b128 v[220:223], v4 offset:20480
  v_mfma_f32_16x16x32_bf16 v[108:111], a[108:111], v[192:195], v[108:111]
  ds_read_b128 v[224:227], v5 offset:20480
  buffer_load_dwordx4 a[252:255], v2, s[4:7], s25 offen offset:3072
  v_mfma_f32_16x16x32_bf16 v[112:115], a[108:111], v[196:199], v[112:115]
  ds_read_b128 v[228:231], v6 offset:20480
  v_mfma_f32_16x16x32_bf16 v[116:119], a[108:111], v[200:203], v[116:119]
  ds_read_b128 v[232:235], v7 offset:20480
  v_mfma_f32_16x16x32_bf16 v[152:155], v[24:27], v[188:191], v[152:155]
  v_mfma_f32_16x16x32_bf16 v[156:159], v[188:191], v[188:191], v[156:159]
  s_add_u32 s25, s25, 4096
  buffer_load_dwordx4 a[0:3], v2, s[4:7], s25 offen offset:0
  s_waitcnt lgkmcnt(4)
  v_mfma_f32_16x16x32_bf16 v[104:107], a[112:115], v[204:207], v[104:107]
  ds_read_b128 v[188:191], v4 offset:24576
  v_mfma_f32_16x16x32_bf16 v[108:111], a[112:115], v[208:211], v[108:111]
  ds_read_b128 v[192:195], v5 offset:24576
  v_mfma_f32_16x16x32_bf16 v[112:115], a[112:115], v[212:215], v[112:115]
  ds_read_b128 v[196:199], v6 offset:24576
  v_mfma_f32_16x16x32_bf16 v[116:119], a[112:115], v[216:219], v[116:119]
  ds_read_b128 v[200:203], v7 offset:24576
  buffer_load_dwordx4 a[4:7], v2, s[4:7], s25 offen offset:1024
  v_mfma_f32_16x16x32_bf16 v[152:155], v[24:27], v[204:207], v[152:155]
  v_mfma_f32_16x16x32_bf16 v[156:159], v[204:207], v[204:207], v[156:159]
  s_waitcnt lgkmcnt(4)
  v_mfma_f32_16x16x32_bf16 v[104:107], a[116:119], v[220:223], v[104:107]
  ds_read_b128 v[204:207], v4 offset:28672
  v_mfma_f32_16x16x32_bf16 v[108:111], a[116:119], v[224:227], v[108:111]
  ds_read_b128 v[208:211], v5 offset:28672
  buffer_load_dwordx4 a[8:11], v2, s[4:7], s25 offen offset:2048
  v_mfma_f32_16x16x32_bf16 v[112:115], a[116:119], v[228:231], v[112:115]
  ds_read_b128 v[212:215], v6 offset:28672
  v_mfma_f32_16x16x32_bf16 v[116:119], a[116:119], v[232:235], v[116:119]
  ds_read_b128 v[216:219], v7 offset:28672
  v_mfma_f32_16x16x32_bf16 v[152:155], v[24:27], v[220:223], v[152:155]
  v_mfma_f32_16x16x32_bf16 v[156:159], v[220:223], v[220:223], v[156:159]
  buffer_load_dwordx4 a[12:15], v2, s[4:7], s25 offen offset:3072
  s_waitcnt vmcnt(10)
  s_barrier
  s_waitcnt lgkmcnt(4)
  v_mfma_f32_16x16x32_bf16 v[104:107], a[120:123], v[188:191], v[104:107]
  ds_read_b128 v[220:223], v4 offset:32768
  v_mfma_f32_16x16x32_bf16 v[108:111], a[120:123], v[192:195], v[108:111]
  ds_read_b128 v[224:227], v5 offset:32768
  v_mfma_f32_16x16x32_bf16 v[112:115], a[120:123], v[196:199], v[112:115]
  ds_read_b128 v[228:231], v6 offset:32768
  v_mfma_f32_16x16x32_bf16 v[116:119], a[120:123], v[200:203], v[116:119]
  ds_read_b128 v[232:235], v7 offset:32768
  s_add_u32 s25, s25, 4096
  buffer_load_dwordx4 a[16:19], v2, s[4:7], s25 offen offset:0
  v_mfma_f32_16x16x32_bf16 v[152:155], v[24:27], v[188:191], v[152:155]
  v_mfma_f32_16x16x32_bf16 v[156:159], v[188:191], v[188:191], v[156:159]
  s_waitcnt lgkmcnt(4)
  v_mfma_f32_16x16x32_bf16 v[104:107], a[124:127], v[204:207], v[104:107]
  ds_read_b128 v[188:191], v4 offset:36864
  v_mfma_f32_16x16x32_bf16 v[108:111], a[124:127], v[208:211], v[108:111]
  ds_read_b128 v[192:195], v5 offset:36864
  buffer_load_dwordx4 a[20:23], v2, s[4:7], s25 offen offset:1024
  v_mfma_f32_16x16x32_bf16 v[112:115], a[124:127], v[212:215], v[112:115]
  ds_read_b128 v[196:199], v6 offset:36864
  v_mfma_f32_16x16x32_bf16 v[116:119], a[124:127], v[216:219], v[116:119]
  ds_read_b128 v[200:203], v7 offset:36864
  v_mfma_f32_16x16x32_bf16 v[152:155], v[24:27], v[204:207], v[152:155]
  v_mfma_f32_16x16x32_bf16 v[156:159], v[204:207], v[204:207], v[156:159]
  buffer_load_dwordx4 a[24:27], v2, s[4:7], s25 offen offset:2048
  s_waitcnt lgkmcnt(4)
  v_mfma_f32_16x16x32_bf16 v[104:107], a[128:131], v[220:223], v[104:107]
  ds_read_b128 v[204:207], v4 offset:40960
  v_mfma_f32_16x16x32_bf16 v[108:111], a[128:131], v[224:227], v[108:111]
  ds_read_b128 v[208:211], v5 offset:40960
  v_mfma_f32_16x16x32_bf16 v[112:115], a[128:131], v[228:231], v[112:115]
  ds_read_b128 v[212:215], v6 offset:40960
  v_mfma_f32_16x16x32_bf16 v[116:119], a[128:131], v[232:235], v[116:119]
  ds_read_b128 v[216:219], v7 offset:40960
  buffer_load_dwordx4 a[28:31], v2, s[4:7], s25 offen offset:3072
  v_mfma_f32_16x16x32_bf16 v[152:155], v[24:27], v[220:223], v[152:155]
  v_mfma_f32_16x16x32_bf16 v[156:159], v[220:223], v[220:223], v[156:159]
  s_waitcnt lgkmcnt(4)
  v_mfma_f32_16x16x32_bf16 v[104:107], a[132:135], v[188:191], v[104:107]
  ds_read_b128 v[220:223], v4 offset:45056
  v_mfma_f32_16x16x32_bf16 v[108:111], a[132:135], v[192:195], v[108:111]
  ds_read_b128 v[224:227], v5 offset:45056
  s_add_u32 s25, s25, 4096
  buffer_load_dwordx4 a[32:35], v2, s[4:7], s25 offen offset:0
  v_mfma_f32_16x16x32_bf16 v[112:115], a[132:135], v[196:199], v[112:115]
  ds_read_b128 v[228:231], v6 offset:45056
  v_mfma_f32_16x16x32_bf16 v[116:119], a[132:135], v[200:203], v[116:119]
  ds_read_b128 v[232:235], v7 offset:45056
  v_mfma_f32_16x16x32_bf16 v[152:155], v[24:27], v[188:191], v[152:155]
  v_mfma_f32_16x16x32_bf16 v[156:159], v[188:191], v[188:191], v[156:159]
  buffer_load_dwordx4 a[36:39], v2, s[4:7], s25 offen offset:1024
  s_waitcnt vmcnt(11)
  s_barrier
  s_waitcnt lgkmcnt(4)
  v_mfma_f32_16x16x32_bf16 v[104:107], a[136:139], v[204:207], v[104:107]
  ds_read_b128 v[188:191], v4 offset:49152
  v_mfma_f32_16x16x32_bf16 v[108:111], a[136:139], v[208:211], v[108:111]
  ds_read_b128 v[192:195], v5 offset:49152
  v_mfma_f32_16x16x32_bf16 v[112:115], a[136:139], v[212:215], v[112:115]
  ds_read_b128 v[196:199], v6 offset:49152
  v_mfma_f32_16x16x32_bf16 v[116:119], a[136:139], v[216:219], v[116:119]
  ds_read_b128 v[200:203], v7 offset:49152
  buffer_load_dwordx4 a[40:43], v2, s[4:7], s25 offen offset:2048
  v_mfma_f32_16x16x32_bf16 v[152:155], v[24:27], v[204:207], v[152:155]
  v_mfma_f32_16x16x32_bf16 v[156:159], v[204:207], v[204:207], v[156:159]
  s_waitcnt lgkmcnt(4)
  v_mfma_f32_16x16x32_bf16 v[104:107], a[140:143], v[220:223], v[104:107]
  ds_read_b128 v[204:207], v4 offset:53248
  v_mfma_f32_16x16x32_bf16 v[108:111], a[140:143], v[224:227], v[108:111]
  ds_read_b128 v[208:211], v5 offset:53248
  buffer_load_dwordx4 a[44:47], v2, s[4:7], s25 offen offset:3072
  v_mfma_f32_16x16x32_bf16 v[112:115], a[140:143], v[228:231], v[112:115]
  ds_read_b128 v[212:215], v6 offset:53248
  v_mfma_f32_16x16x32_bf16 v[116:119], a[140:143], v[232:235], v[116:119]
  ds_read_b128 v[216:219], v7 offset:53248
  v_mfma_f32_16x16x32_bf16 v[152:155], v[24:27], v[220:223], v[152:155]
  v_mfma_f32_16x16x32_bf16 v[156:159], v[220:223], v[220:223], v[156:159]
  s_add_u32 s25, s25, 4096
  buffer_load_dwordx4 a[48:51], v2, s[4:7], s25 offen offset:0
  s_waitcnt lgkmcnt(4)
  v_mfma_f32_16x16x32_bf16 v[104:107], a[144:147], v[188:191], v[104:107]
  ds_read_b128 v[220:223], v4 offset:57344
  v_mfma_f32_16x16x32_bf16 v[108:111], a[144:147], v[192:195], v[108:111]
  ds_read_b128 v[224:227], v5 offset:57344
  v_mfma_f32_16x16x32_bf16 v[112:115], a[144:147], v[196:199], v[112:115]
  ds_read_b128 v[228:231], v6 offset:57344
  v_mfma_f32_16x16x32_bf16 v[116:119], a[144:147], v[200:203], v[116:119]
  ds_read_b128 v[232:235], v7 offset:57344
  buffer_load_dwordx4 a[52:55], v2, s[4:7], s25 offen offset:1024
  v_mfma_f32_16x16x32_bf16 v[152:155], v[24:27], v[188:191], v[152:155]
  v_mfma_f32_16x16x32_bf16 v[156:159], v[188:191], v[188:191], v[156:159]
  s_waitcnt lgkmcnt(4)
  v_mfma_f32_16x16x32_bf16 v[104:107], a[148:151], v[204:207], v[104:107]
  ds_read_b128 v[188:191], v4 offset:61440
  v_mfma_f32_16x16x32_bf16 v[108:111], a[148:151], v[208:211], v[108:111]
  ds_read_b128 v[192:195], v5 offset:61440
  buffer_load_dwordx4 a[56:59], v2, s[4:7], s25 offen offset:2048
  v_mfma_f32_16x16x32_bf16 v[112:115], a[148:151], v[212:215], v[112:115]
  ds_read_b128 v[196:199], v6 offset:61440
  v_mfma_f32_16x16x32_bf16 v[116:119], a[148:151], v[216:219], v[116:119]
  ds_read_b128 v[200:203], v7 offset:61440
  v_mfma_f32_16x16x32_bf16 v[152:155], v[24:27], v[204:207], v[152:155]
  v_mfma_f32_16x16x32_bf16 v[156:159], v[204:207], v[204:207], v[156:159]
  buffer_load_dwordx4 a[60:63], v2, s[4:7], s25 offen offset:3072
  s_waitcnt lgkmcnt(4)
  v_mfma_f32_16x16x32_bf16 v[104:107], a[152:155], v[220:223], v[104:107]
  v_mfma_f32_16x16x32_bf16 v[108:111], a[152:155], v[224:227], v[108:111]
  v_mfma_f32_16x16x32_bf16 v[112:115], a[152:155], v[228:231], v[112:115]
  v_mfma_f32_16x16x32_bf16 v[116:119], a[152:155], v[232:235], v[116:119]
  s_add_u32 s25, s25, 4096
  buffer_load_dwordx4 a[64:67], v2, s[4:7], s25 offen offset:0
  v_mfma_f32_16x16x32_bf16 v[152:155], v[24:27], v[220:223], v[152:155]
  v_mfma_f32_16x16x32_bf16 v[156:159], v[220:223], v[220:223], v[156:159]
  s_waitcnt lgkmcnt(0)
  v_mfma_f32_16x16x32_bf16 v[104:107], a[156:159], v[188:191], v[104:107]
  v_mfma_f32_16x16x32_bf16 v[108:111], a[156:159], v[192:195], v[108:111]
  buffer_load_dwordx4 a[68:71], v2, s[4:7], s25 offen offset:1024
  v_mfma_f32_16x16x32_bf16 v[112:115], a[156:159], v[196:199], v[112:115]
  v_mfma_f32_16x16x32_bf16 v[116:119], a[156:159], v[200:203], v[116:119]
  v_mfma_f32_16x16x32_bf16 v[152:155], v[24:27], v[188:191], v[152:155]
  v_mfma_f32_16x16x32_bf16 v[156:159], v[188:191], v[188:191], v[156:159]
  buffer_load_dwordx4 a[72:75], v2, s[4:7], s25 offen offset:2048
  s_nop 6
  v_cndmask_b32_e64 v224, v156, v157, s[40:41]
  v_mul_f32 v225, s60, v152
  v_cndmask_b32_e64 v224, v224, v158, s[42:43]
  v_cndmask_b32_e64 v224, v224, v159, s[44:45]
  v_mul_f32 v224, s60, v224
  v_fma_f32 v224, -v225, v225, v224
  v_max_f32 v224, 0, v224
  v_add_f32 v226, s61, v224
  v_rsq_f32 v230, v226
  v_subrev_u32 v232, 131072, v14
  v_mul_f32 v231, v230, v225
  v_lshrrev_b32 v232, 2, v232
  v_add_u32 v232, 132096, v232
  v_mul_f32 v227, v230, v230
  v_mul_f32 v227, v227, v224
  v_add_f32 v227, s61, v227
  v_rsq_f32 v227, v227
  s_nop 0
  v_mul_f32 v228, v230, v227
  v_mul_f32 v229, v231, v227
  s_mov_b64 exec, s[46:47]
  ds_write_b128 v14, v[228:231]
  s_mov_b64 exec, -1
  s_waitcnt lgkmcnt(0)
  s_barrier
  ds_read_b128 v[200:203], v14
  ds_read_b128 v[204:207], v15
  ds_read_b128 v[208:211], v16
  ds_read_b128 v[212:215], v17
  s_waitcnt lgkmcnt(0)
  v_pk_mul_f32 v[224:225], v[84:85], v[200:201] op_sel:[0,1] op_sel_hi:[1,1]
  v_pk_mul_f32 v[226:227], v[86:87], v[200:201] op_sel:[0,1] op_sel_hi:[1,1]
  v_pk_mul_f32 v[228:229], v[84:85], v[204:205] op_sel:[0,1] op_sel_hi:[1,1]
  v_pk_mul_f32 v[230:231], v[86:87], v[204:205] op_sel:[0,1] op_sel_hi:[1,1]
  v_pk_fma_f32 v[104:105], v[104:105], v[200:201], v[224:225] op_sel_hi:[1,0,1] neg_lo:[0,0,1] neg_hi:[0,0,1]
  v_pk_fma_f32 v[106:107], v[106:107], v[200:201], v[226:227] op_sel_hi:[1,0,1] neg_lo:[0,0,1] neg_hi:[0,0,1]
  v_pk_fma_f32 v[108:109], v[108:109], v[204:205], v[228:229] op_sel_hi:[1,0,1] neg_lo:[0,0,1] neg_hi:[0,0,1]
  v_pk_fma_f32 v[110:111], v[110:111], v[204:205], v[230:231] op_sel_hi:[1,0,1] neg_lo:[0,0,1] neg_hi:[0,0,1]
  v_pk_mul_f32 v[224:225], v[84:85], v[208:209] op_sel:[0,1] op_sel_hi:[1,1]
  v_pk_mul_f32 v[226:227], v[86:87], v[208:209] op_sel:[0,1] op_sel_hi:[1,1]
  v_pk_mul_f32 v[228:229], v[84:85], v[212:213] op_sel:[0,1] op_sel_hi:[1,1]
  v_pk_mul_f32 v[230:231], v[86:87], v[212:213] op_sel:[0,1] op_sel_hi:[1,1]
  buffer_load_dwordx4 a[76:79], v2, s[4:7], s25 offen offset:3072
  v_pk_fma_f32 v[112:113], v[112:113], v[208:209], v[224:225] op_sel_hi:[1,0,1] neg_lo:[0,0,1] neg_hi:[0,0,1]
  v_pk_fma_f32 v[114:115], v[114:115], v[208:209], v[226:227] op_sel_hi:[1,0,1] neg_lo:[0,0,1] neg_hi:[0,0,1]
  v_pk_fma_f32 v[116:117], v[116:117], v[212:213], v[228:229] op_sel_hi:[1,0,1] neg_lo:[0,0,1] neg_hi:[0,0,1]
  v_pk_fma_f32 v[118:119], v[118:119], v[212:213], v[230:231] op_sel_hi:[1,0,1] neg_lo:[0,0,1] neg_hi:[0,0,1]
  s_add_u32 s97, s3, 0
  v_pk_mul_f32 v[224:225], v[104:105], v[104:105]
  v_pk_mul_f32 v[226:227], v[106:107], v[106:107]
  v_pk_mul_f32 v[228:229], v[108:109], v[108:109]
  v_pk_mul_f32 v[230:231], v[110:111], v[110:111]
  v_pk_fma_f32 v[224:225], v[224:225], v[28:29], v[28:29] op_sel:[0,1,0] op_sel_hi:[1,1,0]
  v_pk_fma_f32 v[226:227], v[226:227], v[28:29], v[28:29] op_sel:[0,1,0] op_sel_hi:[1,1,0]
  v_pk_fma_f32 v[228:229], v[228:229], v[28:29], v[28:29] op_sel:[0,1,0] op_sel_hi:[1,1,0]
  v_pk_fma_f32 v[230:231], v[230:231], v[28:29], v[28:29] op_sel:[0,1,0] op_sel_hi:[1,1,0]
  v_pk_mul_f32 v[224:225], v[224:225], v[104:105]
  v_pk_mul_f32 v[226:227], v[226:227], v[106:107]
  v_pk_mul_f32 v[228:229], v[228:229], v[108:109]
  v_pk_mul_f32 v[230:231], v[230:231], v[110:111]
  v_exp_f32 v224, v224
  v_exp_f32 v225, v225
  v_exp_f32 v226, v226
  v_exp_f32 v227, v227
  v_exp_f32 v228, v228
  v_exp_f32 v229, v229
  v_exp_f32 v230, v230
  v_exp_f32 v231, v231
  v_pk_add_f32 v[224:225], v[224:225], 1.0 op_sel_hi:[1,0]
  v_pk_add_f32 v[226:227], v[226:227], 1.0 op_sel_hi:[1,0]
  v_pk_add_f32 v[228:229], v[228:229], 1.0 op_sel_hi:[1,0]
  v_pk_add_f32 v[230:231], v[230:231], 1.0 op_sel_hi:[1,0]
  v_rcp_f32 v224, v224
  v_rcp_f32 v225, v225
  v_rcp_f32 v226, v226
  v_rcp_f32 v227, v227
  v_rcp_f32 v228, v228
  v_rcp_f32 v229, v229
  v_rcp_f32 v230, v230
  v_rcp_f32 v231, v231
  v_pk_mul_f32 v[104:105], v[104:105], v[224:225]
  v_pk_mul_f32 v[106:107], v[106:107], v[226:227]
  v_pk_mul_f32 v[108:109], v[108:109], v[228:229]
  v_pk_mul_f32 v[110:111], v[110:111], v[230:231]
  v_cvt_pk_bf16_f32 v176, v104, v105
  v_cvt_pk_bf16_f32 v177, v106, v107
  v_cvt_pk_bf16_f32 v178, v108, v109
  v_cvt_pk_bf16_f32 v179, v110, v111
  s_nop 0
  v_permlane16_swap_b32 v176, v178
  v_permlane16_swap_b32 v177, v179
  s_cmp_eq_u32 s23, 0
  s_cbranch_scc1 XS_121
  buffer_store_dwordx4 v[176:179], v12, s[4:7], s97 offen
XD_122:
  v_pk_mul_f32 v[224:225], v[112:113], v[112:113]
  v_pk_mul_f32 v[226:227], v[114:115], v[114:115]
  v_pk_mul_f32 v[228:229], v[116:117], v[116:117]
  v_pk_mul_f32 v[230:231], v[118:119], v[118:119]
  v_pk_fma_f32 v[224:225], v[224:225], v[28:29], v[28:29] op_sel:[0,1,0] op_sel_hi:[1,1,0]
  v_pk_fma_f32 v[226:227], v[226:227], v[28:29], v[28:29] op_sel:[0,1,0] op_sel_hi:[1,1,0]
  v_pk_fma_f32 v[228:229], v[228:229], v[28:29], v[28:29] op_sel:[0,1,0] op_sel_hi:[1,1,0]
  v_pk_fma_f32 v[230:231], v[230:231], v[28:29], v[28:29] op_sel:[0,1,0] op_sel_hi:[1,1,0]
  v_pk_mul_f32 v[224:225], v[224:225], v[112:113]
  v_pk_mul_f32 v[226:227], v[226:227], v[114:115]
  v_pk_mul_f32 v[228:229], v[228:229], v[116:117]
  v_pk_mul_f32 v[230:231], v[230:231], v[118:119]
  v_exp_f32 v224, v224
  v_exp_f32 v225, v225
  v_exp_f32 v226, v226
  v_exp_f32 v227, v227
  v_exp_f32 v228, v228
  v_exp_f32 v229, v229
  v_exp_f32 v230, v230
  v_exp_f32 v231, v231
  v_pk_add_f32 v[224:225], v[224:225], 1.0 op_sel_hi:[1,0]
  v_pk_add_f32 v[226:227], v[226:227], 1.0 op_sel_hi:[1,0]
  v_pk_add_f32 v[228:229], v[228:229], 1.0 op_sel_hi:[1,0]
  v_pk_add_f32 v[230:231], v[230:231], 1.0 op_sel_hi:[1,0]
  v_rcp_f32 v224, v224
  v_rcp_f32 v225, v225
  v_rcp_f32 v226, v226
  v_rcp_f32 v227, v227
  v_rcp_f32 v228, v228
  v_rcp_f32 v229, v229
  v_rcp_f32 v230, v230
  v_rcp_f32 v231, v231
  v_pk_mul_f32 v[112:113], v[112:113], v[224:225]
  v_pk_mul_f32 v[114:115], v[114:115], v[226:227]
  v_pk_mul_f32 v[116:117], v[116:117], v[228:229]
  v_pk_mul_f32 v[118:119], v[118:119], v[230:231]
  v_cvt_pk_bf16_f32 v180, v112, v113
  v_cvt_pk_bf16_f32 v181, v114, v115
  v_cvt_pk_bf16_f32 v182, v116, v117
  v_cvt_pk_bf16_f32 v183, v118, v119
  s_nop 0
  v_permlane16_swap_b32 v180, v182
  v_permlane16_swap_b32 v181, v183
  s_cmp_eq_u32 s23, 0
  s_cbranch_scc1 XS_123
  buffer_store_dwordx4 v[180:183], v13, s[4:7], s97 offen
XD_124:
  v_pk_fma_f32 v[48:49], v[32:33], v[202:203], v[202:203] op_sel:[0,0,1] op_sel_hi:[1,0,1] neg_lo:[0,0,1] neg_hi:[0,0,1]
  v_pk_fma_f32 v[50:51], v[34:35], v[202:203], v[202:203] op_sel:[0,0,1] op_sel_hi:[1,0,1] neg_lo:[0,0,1] neg_hi:[0,0,1]
  v_pk_fma_f32 v[52:53], v[36:37], v[206:207], v[206:207] op_sel:[0,0,1] op_sel_hi:[1,0,1] neg_lo:[0,0,1] neg_hi:[0,0,1]
  v_pk_fma_f32 v[54:55], v[38:39], v[206:207], v[206:207] op_sel:[0,0,1] op_sel_hi:[1,0,1] neg_lo:[0,0,1] neg_hi:[0,0,1]
  v_pk_fma_f32 v[56:57], v[40:41], v[210:211], v[210:211] op_sel:[0,0,1] op_sel_hi:[1,0,1] neg_lo:[0,0,1] neg_hi:[0,0,1]
  v_pk_fma_f32 v[58:59], v[42:43], v[210:211], v[210:211] op_sel:[0,0,1] op_sel_hi:[1,0,1] neg_lo:[0,0,1] neg_hi:[0,0,1]
  v_pk_fma_f32 v[60:61], v[44:45], v[214:215], v[214:215] op_sel:[0,0,1] op_sel_hi:[1,0,1] neg_lo:[0,0,1] neg_hi:[0,0,1]
  v_pk_fma_f32 v[62:63], v[46:47], v[214:215], v[214:215] op_sel:[0,0,1] op_sel_hi:[1,0,1] neg_lo:[0,0,1] neg_hi:[0,0,1]
  s_add_u32 s74, s68, 4096
  v_lshlrev_b32 v251, 7, v1
  s_add_u32 s25, s25, 4096
  buffer_load_dwordx4 a[80:83], v2, s[4:7], s25 offen offset:0
  buffer_load_dwordx4 a[84:87], v2, s[4:7], s25 offen offset:1024
  s_waitcnt vmcnt(2)
  s_mov_b64 exec, 15
  s_cmp_eq_u32 s23, 0
  s_cbranch_scc1 XS_125
  buffer_store_dword v254, v251, s[4:7], s74 offen
XD_126:
  s_mov_b64 exec, -1
  s_add_u32 s26, s62, 69632
  s_mov_b64 exec, s[48:49]
  s_cbranch_execz HS_127
  buffer_store_dwordx4 v[176:179], v22, s[4:7], s26 offen sc1
HS_127:
  s_mov_b64 exec, -1
  s_mov_b64 exec, s[50:51]
  s_cbranch_execz HS_128
  buffer_store_dwordx4 v[180:183], v23, s[4:7], s26 offen sc1
HS_128:
  s_mov_b64 exec, -1
  s_load_dwordx16 s[80:95], s[76:77], 4096
  s_waitcnt lgkmcnt(0)
  s_and_b64 s[80:81], s[80:81], s[82:83]
  s_and_b64 s[84:85], s[84:85], s[86:87]
  s_and_b64 s[88:89], s[88:89], s[90:91]
  s_and_b64 s[92:93], s[92:93], s[94:95]
  s_and_b64 s[80:81], s[80:81], s[84:85]
  s_and_b64 s[88:89], s[88:89], s[92:93]
  s_and_b64 s[80:81], s[80:81], s[88:89]
  s_and_b32 s96, s80, s81
  s_cmp_eq_u32 s96, 1
  s_cbranch_scc0 SQ_129
SQok_130:
  s_add_u32 s72, s24, 0
  s_lshl_b32 s26, s22, 12
  s_add_u32 s72, s72, s26
  s_mul_i32 s73, s22, 5120
  s_add_u32 s73, s73, 32
  s_add_u32 m0, s73, 0
  s_nop 0
  buffer_load_dwordx4 v2, s[4:7], s72 offen offset:0 sc1 lds
  s_add_u32 m0, s73, 256
  s_nop 0
  buffer_load_dwordx4 v2, s[4:7], s72 offen offset:1024 sc1 lds
  s_add_u32 m0, s73, 512
  s_nop 0
  buffer_load_dwordx4 v2, s[4:7], s72 offen offset:2048 sc1 lds
  s_add_u32 m0, s73, 768
  s_nop 0
  buffer_load_dwordx4 v2, s[4:7], s72 offen offset:3072 sc1 lds
  s_add_u32 s72, s72, 16384
  s_add_u32 m0, s73, 20480
  s_nop 0
  buffer_load_dwordx4 v2, s[4:7], s72 offen offset:0 sc1 lds
  s_add_u32 m0, s73, 20736
  s_nop 0
  buffer_load_dwordx4 v2, s[4:7], s72 offen offset:1024 sc1 lds
  s_add_u32 m0, s73, 20992
  s_nop 0
  buffer_load_dwordx4 v2, s[4:7], s72 offen offset:2048 sc1 lds
  s_add_u32 m0, s73, 21248
  s_nop 0
  buffer_load_dwordx4 v2, s[4:7], s72 offen offset:3072 sc1 lds
  s_add_u32 s72, s72, 16384
  s_add_u32 m0, s73, 40960
  s_nop 0
  buffer_load_dwordx4 v2, s[4:7], s72 offen offset:0 sc1 lds
  s_add_u32 m0, s73, 41216
  s_nop 0
  buffer_load_dwordx4 v2, s[4:7], s72 offen offset:1024 sc1 lds
  s_add_u32 m0, s73, 41472
  s_nop 0
  buffer_load_dwordx4 v2, s[4:7], s72 offen offset:2048 sc1 lds
  s_add_u32 m0, s73, 41728
  s_nop 0
  buffer_load_dwordx4 v2, s[4:7], s72 offen offset:3072 sc1 lds
  s_cmp_lg_u32 s22, 3
  s_cbranch_scc1 HW_133
  v_lshlrev_b32 v184, 5, v1
  s_add_u32 s26, s63, 69632
  buffer_load_dwordx4 v[176:179], v184, s[4:7], s26 offen sc1
  buffer_load_dwordx4 v[180:183], v184, s[4:7], s26 offen offset:16 sc1
  s_waitcnt vmcnt(0)
  v_max_u32 v250, v176, v177
  v_max3_u32 v250, v250, v178, v179
  v_max3_u32 v250, v250, v180, v181
  v_max3_u32 v250, v250, v182, v183
  v_cmp_eq_u32 vcc, -1, v250
  s_cbranch_vccnz SP_134
SPok_135:
  v_mul_u32_u24 v185, 1280, v1
  v_bfe_u32 v186, v1, 4, 1
  v_mul_u32_u24 v186, 1056, v186
  v_add_u32 v185, v185, v186
  ds_write_b128 v185, v[176:179]
  ds_write_b128 v185, v[180:183] offset:16
  s_waitcnt lgkmcnt(0)
HW_133:
  s_waitcnt vmcnt(8)
  s_barrier
  ds_read_b128 v[188:191], v8 offset:16
  ds_read_b128 v[192:195], v9 offset:16
  ds_read_b128 v[196:199], v10 offset:16
  ds_read_b128 v[200:203], v11 offset:16
  ds_read_b128 v[204:207], v8 offset:5136
  ds_read_b128 v[208:211], v9 offset:5136
  ds_read_b128 v[212:215], v10 offset:5136
  ds_read_b128 v[216:219], v11 offset:5136
  s_waitcnt lgkmcnt(4)
  v_mfma_f32_16x16x32_bf16 v[48:51], a[160:163], v[188:191], v[48:51]
  ds_read_b128 v[220:223], v8 offset:10256
  v_mfma_f32_16x16x32_bf16 v[52:55], a[160:163], v[192:195], v[52:55]
  ds_read_b128 v[224:227], v9 offset:10256
  v_mfma_f32_16x16x32_bf16 v[56:59], a[160:163], v[196:199], v[56:59]
  ds_read_b128 v[228:231], v10 offset:10256
  v_mfma_f32_16x16x32_bf16 v[60:63], a[160:163], v[200:203], v[60:63]
  ds_read_b128 v[232:235], v11 offset:10256
  s_add_u32 s72, s72, 16384
  s_add_u32 m0, s73, 61440
  s_nop 0
  buffer_load_dwordx4 v2, s[4:7], s72 offen offset:0 sc1 lds
  s_waitcnt lgkmcnt(4)
  v_mfma_f32_16x16x32_bf16 v[48:51], a[164:167], v[204:207], v[48:51]
  ds_read_b128 v[188:191], v8 offset:15376
  v_mfma_f32_16x16x32_bf16 v[52:55], a[164:167], v[208:211], v[52:55]
  ds_read_b128 v[192:195], v9 offset:15376
  v_mfma_f32_16x16x32_bf16 v[56:59], a[164:167], v[212:215], v[56:59]
  ds_read_b128 v[196:199], v10 offset:15376
  v_mfma_f32_16x16x32_bf16 v[60:63], a[164:167], v[216:219], v[60:63]
  ds_read_b128 v[200:203], v11 offset:15376
  s_add_u32 m0, s73, 61696
  s_nop 0
  buffer_load_dwordx4 v2, s[4:7], s72 offen offset:1024 sc1 lds
  s_add_u32 s74, s33, 4608
  v_lshlrev_b32 v251, 7, v1
  s_mov_b64 exec, 15
  buffer_load_dword v250, v251, s[4:7], s74 offen
  s_mov_b64 exec, -1
  s_waitcnt vmcnt(7)
  s_barrier
  s_waitcnt lgkmcnt(4)
  v_mfma_f32_16x16x32_bf16 v[48:51], a[168:171], v[220:223], v[48:51]
  ds_read_b128 v[204:207], v8 offset:20528
  v_mfma_f32_16x16x32_bf16 v[52:55], a[168:171], v[224:227], v[52:55]
  ds_read_b128 v[208:211], v9 offset:20528
  v_mfma_f32_16x16x32_bf16 v[56:59], a[168:171], v[228:231], v[56:59]
  ds_read_b128 v[212:215], v10 offset:20528
  v_mfma_f32_16x16x32_bf16 v[60:63], a[168:171], v[232:235], v[60:63]
  ds_read_b128 v[216:219], v11 offset:20528
  s_add_u32 m0, s73, 61952
  s_nop 0
  buffer_load_dwordx4 v2, s[4:7], s72 offen offset:2048 sc1 lds
  s_waitcnt lgkmcnt(4)
  v_mfma_f32_16x16x32_bf16 v[48:51], a[172:175], v[188:191], v[48:51]
  ds_read_b128 v[220:223], v8 offset:25648
  v_mfma_f32_16x16x32_bf16 v[52:55], a[172:175], v[192:195], v[52:55]
  ds_read_b128 v[224:227], v9 offset:25648
  v_mfma_f32_16x16x32_bf16 v[56:59], a[172:175], v[196:199], v[56:59]
  ds_read_b128 v[228:231], v10 offset:25648
  v_mfma_f32_16x16x32_bf16 v[60:63], a[172:175], v[200:203], v[60:63]
  ds_read_b128 v[232:235], v11 offset:25648
  s_add_u32 m0, s73, 62208
  s_nop 0
  buffer_load_dwordx4 v2, s[4:7], s72 offen offset:3072 sc1 lds
  s_waitcnt lgkmcnt(4)
  v_mfma_f32_16x16x32_bf16 v[48:51], a[176:179], v[204:207], v[48:51]
  ds_read_b128 v[188:191], v8 offset:30768
  v_mfma_f32_16x16x32_bf16 v[52:55], a[176:179], v[208:211], v[52:55]
  ds_read_b128 v[192:195], v9 offset:30768
  v_mfma_f32_16x16x32_bf16 v[56:59], a[176:179], v[212:215], v[56:59]
  ds_read_b128 v[196:199], v10 offset:30768
  v_mfma_f32_16x16x32_bf16 v[60:63], a[176:179], v[216:219], v[60:63]
  ds_read_b128 v[200:203], v11 offset:30768
  buffer_load_dwordx4 a[88:91], v2, s[4:7], s25 offen offset:2048
  s_waitcnt lgkmcnt(4)
  v_mfma_f32_16x16x32_bf16 v[48:51], a[180:183], v[220:223], v[48:51]
  ds_read_b128 v[204:207], v8 offset:35888
  v_mfma_f32_16x16x32_bf16 v[52:55], a[180:183], v[224:227], v[52:55]
  ds_read_b128 v[208:211], v9 offset:35888
  v_mfma_f32_16x16x32_bf16 v[56:59], a[180:183], v[228:231], v[56:59]
  ds_read_b128 v[212:215], v10 offset:35888
  v_mfma_f32_16x16x32_bf16 v[60:63], a[180:183], v[232:235], v[60:63]
  ds_read_b128 v[216:219], v11 offset:35888
  buffer_load_dwordx4 a[92:95], v2, s[4:7], s25 offen offset:3072
  v_add_u32 v8, 40960, v8
  v_add_u32 v9, 40960, v9
  v_add_u32 v10, 40960, v10
  v_add_u32 v11, 40960, v11
  s_waitcnt vmcnt(7)
  s_barrier
  s_waitcnt lgkmcnt(4)
  v_mfma_f32_16x16x32_bf16 v[48:51], a[184:187], v[188:191], v[48:51]
  ds_read_b128 v[220:223], v8 offset:0
  v_mfma_f32_16x16x32_bf16 v[52:55], a[184:187], v[192:195], v[52:55]
  ds_read_b128 v[224:227], v9 offset:0
  v_mfma_f32_16x16x32_bf16 v[56:59], a[184:187], v[196:199], v[56:59]
  ds_read_b128 v[228:231], v10 offset:0
  v_mfma_f32_16x16x32_bf16 v[60:63], a[184:187], v[200:203], v[60:63]
  ds_read_b128 v[232:235], v11 offset:0
  s_add_u32 s25, s25, 4096
  buffer_load_dwordx4 a[96:99], v2, s[4:7], s25 offen offset:0
  s_waitcnt lgkmcnt(4)
  v_mfma_f32_16x16x32_bf16 v[48:51], a[188:191], v[204:207], v[48:51]
  ds_read_b128 v[188:191], v8 offset:5120
  v_mfma_f32_16x16x32_bf16 v[52:55], a[188:191], v[208:211], v[52:55]
  ds_read_b128 v[192:195], v9 offset:5120
  v_mfma_f32_16x16x32_bf16 v[56:59], a[188:191], v[212:215], v[56:59]
  ds_read_b128 v[196:199], v10 offset:5120
  v_mfma_f32_16x16x32_bf16 v[60:63], a[188:191], v[216:219], v[60:63]
  ds_read_b128 v[200:203], v11 offset:5120
  buffer_load_dwordx4 a[100:103], v2, s[4:7], s25 offen offset:1024
  s_waitcnt lgkmcnt(4)
  v_mfma_f32_16x16x32_bf16 v[48:51], a[192:195], v[220:223], v[48:51]
  ds_read_b128 v[204:207], v8 offset:10240
  v_mfma_f32_16x16x32_bf16 v[52:55], a[192:195], v[224:227], v[52:55]
  ds_read_b128 v[208:211], v9 offset:10240
  v_mfma_f32_16x16x32_bf16 v[56:59], a[192:195], v[228:231], v[56:59]
  ds_read_b128 v[212:215], v10 offset:10240
  v_mfma_f32_16x16x32_bf16 v[60:63], a[192:195], v[232:235], v[60:63]
  ds_read_b128 v[216:219], v11 offset:10240
  buffer_load_dwordx4 a[104:107], v2, s[4:7], s25 offen offset:2048
  s_waitcnt lgkmcnt(4)
  v_mfma_f32_16x16x32_bf16 v[48:51], a[196:199], v[188:191], v[48:51]
  ds_read_b128 v[220:223], v8 offset:15360
  v_mfma_f32_16x16x32_bf16 v[52:55], a[196:199], v[192:195], v[52:55]
  ds_read_b128 v[224:227], v9 offset:15360
  v_mfma_f32_16x16x32_bf16 v[56:59], a[196:199], v[196:199], v[56:59]
  ds_read_b128 v[228:231], v10 offset:15360
  v_mfma_f32_16x16x32_bf16 v[60:63], a[196:199], v[200:203], v[60:63]
  ds_read_b128 v[232:235], v11 offset:15360
  buffer_load_dwordx4 a[108:111], v2, s[4:7], s25 offen offset:3072
  s_waitcnt vmcnt(6)
  s_barrier
  s_waitcnt lgkmcnt(4)
  v_mfma_f32_16x16x32_bf16 v[48:51], a[200:203], v[204:207], v[48:51]
  ds_read_b128 v[188:191], v8 offset:20544
  v_mfma_f32_16x16x32_bf16 v[52:55], a[200:203], v[208:211], v[52:55]
  ds_read_b128 v[192:195], v9 offset:20544
  v_mfma_f32_16x16x32_bf16 v[56:59], a[200:203], v[212:215], v[56:59]
  ds_read_b128 v[196:199], v10 offset:20544
  v_mfma_f32_16x16x32_bf16 v[60:63], a[200:203], v[216:219], v[60:63]
  ds_read_b128 v[200:203], v11 offset:20544
  s_waitcnt lgkmcnt(4)
  v_mfma_f32_16x16x32_bf16 v[48:51], a[204:207], v[220:223], v[48:51]
  ds_read_b128 v[204:207], v8 offset:25664
  v_mfma_f32_16x16x32_bf16 v[52:55], a[204:207], v[224:227], v[52:55]
  ds_read_b128 v[208:211], v9 offset:25664
  v_mfma_f32_16x16x32_bf16 v[56:59], a[204:207], v[228:231], v[56:59]
  ds_read_b128 v[212:215], v10 offset:25664
  v_mfma_f32_16x16x32_bf16 v[60:63], a[204:207], v[232:235], v[60:63]
  ds_read_b128 v[216:219], v11 offset:25664
  s_waitcnt lgkmcnt(4)
  v_mfma_f32_16x16x32_bf16 v[48:51], a[208:211], v[188:191], v[48:51]
  ds_read_b128 v[220:223], v8 offset:30784
  v_mfma_f32_16x16x32_bf16 v[52:55], a[208:211], v[192:195], v[52:55]
  ds_read_b128 v[224:227], v9 offset:30784
  v_mfma_f32_16x16x32_bf16 v[56:59], a[208:211], v[196:199], v[56:59]
  ds_read_b128 v[228:231], v10 offset:30784
  v_mfma_f32_16x16x32_bf16 v[60:63], a[208:211], v[200:203], v[60:63]
  ds_read_b128 v[232:235], v11 offset:30784
  s_waitcnt lgkmcnt(4)
  v_mfma_f32_16x16x32_bf16 v[48:51], a[212:215], v[204:207], v[48:51]
  ds_read_b128 v[188:191], v8 offset:35904
  v_mfma_f32_16x16x32_bf16 v[52:55], a[212:215], v[208:211], v[52:55]
  ds_read_b128 v[192:195], v9 offset:35904
  v_mfma_f32_16x16x32_bf16 v[56:59], a[212:215], v[212:215], v[56:59]
  ds_read_b128 v[196:199], v10 offset:35904
  v_mfma_f32_16x16x32_bf16 v[60:63], a[212:215], v[216:219], v[60:63]
  ds_read_b128 v[200:203], v11 offset:35904
  s_waitcnt lgkmcnt(4)
  v_mfma_f32_16x16x32_bf16 v[48:51], a[216:219], v[220:223], v[48:51]
  v_mfma_f32_16x16x32_bf16 v[52:55], a[216:219], v[224:227], v[52:55]
  v_mfma_f32_16x16x32_bf16 v[56:59], a[216:219], v[228:231], v[56:59]
  v_mfma_f32_16x16x32_bf16 v[60:63], a[216:219], v[232:235], v[60:63]
  s_waitcnt lgkmcnt(0)
  v_mfma_f32_16x16x32_bf16 v[48:51], a[220:223], v[188:191], v[48:51]
  v_mfma_f32_16x16x32_bf16 v[52:55], a[220:223], v[192:195], v[52:55]
  v_mfma_f32_16x16x32_bf16 v[56:59], a[220:223], v[196:199], v[56:59]
  v_mfma_f32_16x16x32_bf16 v[60:63], a[220:223], v[200:203], v[60:63]
  v_subrev_u32 v8, 40960, v8
  v_subrev_u32 v9, 40960, v9
  v_subrev_u32 v10, 40960, v10
  v_subrev_u32 v11, 40960, v11
  s_barrier
  v_cvt_pk_bf16_f32 v176, v48, v49
  v_cvt_pk_bf16_f32 v177, v50, v51
  v_cvt_pk_bf16_f32 v178, v52, v53
  v_cvt_pk_bf16_f32 v179, v54, v55
  v_cvt_pk_bf16_f32 v180, v56, v57
  v_cvt_pk_bf16_f32 v181, v58, v59
  v_cvt_pk_bf16_f32 v182, v60, v61
  v_cvt_pk_bf16_f32 v183, v62, v63
  v_permlane16_swap_b32 v176, v178
  v_permlane16_swap_b32 v177, v179
  v_permlane16_swap_b32 v180, v182
  v_permlane16_swap_b32 v181, v183
  s_add_u32 s26, s3, 1835008
  s_cmp_eq_u32 s23, 0
  s_cbranch_scc1 XS_138
  buffer_store_dwordx4 v[176:179], v12, s[4:7], s26 offen
  buffer_store_dwordx4 v[180:183], v13, s[4:7], s26 offen
XD_139:
  v_pk_add_f32 v[32:33], v[32:33], v[48:49]
  v_pk_add_f32 v[34:35], v[34:35], v[50:51]
  v_pk_add_f32 v[36:37], v[36:37], v[52:53]
  v_pk_add_f32 v[38:39], v[38:39], v[54:55]
  v_pk_add_f32 v[40:41], v[40:41], v[56:57]
  v_pk_add_f32 v[42:43], v[42:43], v[58:59]
  v_pk_add_f32 v[44:45], v[44:45], v[60:61]
  v_pk_add_f32 v[46:47], v[46:47], v[62:63]
  s_add_u32 s74, s68, 4608
  v_lshlrev_b32 v251, 7, v1
  s_add_u32 s25, s25, 4096
  buffer_load_dwordx4 a[112:115], v2, s[4:7], s25 offen offset:0
  buffer_load_dwordx4 a[116:119], v2, s[4:7], s25 offen offset:1024
  s_waitcnt vmcnt(2)
  s_mov_b64 exec, 15
  s_cmp_eq_u32 s23, 0
  s_cbranch_scc1 XS_140
  buffer_store_dword v254, v251, s[4:7], s74 offen
XD_141:
  s_mov_b64 exec, -1
  s_load_dwordx16 s[80:95], s[76:77], 4608
  s_waitcnt lgkmcnt(0)
  s_and_b64 s[80:81], s[80:81], s[82:83]
  s_and_b64 s[84:85], s[84:85], s[86:87]
  s_and_b64 s[88:89], s[88:89], s[90:91]
  s_and_b64 s[92:93], s[92:93], s[94:95]
  s_and_b64 s[80:81], s[80:81], s[84:85]
  s_and_b64 s[88:89], s[88:89], s[92:93]
  s_and_b64 s[80:81], s[80:81], s[88:89]
  s_and_b32 s96, s80, s81
  s_cmp_eq_u32 s96, 1
  s_cbranch_scc0 SQ_142
SQok_143:
  s_add_u32 s72, s24, 1835008
  s_lshl_b32 s26, s22, 12
  s_add_u32 s72, s72, s26
  s_mov_b32 s73, s26
  s_add_u32 m0, s73, 0
  s_nop 0
  buffer_load_dwordx4 v2, s[4:7], s72 offen offset:0 sc1 lds
  buffer_load_dwordx4 v2, s[4:7], s72 offen offset:1024 sc1 lds
  buffer_load_dwordx4 v2, s[4:7], s72 offen offset:2048 sc1 lds
  buffer_load_dwordx4 v2, s[4:7], s72 offen offset:3072 sc1 lds
  s_add_u32 s72, s72, 16384
  s_add_u32 m0, s73, 16384
  s_nop 0
  buffer_load_dwordx4 v2, s[4:7], s72 offen offset:0 sc1 lds
  buffer_load_dwordx4 v2, s[4:7], s72 offen offset:1024 sc1 lds
  buffer_load_dwordx4 v2, s[4:7], s72 offen offset:2048 sc1 lds
  buffer_load_dwordx4 v2, s[4:7], s72 offen offset:3072 sc1 lds
  s_add_u32 s72, s72, 16384
  s_add_u32 m0, s73, 32768
  s_nop 0
  buffer_load_dwordx4 v2, s[4:7], s72 offen offset:0 sc1 lds
  buffer_load_dwordx4 v2, s[4:7], s72 offen offset:1024 sc1 lds
  buffer_load_dwordx4 v2, s[4:7], s72 offen offset:2048 sc1 lds
  buffer_load_dwordx4 v2, s[4:7], s72 offen offset:3072 sc1 lds
  s_waitcnt vmcnt(8)
  s_barrier
  ds_read_b128 v[188:191], v4 offset:0
  ds_read_b128 v[192:195], v5 offset:0
  ds_read_b128 v[196:199], v6 offset:0
  ds_read_b128 v[200:203], v7 offset:0
  ds_read_b128 v[204:207], v4 offset:4096
  ds_read_b128 v[208:211], v5 offset:4096
  ds_read_b128 v[212:215], v6 offset:4096
  ds_read_b128 v[216:219], v7 offset:4096
  s_waitcnt lgkmcnt(4)
  v_mfma_f32_16x16x32_bf16 v[104:107], a[224:227], v[188:191], 0
  ds_read_b128 v[220:223], v4 offset:8192
  v_mfma_f32_16x16x32_bf16 v[108:111], a[224:227], v[192:195], 0
  ds_read_b128 v[224:227], v5 offset:8192
  v_mfma_f32_16x16x32_bf16 v[112:115], a[224:227], v[196:199], 0
  ds_read_b128 v[228:231], v6 offset:8192
  v_mfma_f32_16x16x32_bf16 v[116:119], a[224:227], v[200:203], 0
  ds_read_b128 v[232:235], v7 offset:8192
  s_add_u32 s72, s72, 16384
  s_add_u32 m0, s73, 49152
  s_nop 0
  buffer_load_dwordx4 v2, s[4:7], s72 offen offset:0 sc1 lds
  v_mfma_f32_16x16x32_bf16 v[120:123], a[228:231], v[188:191], 0
  v_mfma_f32_16x16x32_bf16 v[124:127], a[228:231], v[192:195], 0
  v_mfma_f32_16x16x32_bf16 v[128:131], a[228:231], v[196:199], 0
  v_mfma_f32_16x16x32_bf16 v[132:135], a[228:231], v[200:203], 0
  buffer_load_dwordx4 v2, s[4:7], s72 offen offset:1024 sc1 lds
  v_mfma_f32_16x16x32_bf16 v[160:163], v[24:27], v[188:191], 0
  v_mfma_f32_16x16x32_bf16 v[164:167], v[188:191], v[188:191], 0
  s_waitcnt lgkmcnt(4)
  v_mfma_f32_16x16x32_bf16 v[104:107], a[232:235], v[204:207], v[104:107]
  ds_read_b128 v[188:191], v4 offset:12288
  v_mfma_f32_16x16x32_bf16 v[108:111], a[232:235], v[208:211], v[108:111]
  ds_read_b128 v[192:195], v5 offset:12288
  buffer_load_dwordx4 v2, s[4:7], s72 offen offset:2048 sc1 lds
  v_mfma_f32_16x16x32_bf16 v[112:115], a[232:235], v[212:215], v[112:115]
  ds_read_b128 v[196:199], v6 offset:12288
  v_mfma_f32_16x16x32_bf16 v[116:119], a[232:235], v[216:219], v[116:119]
  ds_read_b128 v[200:203], v7 offset:12288
  v_mfma_f32_16x16x32_bf16 v[120:123], a[236:239], v[204:207], v[120:123]
  v_mfma_f32_16x16x32_bf16 v[124:127], a[236:239], v[208:211], v[124:127]
  buffer_load_dwordx4 v2, s[4:7], s72 offen offset:3072 sc1 lds
  v_mfma_f32_16x16x32_bf16 v[128:131], a[236:239], v[212:215], v[128:131]
  v_mfma_f32_16x16x32_bf16 v[132:135], a[236:239], v[216:219], v[132:135]
  v_mfma_f32_16x16x32_bf16 v[160:163], v[24:27], v[204:207], v[160:163]
  v_mfma_f32_16x16x32_bf16 v[164:167], v[204:207], v[204:207], v[164:167]
  buffer_load_dwordx4 a[120:123], v2, s[4:7], s25 offen offset:2048
  s_waitcnt vmcnt(9)
  s_barrier
  s_waitcnt lgkmcnt(4)
  v_mfma_f32_16x16x32_bf16 v[104:107], a[240:243], v[220:223], v[104:107]
  ds_read_b128 v[204:207], v4 offset:16384
  v_mfma_f32_16x16x32_bf16 v[108:111], a[240:243], v[224:227], v[108:111]
  ds_read_b128 v[208:211], v5 offset:16384
  v_mfma_f32_16x16x32_bf16 v[112:115], a[240:243], v[228:231], v[112:115]
  ds_read_b128 v[212:215], v6 offset:16384
  v_mfma_f32_16x16x32_bf16 v[116:119], a[240:243], v[232:235], v[116:119]
  ds_read_b128 v[216:219], v7 offset:16384
  buffer_load_dwordx4 a[124:127], v2, s[4:7], s25 offen offset:3072
  v_mfma_f32_16x16x32_bf16 v[120:123], a[244:247], v[220:223], v[120:123]
  v_mfma_f32_16x16x32_bf16 v[124:127], a[244:247], v[224:227], v[124:127]
  v_mfma_f32_16x16x32_bf16 v[128:131], a[244:247], v[228:231], v[128:131]
  v_mfma_f32_16x16x32_bf16 v[132:135], a[244:247], v[232:235], v[132:135]
  s_add_u32 s25, s25, 4096
  buffer_load_dwordx4 a[128:131], v2, s[4:7], s25 offen offset:0
  v_mfma_f32_16x16x32_bf16 v[160:163], v[24:27], v[220:223], v[160:163]
  v_mfma_f32_16x16x32_bf16 v[164:167], v[220:223], v[220:223], v[164:167]
  s_waitcnt lgkmcnt(4)
  v_mfma_f32_16x16x32_bf16 v[104:107], a[248:251], v[188:191], v[104:107]
  ds_read_b128 v[220:223], v4 offset:20480
  v_mfma_f32_16x16x32_bf16 v[108:111], a[248:251], v[192:195], v[108:111]
  ds_read_b128 v[224:227], v5 offset:20480
  buffer_load_dwordx4 a[132:135], v2, s[4:7], s25 offen offset:1024
  v_mfma_f32_16x16x32_bf16 v[112:115], a[248:251], v[196:199], v[112:115]
  ds_read_b128 v[228:231], v6 offset:20480
  v_mfma_f32_16x16x32_bf16 v[116:119], a[248:251], v[200:203], v[116:119]
  ds_read_b128 v[232:235], v7 offset:20480
  v_mfma_f32_16x16x32_bf16 v[120:123], a[252:255], v[188:191], v[120:123]
  v_mfma_f32_16x16x32_bf16 v[124:127], a[252:255], v[192:195], v[124:127]
  buffer_load_dwordx4 a[136:139], v2, s[4:7], s25 offen offset:2048
  v_mfma_f32_16x16x32_bf16 v[128:131], a[252:255], v[196:199], v[128:131]
  v_mfma_f32_16x16x32_bf16 v[132:135], a[252:255], v[200:203], v[132:135]
  v_mfma_f32_16x16x32_bf16 v[160:163], v[24:27], v[188:191], v[160:163]
  v_mfma_f32_16x16x32_bf16 v[164:167], v[188:191], v[188:191], v[164:167]
  buffer_load_dwordx4 a[140:143], v2, s[4:7], s25 offen offset:3072
  s_add_u32 s27, s24, 1572864
  s_add_u32 s27, s27, s38
  s_lshl_b32 s26, s22, 11
  s_add_u32 s27, s27, s26
  s_add_u32 s27, s27, 0
  buffer_load_dwordx4 v[48:51], v2, s[4:7], s27 offen
  s_waitcnt lgkmcnt(4)
  v_mfma_f32_16x16x32_bf16 v[104:107], a[0:3], v[204:207], v[104:107]
  ds_read_b128 v[188:191], v4 offset:24576
  v_mfma_f32_16x16x32_bf16 v[108:111], a[0:3], v[208:211], v[108:111]
  ds_read_b128 v[192:195], v5 offset:24576
  v_mfma_f32_16x16x32_bf16 v[112:115], a[0:3], v[212:215], v[112:115]
  ds_read_b128 v[196:199], v6 offset:24576
  v_mfma_f32_16x16x32_bf16 v[116:119], a[0:3], v[216:219], v[116:119]
  ds_read_b128 v[200:203], v7 offset:24576
  s_add_u32 s25, s25, 4096
  buffer_load_dwordx4 a[144:147], v2, s[4:7], s25 offen offset:0
  v_mfma_f32_16x16x32_bf16 v[120:123], a[4:7], v[204:207], v[120:123]
  v_mfma_f32_16x16x32_bf16 v[124:127], a[4:7], v[208:211], v[124:127]
  v_mfma_f32_16x16x32_bf16 v[128:131], a[4:7], v[212:215], v[128:131]
  v_mfma_f32_16x16x32_bf16 v[132:135], a[4:7], v[216:219], v[132:135]
  buffer_load_dwordx4 a[148:151], v2, s[4:7], s25 offen offset:1024
  v_mfma_f32_16x16x32_bf16 v[160:163], v[24:27], v[204:207], v[160:163]
  v_mfma_f32_16x16x32_bf16 v[164:167], v[204:207], v[204:207], v[164:167]
  s_waitcnt lgkmcnt(4)
  v_mfma_f32_16x16x32_bf16 v[104:107], a[8:11], v[220:223], v[104:107]
  ds_read_b128 v[204:207], v4 offset:28672
  v_mfma_f32_16x16x32_bf16 v[108:111], a[8:11], v[224:227], v[108:111]
  ds_read_b128 v[208:211], v5 offset:28672
  buffer_load_dwordx4 a[152:155], v2, s[4:7], s25 offen offset:2048
  v_mfma_f32_16x16x32_bf16 v[112:115], a[8:11], v[228:231], v[112:115]
  ds_read_b128 v[212:215], v6 offset:28672
  v_mfma_f32_16x16x32_bf16 v[116:119], a[8:11], v[232:235], v[116:119]
  ds_read_b128 v[216:219], v7 offset:28672
  v_mfma_f32_16x16x32_bf16 v[120:123], a[12:15], v[220:223], v[120:123]
  v_mfma_f32_16x16x32_bf16 v[124:127], a[12:15], v[224:227], v[124:127]
  buffer_load_dwordx4 a[156:159], v2, s[4:7], s25 offen offset:3072
  v_mfma_f32_16x16x32_bf16 v[128:131], a[12:15], v[228:231], v[128:131]
  v_mfma_f32_16x16x32_bf16 v[132:135], a[12:15], v[232:235], v[132:135]
  v_mfma_f32_16x16x32_bf16 v[160:163], v[24:27], v[220:223], v[160:163]
  v_mfma_f32_16x16x32_bf16 v[164:167], v[220:223], v[220:223], v[164:167]
  s_add_u32 s25, s25, 4096
  buffer_load_dwordx4 a[160:163], v2, s[4:7], s25 offen offset:0
  s_waitcnt vmcnt(16)
  s_barrier
  s_waitcnt lgkmcnt(4)
  v_mfma_f32_16x16x32_bf16 v[104:107], a[16:19], v[188:191], v[104:107]
  ds_read_b128 v[220:223], v4 offset:32768
  v_mfma_f32_16x16x32_bf16 v[108:111], a[16:19], v[192:195], v[108:111]
  ds_read_b128 v[224:227], v5 offset:32768
  v_mfma_f32_16x16x32_bf16 v[112:115], a[16:19], v[196:199], v[112:115]
  ds_read_b128 v[228:231], v6 offset:32768
  v_mfma_f32_16x16x32_bf16 v[116:119], a[16:19], v[200:203], v[116:119]
  ds_read_b128 v[232:235], v7 offset:32768
  buffer_load_dwordx4 a[164:167], v2, s[4:7], s25 offen offset:1024
  v_mfma_f32_16x16x32_bf16 v[120:123], a[20:23], v[188:191], v[120:123]
  v_mfma_f32_16x16x32_bf16 v[124:127], a[20:23], v[192:195], v[124:127]
  v_mfma_f32_16x16x32_bf16 v[128:131], a[20:23], v[196:199], v[128:131]
  v_mfma_f32_16x16x32_bf16 v[132:135], a[20:23], v[200:203], v[132:135]
  buffer_load_dwordx4 a[168:171], v2, s[4:7], s25 offen offset:2048
  v_mfma_f32_16x16x32_bf16 v[160:163], v[24:27], v[188:191], v[160:163]
  v_mfma_f32_16x16x32_bf16 v[164:167], v[188:191], v[188:191], v[164:167]
  s_add_u32 s27, s24, 1572864
  s_add_u32 s27, s27, s38
  s_lshl_b32 s26, s22, 11
  s_add_u32 s27, s27, s26
  s_add_u32 s27, s27, 1024
  buffer_load_dwordx4 v[48:51], v2, s[4:7], s27 offen
  s_waitcnt lgkmcnt(4)
  v_mfma_f32_16x16x32_bf16 v[104:107], a[24:27], v[204:207], v[104:107]
  ds_read_b128 v[188:191], v4 offset:36864
  v_mfma_f32_16x16x32_bf16 v[108:111], a[24:27], v[208:211], v[108:111]
  ds_read_b128 v[192:195], v5 offset:36864
  v_mfma_f32_16x16x32_bf16 v[112:115], a[24:27], v[212:215], v[112:115]
  ds_read_b128 v[196:199], v6 offset:36864
  v_mfma_f32_16x16x32_bf16 v[116:119], a[24:27], v[216:219], v[116:119]
  ds_read_b128 v[200:203], v7 offset:36864
  buffer_load_dwordx4 a[172:175], v2, s[4:7], s25 offen offset:3072
  v_mfma_f32_16x16x32_bf16 v[120:123], a[28:31], v[204:207], v[120:123]
  v_mfma_f32_16x16x32_bf16 v[124:127], a[28:31], v[208:211], v[124:127]
  v_mfma_f32_16x16x32_bf16 v[128:131], a[28:31], v[212:215], v[128:131]
  v_mfma_f32_16x16x32_bf16 v[132:135], a[28:31], v[216:219], v[132:135]
  s_add_u32 s25, s25, 4096
  buffer_load_dwordx4 a[176:179], v2, s[4:7], s25 offen offset:0
  v_mfma_f32_16x16x32_bf16 v[160:163], v[24:27], v[204:207], v[160:163]
  v_mfma_f32_16x16x32_bf16 v[164:167], v[204:207], v[204:207], v[164:167]
  s_waitcnt lgkmcnt(4)
  v_mfma_f32_16x16x32_bf16 v[104:107], a[32:35], v[220:223], v[104:107]
  ds_read_b128 v[204:207], v4 offset:40960
  v_mfma_f32_16x16x32_bf16 v[108:111], a[32:35], v[224:227], v[108:111]
  ds_read_b128 v[208:211], v5 offset:40960
  buffer_load_dwordx4 a[180:183], v2, s[4:7], s25 offen offset:1024
  v_mfma_f32_16x16x32_bf16 v[112:115], a[32:35], v[228:231], v[112:115]
  ds_read_b128 v[212:215], v6 offset:40960
  v_mfma_f32_16x16x32_bf16 v[116:119], a[32:35], v[232:235], v[116:119]
  ds_read_b128 v[216:219], v7 offset:40960
  v_mfma_f32_16x16x32_bf16 v[120:123], a[36:39], v[220:223], v[120:123]
  v_mfma_f32_16x16x32_bf16 v[124:127], a[36:39], v[224:227], v[124:127]
  buffer_load_dwordx4 a[184:187], v2, s[4:7], s25 offen offset:2048
  v_mfma_f32_16x16x32_bf16 v[128:131], a[36:39], v[228:231], v[128:131]
  v_mfma_f32_16x16x32_bf16 v[132:135], a[36:39], v[232:235], v[132:135]
  v_mfma_f32_16x16x32_bf16 v[160:163], v[24:27], v[220:223], v[160:163]
  v_mfma_f32_16x16x32_bf16 v[164:167], v[220:223], v[220:223], v[164:167]
  buffer_load_dwordx4 a[188:191], v2, s[4:7], s25 offen offset:3072
  s_waitcnt lgkmcnt(4)
  v_mfma_f32_16x16x32_bf16 v[104:107], a[40:43], v[188:191], v[104:107]
  ds_read_b128 v[220:223], v4 offset:45056
  v_mfma_f32_16x16x32_bf16 v[108:111], a[40:43], v[192:195], v[108:111]
  ds_read_b128 v[224:227], v5 offset:45056
  v_mfma_f32_16x16x32_bf16 v[112:115], a[40:43], v[196:199], v[112:115]
  ds_read_b128 v[228:231], v6 offset:45056
  v_mfma_f32_16x16x32_bf16 v[116:119], a[40:43], v[200:203], v[116:119]
  ds_read_b128 v[232:235], v7 offset:45056
  s_add_u32 s25, s25, 4096
  buffer_load_dwordx4 a[192:195], v2, s[4:7], s25 offen offset:0
  v_mfma_f32_16x16x32_bf16 v[120:123], a[44:47], v[188:191], v[120:123]
  v_mfma_f32_16x16x32_bf16 v[124:127], a[44:47], v[192:195], v[124:127]
  v_mfma_f32_16x16x32_bf16 v[128:131], a[44:47], v[196:199], v[128:131]
  v_mfma_f32_16x16x32_bf16 v[132:135], a[44:47], v[200:203], v[132:135]
  buffer_load_dwordx4 a[196:199], v2, s[4:7], s25 offen offset:1024
  v_mfma_f32_16x16x32_bf16 v[160:163], v[24:27], v[188:191], v[160:163]
  v_mfma_f32_16x16x32_bf16 v[164:167], v[188:191], v[188:191], v[164:167]
  s_add_u32 s27, s24, 1572864
  s_add_u32 s27, s27, s38
  s_lshl_b32 s26, s22, 11
  s_add_u32 s27, s27, s26
  s_add_u32 s27, s27, 8192
  buffer_load_dwordx4 v[48:51], v2, s[4:7], s27 offen
  s_waitcnt vmcnt(23)
  s_barrier
  s_waitcnt lgkmcnt(4)
  v_mfma_f32_16x16x32_bf16 v[104:107], a[48:51], v[204:207], v[104:107]
  ds_read_b128 v[188:191], v4 offset:49152
  v_mfma_f32_16x16x32_bf16 v[108:111], a[48:51], v[208:211], v[108:111]
  ds_read_b128 v[192:195], v5 offset:49152
  v_mfma_f32_16x16x32_bf16 v[112:115], a[48:51], v[212:215], v[112:115]
  ds_read_b128 v[196:199], v6 offset:49152
  v_mfma_f32_16x16x32_bf16 v[116:119], a[48:51], v[216:219], v[116:119]
  ds_read_b128 v[200:203], v7 offset:49152
  buffer_load_dwordx4 a[200:203], v2, s[4:7], s25 offen offset:2048
  v_mfma_f32_16x16x32_bf16 v[120:123], a[52:55], v[204:207], v[120:123]
  v_mfma_f32_16x16x32_bf16 v[124:127], a[52:55], v[208:211], v[124:127]
  v_mfma_f32_16x16x32_bf16 v[128:131], a[52:55], v[212:215], v[128:131]
  v_mfma_f32_16x16x32_bf16 v[132:135], a[52:55], v[216:219], v[132:135]
  buffer_load_dwordx4 a[204:207], v2, s[4:7], s25 offen offset:3072
  v_mfma_f32_16x16x32_bf16 v[160:163], v[24:27], v[204:207], v[160:163]
  v_mfma_f32_16x16x32_bf16 v[164:167], v[204:207], v[204:207], v[164:167]
  s_waitcnt lgkmcnt(4)
  v_mfma_f32_16x16x32_bf16 v[104:107], a[56:59], v[220:223], v[104:107]
  ds_read_b128 v[204:207], v4 offset:53248
  v_mfma_f32_16x16x32_bf16 v[108:111], a[56:59], v[224:227], v[108:111]
  ds_read_b128 v[208:211], v5 offset:53248
  s_add_u32 s25, s25, 4096
  buffer_load_dwordx4 a[208:211], v2, s[4:7], s25 offen offset:0
  v_mfma_f32_16x16x32_bf16 v[112:115], a[56:59], v[228:231], v[112:115]
  ds_read_b128 v[212:215], v6 offset:53248
  v_mfma_f32_16x16x32_bf16 v[116:119], a[56:59], v[232:235], v[116:119]
  ds_read_b128 v[216:219], v7 offset:53248
  v_mfma_f32_16x16x32_bf16 v[120:123], a[60:63], v[220:223], v[120:123]
  v_mfma_f32_16x16x32_bf16 v[124:127], a[60:63], v[224:227], v[124:127]
  buffer_load_dwordx4 a[212:215], v2, s[4:7], s25 offen offset:1024
  v_mfma_f32_16x16x32_bf16 v[128:131], a[60:63], v[228:231], v[128:131]
  v_mfma_f32_16x16x32_bf16 v[132:135], a[60:63], v[232:235], v[132:135]
  v_mfma_f32_16x16x32_bf16 v[160:163], v[24:27], v[220:223], v[160:163]
  v_mfma_f32_16x16x32_bf16 v[164:167], v[220:223], v[220:223], v[164:167]
  buffer_load_dwordx4 a[216:219], v2, s[4:7], s25 offen offset:2048
  s_waitcnt lgkmcnt(4)
  v_mfma_f32_16x16x32_bf16 v[104:107], a[64:67], v[188:191], v[104:107]
  ds_read_b128 v[220:223], v4 offset:57344
  v_mfma_f32_16x16x32_bf16 v[108:111], a[64:67], v[192:195], v[108:111]
  ds_read_b128 v[224:227], v5 offset:57344
  v_mfma_f32_16x16x32_bf16 v[112:115], a[64:67], v[196:199], v[112:115]
  ds_read_b128 v[228:231], v6 offset:57344
  v_mfma_f32_16x16x32_bf16 v[116:119], a[64:67], v[200:203], v[116:119]
  ds_read_b128 v[232:235], v7 offset:57344
  buffer_load_dwordx4 a[220:223], v2, s[4:7], s25 offen offset:3072
  v_mfma_f32_16x16x32_bf16 v[120:123], a[68:71], v[188:191], v[120:123]
  v_mfma_f32_16x16x32_bf16 v[124:127], a[68:71], v[192:195], v[124:127]
  v_mfma_f32_16x16x32_bf16 v[128:131], a[68:71], v[196:199], v[128:131]
  v_mfma_f32_16x16x32_bf16 v[132:135], a[68:71], v[200:203], v[132:135]
  s_add_u32 s25, s25, 4096
  buffer_load_dwordx4 a[224:227], v2, s[4:7], s25 offen offset:0
  v_mfma_f32_16x16x32_bf16 v[160:163], v[24:27], v[188:191], v[160:163]
  v_mfma_f32_16x16x32_bf16 v[164:167], v[188:191], v[188:191], v[164:167]
  s_add_u32 s27, s24, 1572864
  s_add_u32 s27, s27, s38
  s_lshl_b32 s26, s22, 11
  s_add_u32 s27, s27, s26
  s_add_u32 s27, s27, 9216
  buffer_load_dwordx4 v[48:51], v2, s[4:7], s27 offen
  s_waitcnt lgkmcnt(4)
  v_mfma_f32_16x16x32_bf16 v[104:107], a[72:75], v[204:207], v[104:107]
  ds_read_b128 v[188:191], v4 offset:61440
  v_mfma_f32_16x16x32_bf16 v[108:111], a[72:75], v[208:211], v[108:111]
  ds_read_b128 v[192:195], v5 offset:61440
  v_mfma_f32_16x16x32_bf16 v[112:115], a[72:75], v[212:215], v[112:115]
  ds_read_b128 v[196:199], v6 offset:61440
  v_mfma_f32_16x16x32_bf16 v[116:119], a[72:75], v[216:219], v[116:119]
  ds_read_b128 v[200:203], v7 offset:61440
  buffer_load_dwordx4 a[228:231], v2, s[4:7], s25 offen offset:1024
  v_mfma_f32_16x16x32_bf16 v[120:123], a[76:79], v[204:207], v[120:123]
  v_mfma_f32_16x16x32_bf16 v[124:127], a[76:79], v[208:211], v[124:127]
  v_mfma_f32_16x16x32_bf16 v[128:131], a[76:79], v[212:215], v[128:131]
  v_mfma_f32_16x16x32_bf16 v[132:135], a[76:79], v[216:219], v[132:135]
  buffer_load_dwordx4 a[232:235], v2, s[4:7], s25 offen offset:2048
  v_mfma_f32_16x16x32_bf16 v[160:163], v[24:27], v[204:207], v[160:163]
  v_mfma_f32_16x16x32_bf16 v[164:167], v[204:207], v[204:207], v[164:167]
  s_waitcnt lgkmcnt(4)
  v_mfma_f32_16x16x32_bf16 v[104:107], a[80:83], v[220:223], v[104:107]
  v_mfma_f32_16x16x32_bf16 v[108:111], a[80:83], v[224:227], v[108:111]
  buffer_load_dwordx4 a[236:239], v2, s[4:7], s25 offen offset:3072
  v_mfma_f32_16x16x32_bf16 v[112:115], a[80:83], v[228:231], v[112:115]
  v_mfma_f32_16x16x32_bf16 v[116:119], a[80:83], v[232:235], v[116:119]
  v_mfma_f32_16x16x32_bf16 v[120:123], a[84:87], v[220:223], v[120:123]
  v_mfma_f32_16x16x32_bf16 v[124:127], a[84:87], v[224:227], v[124:127]
  s_add_u32 s25, s25, 4096
  buffer_load_dwordx4 a[240:243], v2, s[4:7], s25 offen offset:0
  v_mfma_f32_16x16x32_bf16 v[128:131], a[84:87], v[228:231], v[128:131]
  v_mfma_f32_16x16x32_bf16 v[132:135], a[84:87], v[232:235], v[132:135]
  v_mfma_f32_16x16x32_bf16 v[160:163], v[24:27], v[220:223], v[160:163]
  v_mfma_f32_16x16x32_bf16 v[164:167], v[220:223], v[220:223], v[164:167]
  buffer_load_dwordx4 a[244:247], v2, s[4:7], s25 offen offset:1024
  s_waitcnt lgkmcnt(0)
  v_mfma_f32_16x16x32_bf16 v[104:107], a[88:91], v[188:191], v[104:107]
  v_mfma_f32_16x16x32_bf16 v[108:111], a[88:91], v[192:195], v[108:111]
  v_mfma_f32_16x16x32_bf16 v[112:115], a[88:91], v[196:199], v[112:115]
  v_mfma_f32_16x16x32_bf16 v[116:119], a[88:91], v[200:203], v[116:119]
  buffer_load_dwordx4 a[248:251], v2, s[4:7], s25 offen offset:2048
  v_mfma_f32_16x16x32_bf16 v[120:123], a[92:95], v[188:191], v[120:123]
  v_mfma_f32_16x16x32_bf16 v[124:127], a[92:95], v[192:195], v[124:127]
  v_mfma_f32_16x16x32_bf16 v[128:131], a[92:95], v[196:199], v[128:131]
  v_mfma_f32_16x16x32_bf16 v[132:135], a[92:95], v[200:203], v[132:135]
  buffer_load_dwordx4 a[252:255], v2, s[4:7], s25 offen offset:3072
  v_mfma_f32_16x16x32_bf16 v[160:163], v[24:27], v[188:191], v[160:163]
  v_mfma_f32_16x16x32_bf16 v[164:167], v[188:191], v[188:191], v[164:167]
  s_nop 7
  v_cndmask_b32_e64 v224, v164, v165, s[40:41]
  v_mul_f32 v225, s60, v160
  v_cndmask_b32_e64 v224, v224, v166, s[42:43]
  v_cndmask_b32_e64 v224, v224, v167, s[44:45]
  v_mul_f32 v224, s60, v224
  v_fma_f32 v224, -v225, v225, v224
  v_max_f32 v224, 0, v224
  v_add_f32 v226, s61, v224
  v_rsq_f32 v230, v226
  v_subrev_u32 v232, 131072, v14
  v_mul_f32 v231, v230, v225
  v_lshrrev_b32 v232, 2, v232
  v_add_u32 v232, 132096, v232
  v_mov_b32 v228, v230
  v_mov_b32 v229, v231
  s_mov_b64 exec, s[46:47]
  ds_write_b128 v14, v[228:231]
  s_mov_b64 exec, -1
  s_waitcnt lgkmcnt(0)
  s_barrier
  ds_read_b128 v[200:203], v14
  ds_read_b128 v[204:207], v15
  ds_read_b128 v[208:211], v16
  ds_read_b128 v[212:215], v17
  s_waitcnt lgkmcnt(0)
  v_pk_mul_f32 v[224:225], v[88:89], v[200:201] op_sel:[0,1] op_sel_hi:[1,1]
  v_pk_mul_f32 v[226:227], v[90:91], v[200:201] op_sel:[0,1] op_sel_hi:[1,1]
  v_pk_mul_f32 v[228:229], v[88:89], v[204:205] op_sel:[0,1] op_sel_hi:[1,1]
  v_pk_mul_f32 v[230:231], v[90:91], v[204:205] op_sel:[0,1] op_sel_hi:[1,1]
  s_add_u32 s25, s25, 4096
  buffer_load_dwordx4 a[0:3], v2, s[4:7], s25 offen offset:0
  v_pk_fma_f32 v[104:105], v[104:105], v[200:201], v[224:225] op_sel_hi:[1,0,1] neg_lo:[0,0,1] neg_hi:[0,0,1]
  v_pk_fma_f32 v[106:107], v[106:107], v[200:201], v[226:227] op_sel_hi:[1,0,1] neg_lo:[0,0,1] neg_hi:[0,0,1]
  v_pk_fma_f32 v[108:109], v[108:109], v[204:205], v[228:229] op_sel_hi:[1,0,1] neg_lo:[0,0,1] neg_hi:[0,0,1]
  v_pk_fma_f32 v[110:111], v[110:111], v[204:205], v[230:231] op_sel_hi:[1,0,1] neg_lo:[0,0,1] neg_hi:[0,0,1]
  v_pk_mul_f32 v[224:225], v[88:89], v[208:209] op_sel:[0,1] op_sel_hi:[1,1]
  v_pk_mul_f32 v[226:227], v[90:91], v[208:209] op_sel:[0,1] op_sel_hi:[1,1]
  v_pk_mul_f32 v[228:229], v[88:89], v[212:213] op_sel:[0,1] op_sel_hi:[1,1]
  v_pk_mul_f32 v[230:231], v[90:91], v[212:213] op_sel:[0,1] op_sel_hi:[1,1]
  v_pk_fma_f32 v[112:113], v[112:113], v[208:209], v[224:225] op_sel_hi:[1,0,1] neg_lo:[0,0,1] neg_hi:[0,0,1]
  v_pk_fma_f32 v[114:115], v[114:115], v[208:209], v[226:227] op_sel_hi:[1,0,1] neg_lo:[0,0,1] neg_hi:[0,0,1]
  v_pk_fma_f32 v[116:117], v[116:117], v[212:213], v[228:229] op_sel_hi:[1,0,1] neg_lo:[0,0,1] neg_hi:[0,0,1]
  v_pk_fma_f32 v[118:119], v[118:119], v[212:213], v[230:231] op_sel_hi:[1,0,1] neg_lo:[0,0,1] neg_hi:[0,0,1]
  v_pk_mul_f32 v[224:225], v[104:105], v[104:105]
  v_pk_mul_f32 v[226:227], v[106:107], v[106:107]
  buffer_load_dwordx4 a[4:7], v2, s[4:7], s25 offen offset:1024
  v_pk_mul_f32 v[228:229], v[108:109], v[108:109]
  v_pk_mul_f32 v[230:231], v[110:111], v[110:111]
  v_pk_fma_f32 v[224:225], v[224:225], v[28:29], v[28:29] op_sel:[0,1,0] op_sel_hi:[1,1,0]
  v_pk_fma_f32 v[226:227], v[226:227], v[28:29], v[28:29] op_sel:[0,1,0] op_sel_hi:[1,1,0]
  v_pk_fma_f32 v[228:229], v[228:229], v[28:29], v[28:29] op_sel:[0,1,0] op_sel_hi:[1,1,0]
  v_pk_fma_f32 v[230:231], v[230:231], v[28:29], v[28:29] op_sel:[0,1,0] op_sel_hi:[1,1,0]
  v_pk_mul_f32 v[224:225], v[224:225], v[104:105]
  v_pk_mul_f32 v[226:227], v[226:227], v[106:107]
  v_pk_mul_f32 v[228:229], v[228:229], v[108:109]
  v_pk_mul_f32 v[230:231], v[230:231], v[110:111]
  v_exp_f32 v224, v224
  v_exp_f32 v225, v225
  buffer_load_dwordx4 a[8:11], v2, s[4:7], s25 offen offset:2048
  v_exp_f32 v226, v226
  v_exp_f32 v227, v227
  v_exp_f32 v228, v228
  v_exp_f32 v229, v229
  v_exp_f32 v230, v230
  v_exp_f32 v231, v231
  v_pk_add_f32 v[224:225], v[224:225], 1.0 op_sel_hi:[1,0]
  v_pk_add_f32 v[226:227], v[226:227], 1.0 op_sel_hi:[1,0]
  v_pk_add_f32 v[228:229], v[228:229], 1.0 op_sel_hi:[1,0]
  buffer_load_dwordx4 a[12:15], v2, s[4:7], s25 offen offset:3072
  v_pk_add_f32 v[230:231], v[230:231], 1.0 op_sel_hi:[1,0]
  v_rcp_f32 v224, v224
  v_rcp_f32 v225, v225
  v_rcp_f32 v226, v226
  v_rcp_f32 v227, v227
  v_rcp_f32 v228, v228
  v_rcp_f32 v229, v229
  v_rcp_f32 v230, v230
  s_add_u32 s25, s25, 4096
  buffer_load_dwordx4 a[16:19], v2, s[4:7], s25 offen offset:0
  v_rcp_f32 v231, v231
  v_pk_mul_f32 v[104:105], v[104:105], v[224:225]
  v_pk_mul_f32 v[106:107], v[106:107], v[226:227]
  v_pk_mul_f32 v[108:109], v[108:109], v[228:229]
  v_pk_mul_f32 v[110:111], v[110:111], v[230:231]
  v_pk_mul_f32 v[224:225], v[112:113], v[112:113]
  v_pk_mul_f32 v[226:227], v[114:115], v[114:115]
  v_pk_mul_f32 v[228:229], v[116:117], v[116:117]
  v_pk_mul_f32 v[230:231], v[118:119], v[118:119]
  v_pk_fma_f32 v[224:225], v[224:225], v[28:29], v[28:29] op_sel:[0,1,0] op_sel_hi:[1,1,0]
  v_pk_fma_f32 v[226:227], v[226:227], v[28:29], v[28:29] op_sel:[0,1,0] op_sel_hi:[1,1,0]
  v_pk_fma_f32 v[228:229], v[228:229], v[28:29], v[28:29] op_sel:[0,1,0] op_sel_hi:[1,1,0]
  v_pk_fma_f32 v[230:231], v[230:231], v[28:29], v[28:29] op_sel:[0,1,0] op_sel_hi:[1,1,0]
  buffer_load_dwordx4 a[20:23], v2, s[4:7], s25 offen offset:1024
  v_pk_mul_f32 v[224:225], v[224:225], v[112:113]
  v_pk_mul_f32 v[226:227], v[226:227], v[114:115]
  v_pk_mul_f32 v[228:229], v[228:229], v[116:117]
  v_pk_mul_f32 v[230:231], v[230:231], v[118:119]
  v_exp_f32 v224, v224
  v_exp_f32 v225, v225
  v_exp_f32 v226, v226
  v_exp_f32 v227, v227
  v_exp_f32 v228, v228
  v_exp_f32 v229, v229
  buffer_load_dwordx4 a[24:27], v2, s[4:7], s25 offen offset:2048
  v_exp_f32 v230, v230
  v_exp_f32 v231, v231
  v_pk_add_f32 v[224:225], v[224:225], 1.0 op_sel_hi:[1,0]
  v_pk_add_f32 v[226:227], v[226:227], 1.0 op_sel_hi:[1,0]
  v_pk_add_f32 v[228:229], v[228:229], 1.0 op_sel_hi:[1,0]
  v_pk_add_f32 v[230:231], v[230:231], 1.0 op_sel_hi:[1,0]
  v_rcp_f32 v224, v224
  v_rcp_f32 v225, v225
  v_rcp_f32 v226, v226
  v_rcp_f32 v227, v227
  buffer_load_dwordx4 a[28:31], v2, s[4:7], s25 offen offset:3072
  v_rcp_f32 v228, v228
  v_rcp_f32 v229, v229
  v_rcp_f32 v230, v230
  v_rcp_f32 v231, v231
  v_pk_mul_f32 v[112:113], v[112:113], v[224:225]
  v_pk_mul_f32 v[114:115], v[114:115], v[226:227]
  v_pk_mul_f32 v[116:117], v[116:117], v[228:229]
  v_pk_mul_f32 v[118:119], v[118:119], v[230:231]
  v_cvt_pk_bf16_f32 v176, v104, v105
  v_cvt_pk_bf16_f32 v177, v106, v107
  v_cvt_pk_bf16_f32 v178, v108, v109
  v_cvt_pk_bf16_f32 v179, v110, v111
  v_cvt_pk_bf16_f32 v180, v112, v113
  v_cvt_pk_bf16_f32 v181, v114, v115
  v_cvt_pk_bf16_f32 v182, v116, v117
  v_cvt_pk_bf16_f32 v183, v118, v119
  v_permlane16_swap_b32 v176, v178
  v_permlane16_swap_b32 v177, v179
  v_permlane16_swap_b32 v180, v182
  v_permlane16_swap_b32 v181, v183
  s_lshl_b32 s28, s22, 11
  s_add_u32 s28, s28, 0
  s_add_u32 s29, s28, 65536
  v_add_u32 v250, s29, v12
  v_add_u32 v251, s29, v13
  ds_write_b128 v250, v[176:179]
  ds_write_b128 v251, v[180:183]
  s_add_u32 s27, s24, 1572864
  s_add_u32 s97, s27, s38
  s_add_u32 s97, s97, s28
  s_cmp_eq_u32 s23, 0
  s_cbranch_scc1 XS_146
  buffer_store_dwordx4 v[176:179], v12, s[4:7], s97 offen
XD_147:
  v_pk_mul_f32 v[224:225], v[92:93], v[200:201] op_sel:[0,1] op_sel_hi:[1,1]
  v_pk_mul_f32 v[226:227], v[94:95], v[200:201] op_sel:[0,1] op_sel_hi:[1,1]
  v_pk_mul_f32 v[228:229], v[92:93], v[204:205] op_sel:[0,1] op_sel_hi:[1,1]
  s_add_u32 s25, s25, 4096
  buffer_load_dwordx4 a[32:35], v2, s[4:7], s25 offen offset:0
  v_pk_mul_f32 v[230:231], v[94:95], v[204:205] op_sel:[0,1] op_sel_hi:[1,1]
  v_pk_fma_f32 v[120:121], v[120:121], v[200:201], v[224:225] op_sel_hi:[1,0,1] neg_lo:[0,0,1] neg_hi:[0,0,1]
  v_pk_fma_f32 v[122:123], v[122:123], v[200:201], v[226:227] op_sel_hi:[1,0,1] neg_lo:[0,0,1] neg_hi:[0,0,1]
  v_pk_fma_f32 v[124:125], v[124:125], v[204:205], v[228:229] op_sel_hi:[1,0,1] neg_lo:[0,0,1] neg_hi:[0,0,1]
  v_pk_fma_f32 v[126:127], v[126:127], v[204:205], v[230:231] op_sel_hi:[1,0,1] neg_lo:[0,0,1] neg_hi:[0,0,1]
  v_pk_mul_f32 v[224:225], v[92:93], v[208:209] op_sel:[0,1] op_sel_hi:[1,1]
  v_pk_mul_f32 v[226:227], v[94:95], v[208:209] op_sel:[0,1] op_sel_hi:[1,1]
  v_pk_mul_f32 v[228:229], v[92:93], v[212:213] op_sel:[0,1] op_sel_hi:[1,1]
  v_pk_mul_f32 v[230:231], v[94:95], v[212:213] op_sel:[0,1] op_sel_hi:[1,1]
  v_pk_fma_f32 v[128:129], v[128:129], v[208:209], v[224:225] op_sel_hi:[1,0,1] neg_lo:[0,0,1] neg_hi:[0,0,1]
  v_pk_fma_f32 v[130:131], v[130:131], v[208:209], v[226:227] op_sel_hi:[1,0,1] neg_lo:[0,0,1] neg_hi:[0,0,1]
  v_pk_fma_f32 v[132:133], v[132:133], v[212:213], v[228:229] op_sel_hi:[1,0,1] neg_lo:[0,0,1] neg_hi:[0,0,1]
  v_pk_fma_f32 v[134:135], v[134:135], v[212:213], v[230:231] op_sel_hi:[1,0,1] neg_lo:[0,0,1] neg_hi:[0,0,1]
  v_pk_mul_f32 v[224:225], v[120:121], v[120:121]
  buffer_load_dwordx4 a[36:39], v2, s[4:7], s25 offen offset:1024
  v_pk_mul_f32 v[226:227], v[122:123], v[122:123]
  v_pk_mul_f32 v[228:229], v[124:125], v[124:125]
  v_pk_mul_f32 v[230:231], v[126:127], v[126:127]
  v_pk_fma_f32 v[224:225], v[224:225], v[28:29], v[28:29] op_sel:[0,1,0] op_sel_hi:[1,1,0]
  v_pk_fma_f32 v[226:227], v[226:227], v[28:29], v[28:29] op_sel:[0,1,0] op_sel_hi:[1,1,0]
  v_pk_fma_f32 v[228:229], v[228:229], v[28:29], v[28:29] op_sel:[0,1,0] op_sel_hi:[1,1,0]
  v_pk_fma_f32 v[230:231], v[230:231], v[28:29], v[28:29] op_sel:[0,1,0] op_sel_hi:[1,1,0]
  v_pk_mul_f32 v[224:225], v[224:225], v[120:121]
  v_pk_mul_f32 v[226:227], v[226:227], v[122:123]
  v_pk_mul_f32 v[228:229], v[228:229], v[124:125]
  v_pk_mul_f32 v[230:231], v[230:231], v[126:127]
  v_exp_f32 v224, v224
  v_exp_f32 v225, v225
  buffer_load_dwordx4 a[40:43], v2, s[4:7], s25 offen offset:2048
  v_exp_f32 v226, v226
  v_exp_f32 v227, v227
  v_exp_f32 v228, v228
  v_exp_f32 v229, v229
  v_exp_f32 v230, v230
  v_exp_f32 v231, v231
  s_cmp_eq_u32 s23, 0
  s_cbranch_scc1 XS_148
  buffer_store_dwordx4 v[180:183], v13, s[4:7], s97 offen
XD_149:
  v_pk_add_f32 v[224:225], v[224:225], 1.0 op_sel_hi:[1,0]
  v_pk_add_f32 v[226:227], v[226:227], 1.0 op_sel_hi:[1,0]
  v_pk_add_f32 v[228:229], v[228:229], 1.0 op_sel_hi:[1,0]
  v_pk_add_f32 v[230:231], v[230:231], 1.0 op_sel_hi:[1,0]
  v_rcp_f32 v224, v224
  v_rcp_f32 v225, v225
  v_rcp_f32 v226, v226
  v_rcp_f32 v227, v227
  v_rcp_f32 v228, v228
  v_rcp_f32 v229, v229
  buffer_load_dwordx4 a[44:47], v2, s[4:7], s25 offen offset:3072
  v_rcp_f32 v230, v230
  v_rcp_f32 v231, v231
  v_pk_mul_f32 v[120:121], v[120:121], v[224:225]
  v_pk_mul_f32 v[122:123], v[122:123], v[226:227]
  v_pk_mul_f32 v[124:125], v[124:125], v[228:229]
  v_pk_mul_f32 v[126:127], v[126:127], v[230:231]
  v_pk_mul_f32 v[224:225], v[128:129], v[128:129]
  v_pk_mul_f32 v[226:227], v[130:131], v[130:131]
  v_pk_mul_f32 v[228:229], v[132:133], v[132:133]
  v_pk_mul_f32 v[230:231], v[134:135], v[134:135]
  v_pk_fma_f32 v[224:225], v[224:225], v[28:29], v[28:29] op_sel:[0,1,0] op_sel_hi:[1,1,0]
  v_pk_fma_f32 v[226:227], v[226:227], v[28:29], v[28:29] op_sel:[0,1,0] op_sel_hi:[1,1,0]
  s_add_u32 s25, s25, 4096
  buffer_load_dwordx4 a[48:51], v2, s[4:7], s25 offen offset:0
  v_pk_fma_f32 v[228:229], v[228:229], v[28:29], v[28:29] op_sel:[0,1,0] op_sel_hi:[1,1,0]
  v_pk_fma_f32 v[230:231], v[230:231], v[28:29], v[28:29] op_sel:[0,1,0] op_sel_hi:[1,1,0]
  v_pk_mul_f32 v[224:225], v[224:225], v[128:129]
  v_pk_mul_f32 v[226:227], v[226:227], v[130:131]
  v_pk_mul_f32 v[228:229], v[228:229], v[132:133]
  v_pk_mul_f32 v[230:231], v[230:231], v[134:135]
  v_exp_f32 v224, v224
  v_exp_f32 v225, v225
  v_exp_f32 v226, v226
  v_exp_f32 v227, v227
  v_exp_f32 v228, v228
  buffer_load_dwordx4 a[52:55], v2, s[4:7], s25 offen offset:1024
  v_exp_f32 v229, v229
  v_exp_f32 v230, v230
  v_exp_f32 v231, v231
  v_pk_add_f32 v[224:225], v[224:225], 1.0 op_sel_hi:[1,0]
  v_pk_add_f32 v[226:227], v[226:227], 1.0 op_sel_hi:[1,0]
  v_pk_add_f32 v[228:229], v[228:229], 1.0 op_sel_hi:[1,0]
  v_pk_add_f32 v[230:231], v[230:231], 1.0 op_sel_hi:[1,0]
  v_rcp_f32 v224, v224
  v_rcp_f32 v225, v225
  v_rcp_f32 v226, v226
  buffer_load_dwordx4 a[56:59], v2, s[4:7], s25 offen offset:2048
  v_rcp_f32 v227, v227
  v_rcp_f32 v228, v228
  v_rcp_f32 v229, v229
  v_rcp_f32 v230, v230
  v_rcp_f32 v231, v231
  v_pk_mul_f32 v[128:129], v[128:129], v[224:225]
  v_pk_mul_f32 v[130:131], v[130:131], v[226:227]
  v_pk_mul_f32 v[132:133], v[132:133], v[228:229]
  v_pk_mul_f32 v[134:135], v[134:135], v[230:231]
  v_cvt_pk_bf16_f32 v168, v120, v121
  v_cvt_pk_bf16_f32 v169, v122, v123
  v_cvt_pk_bf16_f32 v170, v124, v125
  v_cvt_pk_bf16_f32 v171, v126, v127
  v_cvt_pk_bf16_f32 v172, v128, v129
  v_cvt_pk_bf16_f32 v173, v130, v131
  v_cvt_pk_bf16_f32 v174, v132, v133
  v_cvt_pk_bf16_f32 v175, v134, v135
  v_permlane16_swap_b32 v168, v170
  v_permlane16_swap_b32 v169, v171
  v_permlane16_swap_b32 v172, v174
  v_permlane16_swap_b32 v173, v175
  s_lshl_b32 s28, s22, 11
  s_add_u32 s28, s28, 8192
  s_add_u32 s29, s28, 65536
  v_add_u32 v250, s29, v12
  v_add_u32 v251, s29, v13
  ds_write_b128 v250, v[168:171]
  ds_write_b128 v251, v[172:175]
  s_add_u32 s27, s24, 1572864
  s_add_u32 s57, s27, s38
  s_add_u32 s57, s57, s28
  s_cmp_eq_u32 s23, 0
  s_cbranch_scc1 XS_150
  buffer_store_dwordx4 v[168:171], v12, s[4:7], s57 offen
XD_151:
  ds_read_b128 v[188:191], v4 offset:0
  ds_read_b128 v[192:195], v5 offset:0
  ds_read_b128 v[196:199], v6 offset:0
  ds_read_b128 v[200:203], v7 offset:0
  ds_read_b128 v[176:179], v237 offset:0
  ds_read_b128 v[204:207], v4 offset:4096
  ds_read_b128 v[208:211], v5 offset:4096
  ds_read_b128 v[212:215], v6 offset:4096
  ds_read_b128 v[216:219], v7 offset:4096
  ds_read_b128 v[180:183], v237 offset:4096
  s_waitcnt lgkmcnt(5)
  v_mfma_f32_16x16x32_bf16 v[136:139], a[96:99], v[188:191], 0
  ds_read_b128 v[220:223], v4 offset:8192
  buffer_load_dwordx4 a[60:63], v2, s[4:7], s25 offen offset:3072
  v_mfma_f32_16x16x32_bf16 v[140:143], a[96:99], v[192:195], 0
  ds_read_b128 v[224:227], v5 offset:8192
  v_mfma_f32_16x16x32_bf16 v[144:147], a[96:99], v[196:199], 0
  ds_read_b128 v[228:231], v6 offset:8192
  v_mfma_f32_16x16x32_bf16 v[148:151], a[96:99], v[200:203], 0
  ds_read_b128 v[232:235], v7 offset:8192
  v_mfma_f32_16x16x32_bf16 v[152:155], a[100:103], v[176:179], 0
  ds_read_b128 v[184:187], v237 offset:8192
  s_add_u32 s25, s25, 4096
  buffer_load_dwordx4 a[64:67], v2, s[4:7], s25 offen offset:0
  v_mfma_f32_16x16x32_bf16 v[156:159], a[100:103], v[192:195], 0
  s_waitcnt lgkmcnt(5)
  v_mfma_f32_16x16x32_bf16 v[136:139], a[104:107], v[204:207], v[136:139]
  ds_read_b128 v[188:191], v4 offset:12288
  v_mfma_f32_16x16x32_bf16 v[140:143], a[104:107], v[208:211], v[140:143]
  ds_read_b128 v[192:195], v5 offset:12288
  v_mfma_f32_16x16x32_bf16 v[144:147], a[104:107], v[212:215], v[144:147]
  ds_read_b128 v[196:199], v6 offset:12288
  buffer_load_dwordx4 a[68:71], v2, s[4:7], s25 offen offset:1024
  v_mfma_f32_16x16x32_bf16 v[148:151], a[104:107], v[216:219], v[148:151]
  ds_read_b128 v[200:203], v7 offset:12288
  v_mfma_f32_16x16x32_bf16 v[152:155], a[108:111], v[180:183], v[152:155]
  ds_read_b128 v[176:179], v237 offset:12288
  v_mfma_f32_16x16x32_bf16 v[156:159], a[108:111], v[208:211], v[156:159]
  s_cmp_eq_u32 s23, 0
  s_cbranch_scc1 XS_152
  buffer_store_dwordx4 v[172:175], v13, s[4:7], s57 offen
XD_153:
  s_add_u32 s74, s33, 5120
  v_lshlrev_b32 v251, 7, v1
  s_mov_b64 exec, 15
  buffer_load_dword v250, v251, s[4:7], s74 offen
  s_mov_b64 exec, -1
  s_waitcnt vmcnt(53) lgkmcnt(5)
  v_mfma_f32_16x16x32_bf16 v[136:139], a[112:115], v[220:223], v[136:139]
  ds_read_b128 v[204:207], v4 offset:16384
  v_mfma_f32_16x16x32_bf16 v[140:143], a[112:115], v[224:227], v[140:143]
  ds_read_b128 v[208:211], v5 offset:16384
  v_mfma_f32_16x16x32_bf16 v[144:147], a[112:115], v[228:231], v[144:147]
  ds_read_b128 v[212:215], v6 offset:16384
  v_mfma_f32_16x16x32_bf16 v[148:151], a[112:115], v[232:235], v[148:151]
  ds_read_b128 v[216:219], v7 offset:16384
  buffer_load_dwordx4 a[72:75], v2, s[4:7], s25 offen offset:2048
  v_mfma_f32_16x16x32_bf16 v[152:155], a[116:119], v[184:187], v[152:155]
  ds_read_b128 v[180:183], v237 offset:16384
  v_mfma_f32_16x16x32_bf16 v[156:159], a[116:119], v[224:227], v[156:159]
  s_add_u32 s27, s24, 1572864
  s_add_u32 s27, s27, s38
  s_lshl_b32 s26, s22, 11
  s_add_u32 s27, s27, s26
  s_add_u32 s27, s27, 16384
  buffer_load_dwordx4 v[48:51], v2, s[4:7], s27 offen
  s_waitcnt lgkmcnt(5)
  v_mfma_f32_16x16x32_bf16 v[136:139], a[120:123], v[188:191], v[136:139]
  ds_read_b128 v[220:223], v4 offset:20480
  v_mfma_f32_16x16x32_bf16 v[140:143], a[120:123], v[192:195], v[140:143]
  ds_read_b128 v[224:227], v5 offset:20480
  v_mfma_f32_16x16x32_bf16 v[144:147], a[120:123], v[196:199], v[144:147]
  ds_read_b128 v[228:231], v6 offset:20480
  v_mfma_f32_16x16x32_bf16 v[148:151], a[120:123], v[200:203], v[148:151]
  ds_read_b128 v[232:235], v7 offset:20480
  buffer_load_dwordx4 a[76:79], v2, s[4:7], s25 offen offset:3072
  v_mfma_f32_16x16x32_bf16 v[152:155], a[124:127], v[176:179], v[152:155]
  ds_read_b128 v[184:187], v237 offset:20480
  v_mfma_f32_16x16x32_bf16 v[156:159], a[124:127], v[192:195], v[156:159]
  s_waitcnt lgkmcnt(5)
  v_mfma_f32_16x16x32_bf16 v[136:139], a[128:131], v[204:207], v[136:139]
  ds_read_b128 v[188:191], v4 offset:24576
  v_mfma_f32_16x16x32_bf16 v[140:143], a[128:131], v[208:211], v[140:143]
  ds_read_b128 v[192:195], v5 offset:24576
  s_add_u32 s25, s25, 4096
  buffer_load_dwordx4 a[80:83], v2, s[4:7], s25 offen offset:0
  v_mfma_f32_16x16x32_bf16 v[144:147], a[128:131], v[212:215], v[144:147]
  ds_read_b128 v[196:199], v6 offset:24576
  v_mfma_f32_16x16x32_bf16 v[148:151], a[128:131], v[216:219], v[148:151]
  ds_read_b128 v[200:203], v7 offset:24576
  v_mfma_f32_16x16x32_bf16 v[152:155], a[132:135], v[180:183], v[152:155]
  ds_read_b128 v[176:179], v237 offset:24576
  v_mfma_f32_16x16x32_bf16 v[156:159], a[132:135], v[208:211], v[156:159]
  buffer_load_dwordx4 a[84:87], v2, s[4:7], s25 offen offset:1024
  s_waitcnt lgkmcnt(5)
  v_mfma_f32_16x16x32_bf16 v[136:139], a[136:139], v[220:223], v[136:139]
  ds_read_b128 v[204:207], v4 offset:28672
  v_mfma_f32_16x16x32_bf16 v[140:143], a[136:139], v[224:227], v[140:143]
  ds_read_b128 v[208:211], v5 offset:28672
  v_mfma_f32_16x16x32_bf16 v[144:147], a[136:139], v[228:231], v[144:147]
  ds_read_b128 v[212:215], v6 offset:28672
  v_mfma_f32_16x16x32_bf16 v[148:151], a[136:139], v[232:235], v[148:151]
  ds_read_b128 v[216:219], v7 offset:28672
  buffer_load_dwordx4 a[88:91], v2, s[4:7], s25 offen offset:2048
  v_mfma_f32_16x16x32_bf16 v[152:155], a[140:143], v[184:187], v[152:155]
  ds_read_b128 v[180:183], v237 offset:28672
  v_mfma_f32_16x16x32_bf16 v[156:159], a[140:143], v[224:227], v[156:159]
  s_waitcnt vmcnt(50) lgkmcnt(5)
  v_mfma_f32_16x16x32_bf16 v[136:139], a[144:147], v[188:191], v[136:139]
  ds_read_b128 v[220:223], v4 offset:32768
  v_mfma_f32_16x16x32_bf16 v[140:143], a[144:147], v[192:195], v[140:143]
  ds_read_b128 v[224:227], v5 offset:32768
  buffer_load_dwordx4 a[92:95], v2, s[4:7], s25 offen offset:3072
  v_mfma_f32_16x16x32_bf16 v[144:147], a[144:147], v[196:199], v[144:147]
  ds_read_b128 v[228:231], v6 offset:32768
  v_mfma_f32_16x16x32_bf16 v[148:151], a[144:147], v[200:203], v[148:151]
  ds_read_b128 v[232:235], v7 offset:32768
  v_mfma_f32_16x16x32_bf16 v[152:155], a[148:151], v[176:179], v[152:155]
  ds_read_b128 v[184:187], v237 offset:32768
  v_mfma_f32_16x16x32_bf16 v[156:159], a[148:151], v[192:195], v[156:159]
  s_add_u32 s25, s25, 4096
  buffer_load_dwordx4 a[96:99], v2, s[4:7], s25 offen offset:0
  s_add_u32 s27, s24, 1572864
  s_add_u32 s27, s27, s38
  s_lshl_b32 s26, s22, 11
  s_add_u32 s27, s27, s26
  s_add_u32 s27, s27, 17408
  buffer_load_dwordx4 v[48:51], v2, s[4:7], s27 offen
  s_waitcnt lgkmcnt(5)
  v_mfma_f32_16x16x32_bf16 v[136:139], a[152:155], v[204:207], v[136:139]
  ds_read_b128 v[188:191], v4 offset:36864
  v_mfma_f32_16x16x32_bf16 v[140:143], a[152:155], v[208:211], v[140:143]
  ds_read_b128 v[192:195], v5 offset:36864
  v_mfma_f32_16x16x32_bf16 v[144:147], a[152:155], v[212:215], v[144:147]
  ds_read_b128 v[196:199], v6 offset:36864
  v_mfma_f32_16x16x32_bf16 v[148:151], a[152:155], v[216:219], v[148:151]
  ds_read_b128 v[200:203], v7 offset:36864
  buffer_load_dwordx4 a[100:103], v2, s[4:7], s25 offen offset:1024
  v_mfma_f32_16x16x32_bf16 v[152:155], a[156:159], v[180:183], v[152:155]
  ds_read_b128 v[176:179], v237 offset:36864
  v_mfma_f32_16x16x32_bf16 v[156:159], a[156:159], v[208:211], v[156:159]
  s_waitcnt lgkmcnt(5)
  v_mfma_f32_16x16x32_bf16 v[136:139], a[160:163], v[220:223], v[136:139]
  ds_read_b128 v[204:207], v4 offset:40960
  v_mfma_f32_16x16x32_bf16 v[140:143], a[160:163], v[224:227], v[140:143]
  ds_read_b128 v[208:211], v5 offset:40960
  buffer_load_dwordx4 a[104:107], v2, s[4:7], s25 offen offset:2048
  v_mfma_f32_16x16x32_bf16 v[144:147], a[160:163], v[228:231], v[144:147]
  ds_read_b128 v[212:215], v6 offset:40960
  v_mfma_f32_16x16x32_bf16 v[148:151], a[160:163], v[232:235], v[148:151]
  ds_read_b128 v[216:219], v7 offset:40960
  v_mfma_f32_16x16x32_bf16 v[152:155], a[164:167], v[184:187], v[152:155]
  ds_read_b128 v[180:183], v237 offset:40960
  v_mfma_f32_16x16x32_bf16 v[156:159], a[164:167], v[224:227], v[156:159]
  buffer_load_dwordx4 a[108:111], v2, s[4:7], s25 offen offset:3072
  s_waitcnt lgkmcnt(5)
  v_mfma_f32_16x16x32_bf16 v[136:139], a[168:171], v[188:191], v[136:139]
  ds_read_b128 v[220:223], v4 offset:45056
  v_mfma_f32_16x16x32_bf16 v[140:143], a[168:171], v[192:195], v[140:143]
  ds_read_b128 v[224:227], v5 offset:45056
  v_mfma_f32_16x16x32_bf16 v[144:147], a[168:171], v[196:199], v[144:147]
  ds_read_b128 v[228:231], v6 offset:45056
  v_mfma_f32_16x16x32_bf16 v[148:151], a[168:171], v[200:203], v[148:151]
  ds_read_b128 v[232:235], v7 offset:45056
  s_add_u32 s25, s25, 4096
  buffer_load_dwordx4 a[112:115], v2, s[4:7], s25 offen offset:0
  v_mfma_f32_16x16x32_bf16 v[152:155], a[172:175], v[176:179], v[152:155]
  ds_read_b128 v[184:187], v237 offset:45056
  v_mfma_f32_16x16x32_bf16 v[156:159], a[172:175], v[192:195], v[156:159]
  s_waitcnt vmcnt(48) lgkmcnt(5)
  v_mfma_f32_16x16x32_bf16 v[136:139], a[176:179], v[204:207], v[136:139]
  ds_read_b128 v[188:191], v4 offset:49152
  v_mfma_f32_16x16x32_bf16 v[140:143], a[176:179], v[208:211], v[140:143]
  ds_read_b128 v[192:195], v5 offset:49152
  buffer_load_dwordx4 a[116:119], v2, s[4:7], s25 offen offset:1024
  v_mfma_f32_16x16x32_bf16 v[144:147], a[176:179], v[212:215], v[144:147]
  ds_read_b128 v[196:199], v6 offset:49152
  v_mfma_f32_16x16x32_bf16 v[148:151], a[176:179], v[216:219], v[148:151]
  ds_read_b128 v[200:203], v7 offset:49152
  v_mfma_f32_16x16x32_bf16 v[152:155], a[180:183], v[180:183], v[152:155]
  ds_read_b128 v[176:179], v237 offset:49152
  v_mfma_f32_16x16x32_bf16 v[156:159], a[180:183], v[208:211], v[156:159]
  buffer_load_dwordx4 a[120:123], v2, s[4:7], s25 offen offset:2048
  s_add_u32 s27, s24, 1572864
  s_add_u32 s27, s27, s38
  s_lshl_b32 s26, s22, 10
  s_add_u32 s27, s27, s26
  s_add_u32 s27, s27, 24576
  buffer_load_dwordx4 v[48:51], v2, s[4:7], s27 offen
  s_waitcnt lgkmcnt(5)
  v_mfma_f32_16x16x32_bf16 v[136:139], a[184:187], v[220:223], v[136:139]
  ds_read_b128 v[204:207], v4 offset:53248
  v_mfma_f32_16x16x32_bf16 v[140:143], a[184:187], v[224:227], v[140:143]
  ds_read_b128 v[208:211], v5 offset:53248
  v_mfma_f32_16x16x32_bf16 v[144:147], a[184:187], v[228:231], v[144:147]
  ds_read_b128 v[212:215], v6 offset:53248
  v_mfma_f32_16x16x32_bf16 v[148:151], a[184:187], v[232:235], v[148:151]
  ds_read_b128 v[216:219], v7 offset:53248
  buffer_load_dwordx4 a[124:127], v2, s[4:7], s25 offen offset:3072
  v_mfma_f32_16x16x32_bf16 v[152:155], a[188:191], v[184:187], v[152:155]
  ds_read_b128 v[180:183], v237 offset:53248
  v_mfma_f32_16x16x32_bf16 v[156:159], a[188:191], v[224:227], v[156:159]
  s_waitcnt lgkmcnt(5)
  v_mfma_f32_16x16x32_bf16 v[136:139], a[192:195], v[188:191], v[136:139]
  ds_read_b128 v[220:223], v4 offset:57344
  v_mfma_f32_16x16x32_bf16 v[140:143], a[192:195], v[192:195], v[140:143]
  ds_read_b128 v[224:227], v5 offset:57344
  s_add_u32 s25, s25, 4096
  buffer_load_dwordx4 a[128:131], v2, s[4:7], s25 offen offset:0
  v_mfma_f32_16x16x32_bf16 v[144:147], a[192:195], v[196:199], v[144:147]
  ds_read_b128 v[228:231], v6 offset:57344
  v_mfma_f32_16x16x32_bf16 v[148:151], a[192:195], v[200:203], v[148:151]
  ds_read_b128 v[232:235], v7 offset:57344
  v_mfma_f32_16x16x32_bf16 v[152:155], a[196:199], v[176:179], v[152:155]
  ds_read_b128 v[184:187], v237 offset:57344
  v_mfma_f32_16x16x32_bf16 v[156:159], a[196:199], v[192:195], v[156:159]
  buffer_load_dwordx4 a[132:135], v2, s[4:7], s25 offen offset:1024
  s_waitcnt lgkmcnt(5)
  v_mfma_f32_16x16x32_bf16 v[136:139], a[200:203], v[204:207], v[136:139]
  ds_read_b128 v[188:191], v4 offset:61440
  v_mfma_f32_16x16x32_bf16 v[140:143], a[200:203], v[208:211], v[140:143]
  ds_read_b128 v[192:195], v5 offset:61440
  v_mfma_f32_16x16x32_bf16 v[144:147], a[200:203], v[212:215], v[144:147]
  ds_read_b128 v[196:199], v6 offset:61440
  v_mfma_f32_16x16x32_bf16 v[148:151], a[200:203], v[216:219], v[148:151]
  ds_read_b128 v[200:203], v7 offset:61440
  buffer_load_dwordx4 a[136:139], v2, s[4:7], s25 offen offset:2048
  v_mfma_f32_16x16x32_bf16 v[152:155], a[204:207], v[180:183], v[152:155]
  ds_read_b128 v[176:179], v237 offset:61440
  v_mfma_f32_16x16x32_bf16 v[156:159], a[204:207], v[208:211], v[156:159]
  s_waitcnt vmcnt(46) lgkmcnt(5)
  v_mfma_f32_16x16x32_bf16 v[136:139], a[208:211], v[220:223], v[136:139]
  v_mfma_f32_16x16x32_bf16 v[140:143], a[208:211], v[224:227], v[140:143]
  buffer_load_dwordx4 a[140:143], v2, s[4:7], s25 offen offset:3072
  v_mfma_f32_16x16x32_bf16 v[144:147], a[208:211], v[228:231], v[144:147]
  v_mfma_f32_16x16x32_bf16 v[148:151], a[208:211], v[232:235], v[148:151]
  v_mfma_f32_16x16x32_bf16 v[152:155], a[212:215], v[184:187], v[152:155]
  v_mfma_f32_16x16x32_bf16 v[156:159], a[212:215], v[224:227], v[156:159]
  s_add_u32 s25, s25, 4096
  buffer_load_dwordx4 a[144:147], v2, s[4:7], s25 offen offset:0
  s_waitcnt lgkmcnt(0)
  v_mfma_f32_16x16x32_bf16 v[136:139], a[216:219], v[188:191], v[136:139]
  v_mfma_f32_16x16x32_bf16 v[140:143], a[216:219], v[192:195], v[140:143]
  v_mfma_f32_16x16x32_bf16 v[144:147], a[216:219], v[196:199], v[144:147]
  v_mfma_f32_16x16x32_bf16 v[148:151], a[216:219], v[200:203], v[148:151]
  buffer_load_dwordx4 a[148:151], v2, s[4:7], s25 offen offset:1024
  v_mfma_f32_16x16x32_bf16 v[152:155], a[220:223], v[176:179], v[152:155]
  v_mfma_f32_16x16x32_bf16 v[156:159], a[220:223], v[192:195], v[156:159]
  ds_read_b128 v[200:203], v14
  ds_read_b128 v[204:207], v15
  ds_read_b128 v[208:211], v16
  ds_read_b128 v[212:215], v17
  ds_read_b128 v[188:191], v238
  s_waitcnt lgkmcnt(0)
  v_pk_mul_f32 v[224:225], v[96:97], v[200:201] op_sel:[0,1] op_sel_hi:[1,1]
  v_pk_mul_f32 v[226:227], v[98:99], v[200:201] op_sel:[0,1] op_sel_hi:[1,1]
  v_pk_mul_f32 v[228:229], v[96:97], v[204:205] op_sel:[0,1] op_sel_hi:[1,1]
  v_pk_mul_f32 v[230:231], v[98:99], v[204:205] op_sel:[0,1] op_sel_hi:[1,1]
  v_pk_fma_f32 v[136:137], v[136:137], v[200:201], v[224:225] op_sel_hi:[1,0,1] neg_lo:[0,0,1] neg_hi:[0,0,1]
  buffer_load_dwordx4 a[152:155], v2, s[4:7], s25 offen offset:2048
  v_pk_fma_f32 v[138:139], v[138:139], v[200:201], v[226:227] op_sel_hi:[1,0,1] neg_lo:[0,0,1] neg_hi:[0,0,1]
  v_pk_fma_f32 v[140:141], v[140:141], v[204:205], v[228:229] op_sel_hi:[1,0,1] neg_lo:[0,0,1] neg_hi:[0,0,1]
  v_pk_fma_f32 v[142:143], v[142:143], v[204:205], v[230:231] op_sel_hi:[1,0,1] neg_lo:[0,0,1] neg_hi:[0,0,1]
  v_pk_mul_f32 v[224:225], v[96:97], v[208:209] op_sel:[0,1] op_sel_hi:[1,1]
  v_pk_mul_f32 v[226:227], v[98:99], v[208:209] op_sel:[0,1] op_sel_hi:[1,1]
  v_pk_mul_f32 v[228:229], v[96:97], v[212:213] op_sel:[0,1] op_sel_hi:[1,1]
  v_pk_mul_f32 v[230:231], v[98:99], v[212:213] op_sel:[0,1] op_sel_hi:[1,1]
  v_pk_fma_f32 v[144:145], v[144:145], v[208:209], v[224:225] op_sel_hi:[1,0,1] neg_lo:[0,0,1] neg_hi:[0,0,1]
  v_pk_fma_f32 v[146:147], v[146:147], v[208:209], v[226:227] op_sel_hi:[1,0,1] neg_lo:[0,0,1] neg_hi:[0,0,1]
  v_pk_fma_f32 v[148:149], v[148:149], v[212:213], v[228:229] op_sel_hi:[1,0,1] neg_lo:[0,0,1] neg_hi:[0,0,1]
  v_pk_fma_f32 v[150:151], v[150:151], v[212:213], v[230:231] op_sel_hi:[1,0,1] neg_lo:[0,0,1] neg_hi:[0,0,1]
  v_pk_mul_f32 v[224:225], v[136:137], v[136:137]
  v_pk_mul_f32 v[226:227], v[138:139], v[138:139]
  v_pk_mul_f32 v[228:229], v[140:141], v[140:141]
  v_pk_mul_f32 v[230:231], v[142:143], v[142:143]
  v_pk_fma_f32 v[224:225], v[224:225], v[28:29], v[28:29] op_sel:[0,1,0] op_sel_hi:[1,1,0]
  v_pk_fma_f32 v[226:227], v[226:227], v[28:29], v[28:29] op_sel:[0,1,0] op_sel_hi:[1,1,0]
  v_pk_fma_f32 v[228:229], v[228:229], v[28:29], v[28:29] op_sel:[0,1,0] op_sel_hi:[1,1,0]
  v_pk_fma_f32 v[230:231], v[230:231], v[28:29], v[28:29] op_sel:[0,1,0] op_sel_hi:[1,1,0]
  v_pk_mul_f32 v[224:225], v[224:225], v[136:137]
  v_pk_mul_f32 v[226:227], v[226:227], v[138:139]
  v_pk_mul_f32 v[228:229], v[228:229], v[140:141]
  v_pk_mul_f32 v[230:231], v[230:231], v[142:143]
  v_exp_f32 v224, v224
  v_exp_f32 v225, v225
  v_exp_f32 v226, v226
  v_exp_f32 v227, v227
  v_exp_f32 v228, v228
  v_exp_f32 v229, v229
  v_exp_f32 v230, v230
  v_exp_f32 v231, v231
  v_pk_add_f32 v[224:225], v[224:225], 1.0 op_sel_hi:[1,0]
  v_pk_add_f32 v[226:227], v[226:227], 1.0 op_sel_hi:[1,0]
  v_pk_add_f32 v[228:229], v[228:229], 1.0 op_sel_hi:[1,0]
  v_pk_add_f32 v[230:231], v[230:231], 1.0 op_sel_hi:[1,0]
  v_rcp_f32 v224, v224
  v_rcp_f32 v225, v225
  v_rcp_f32 v226, v226
  v_rcp_f32 v227, v227
  v_rcp_f32 v228, v228
  v_rcp_f32 v229, v229
  v_rcp_f32 v230, v230
  v_rcp_f32 v231, v231
  v_pk_mul_f32 v[136:137], v[136:137], v[224:225]
  v_pk_mul_f32 v[138:139], v[138:139], v[226:227]
  v_pk_mul_f32 v[140:141], v[140:141], v[228:229]
  v_pk_mul_f32 v[142:143], v[142:143], v[230:231]
  v_pk_mul_f32 v[224:225], v[144:145], v[144:145]
  v_pk_mul_f32 v[226:227], v[146:147], v[146:147]
  v_pk_mul_f32 v[228:229], v[148:149], v[148:149]
  v_pk_mul_f32 v[230:231], v[150:151], v[150:151]
  v_pk_fma_f32 v[224:225], v[224:225], v[28:29], v[28:29] op_sel:[0,1,0] op_sel_hi:[1,1,0]
  v_pk_fma_f32 v[226:227], v[226:227], v[28:29], v[28:29] op_sel:[0,1,0] op_sel_hi:[1,1,0]
  v_pk_fma_f32 v[228:229], v[228:229], v[28:29], v[28:29] op_sel:[0,1,0] op_sel_hi:[1,1,0]
  v_pk_fma_f32 v[230:231], v[230:231], v[28:29], v[28:29] op_sel:[0,1,0] op_sel_hi:[1,1,0]
  v_pk_mul_f32 v[224:225], v[224:225], v[144:145]
  v_pk_mul_f32 v[226:227], v[226:227], v[146:147]
  v_pk_mul_f32 v[228:229], v[228:229], v[148:149]
  v_pk_mul_f32 v[230:231], v[230:231], v[150:151]
  v_exp_f32 v224, v224
  v_exp_f32 v225, v225
  v_exp_f32 v226, v226
  v_exp_f32 v227, v227
  v_exp_f32 v228, v228
  v_exp_f32 v229, v229
  v_exp_f32 v230, v230
  v_exp_f32 v231, v231
  v_pk_add_f32 v[224:225], v[224:225], 1.0 op_sel_hi:[1,0]
  v_pk_add_f32 v[226:227], v[226:227], 1.0 op_sel_hi:[1,0]
  v_pk_add_f32 v[228:229], v[228:229], 1.0 op_sel_hi:[1,0]
  v_pk_add_f32 v[230:231], v[230:231], 1.0 op_sel_hi:[1,0]
  v_rcp_f32 v224, v224
  v_rcp_f32 v225, v225
  v_rcp_f32 v226, v226
  v_rcp_f32 v227, v227
  v_rcp_f32 v228, v228
  v_rcp_f32 v229, v229
  v_rcp_f32 v230, v230
  v_rcp_f32 v231, v231
  v_pk_mul_f32 v[144:145], v[144:145], v[224:225]
  v_pk_mul_f32 v[146:147], v[146:147], v[226:227]
  v_pk_mul_f32 v[148:149], v[148:149], v[228:229]
  v_pk_mul_f32 v[150:151], v[150:151], v[230:231]
  v_cvt_pk_bf16_f32 v216, v136, v137
  v_cvt_pk_bf16_f32 v217, v138, v139
  v_cvt_pk_bf16_f32 v218, v140, v141
  v_cvt_pk_bf16_f32 v219, v142, v143
  v_cvt_pk_bf16_f32 v220, v144, v145
  v_cvt_pk_bf16_f32 v221, v146, v147
  v_cvt_pk_bf16_f32 v222, v148, v149
  v_cvt_pk_bf16_f32 v223, v150, v151
  v_permlane16_swap_b32 v216, v218
  v_permlane16_swap_b32 v217, v219
  v_permlane16_swap_b32 v220, v222
  v_permlane16_swap_b32 v221, v223
  s_lshl_b32 s28, s22, 11
  s_add_u32 s28, s28, 16384
  s_add_u32 s29, s28, 65536
  v_add_u32 v250, s29, v12
  v_add_u32 v251, s29, v13
  ds_write_b128 v250, v[216:219]
  ds_write_b128 v251, v[220:223]
  s_add_u32 s27, s24, 1572864
  s_add_u32 s97, s27, s38
  s_add_u32 s97, s97, s28
  s_cmp_eq_u32 s23, 0
  s_cbranch_scc1 XS_154
  buffer_store_dwordx4 v[216:219], v12, s[4:7], s97 offen
XD_155:
  v_pk_mul_f32 v[224:225], v[100:101], v[188:189] op_sel:[0,1] op_sel_hi:[1,1]
  v_pk_mul_f32 v[226:227], v[102:103], v[188:189] op_sel:[0,1] op_sel_hi:[1,1]
  v_pk_fma_f32 v[152:153], v[152:153], v[188:189], v[224:225] op_sel_hi:[1,0,1] neg_lo:[0,0,1] neg_hi:[0,0,1]
  v_pk_fma_f32 v[154:155], v[154:155], v[188:189], v[226:227] op_sel_hi:[1,0,1] neg_lo:[0,0,1] neg_hi:[0,0,1]
  v_pk_mul_f32 v[224:225], v[100:101], v[204:205] op_sel:[0,1] op_sel_hi:[1,1]
  v_pk_mul_f32 v[226:227], v[102:103], v[204:205] op_sel:[0,1] op_sel_hi:[1,1]
  v_pk_fma_f32 v[156:157], v[156:157], v[204:205], v[224:225] op_sel_hi:[1,0,1] neg_lo:[0,0,1] neg_hi:[0,0,1]
  v_pk_fma_f32 v[158:159], v[158:159], v[204:205], v[226:227] op_sel_hi:[1,0,1] neg_lo:[0,0,1] neg_hi:[0,0,1]
  v_pk_mul_f32 v[224:225], v[152:153], v[152:153]
  v_pk_mul_f32 v[226:227], v[154:155], v[154:155]
  v_pk_mul_f32 v[228:229], v[156:157], v[156:157]
  v_pk_mul_f32 v[230:231], v[158:159], v[158:159]
  v_pk_fma_f32 v[224:225], v[224:225], v[28:29], v[28:29] op_sel:[0,1,0] op_sel_hi:[1,1,0]
  v_pk_fma_f32 v[226:227], v[226:227], v[28:29], v[28:29] op_sel:[0,1,0] op_sel_hi:[1,1,0]
  v_pk_fma_f32 v[228:229], v[228:229], v[28:29], v[28:29] op_sel:[0,1,0] op_sel_hi:[1,1,0]
  v_pk_fma_f32 v[230:231], v[230:231], v[28:29], v[28:29] op_sel:[0,1,0] op_sel_hi:[1,1,0]
  v_pk_mul_f32 v[224:225], v[224:225], v[152:153]
  v_pk_mul_f32 v[226:227], v[226:227], v[154:155]
  v_pk_mul_f32 v[228:229], v[228:229], v[156:157]
  v_pk_mul_f32 v[230:231], v[230:231], v[158:159]
  v_exp_f32 v224, v224
  v_exp_f32 v225, v225
  v_exp_f32 v226, v226
  v_exp_f32 v227, v227
  v_exp_f32 v228, v228
  v_exp_f32 v229, v229
  v_exp_f32 v230, v230
  v_exp_f32 v231, v231
  v_pk_add_f32 v[224:225], v[224:225], 1.0 op_sel_hi:[1,0]
  v_pk_add_f32 v[226:227], v[226:227], 1.0 op_sel_hi:[1,0]
  v_pk_add_f32 v[228:229], v[228:229], 1.0 op_sel_hi:[1,0]
  v_pk_add_f32 v[230:231], v[230:231], 1.0 op_sel_hi:[1,0]
  v_rcp_f32 v224, v224
  v_rcp_f32 v225, v225
  v_rcp_f32 v226, v226
  v_rcp_f32 v227, v227
  v_rcp_f32 v228, v228
  v_rcp_f32 v229, v229
  s_cmp_eq_u32 s23, 0
  s_cbranch_scc1 XS_156
  buffer_store_dwordx4 v[220:223], v13, s[4:7], s97 offen
XD_157:
  v_rcp_f32 v230, v230
  v_rcp_f32 v231, v231
  v_pk_mul_f32 v[152:153], v[152:153], v[224:225]
  v_pk_mul_f32 v[154:155], v[154:155], v[226:227]
  v_pk_mul_f32 v[156:157], v[156:157], v[228:229]
  v_pk_mul_f32 v[158:159], v[158:159], v[230:231]
  v_cvt_pk_bf16_f32 v192, v152, v153
  v_cvt_pk_bf16_f32 v193, v154, v155
  v_cvt_pk_bf16_f32 v194, v156, v157
  v_cvt_pk_bf16_f32 v195, v158, v159
  s_nop 0
  v_permlane16_swap_b32 v192, v194
  v_permlane16_swap_b32 v193, v195
  s_lshr_b32 s28, s22, 1
  s_lshl_b32 s28, s28, 11
  s_add_u32 s28, s28, 24576
  s_add_u32 s29, s28, 65536
  v_add_u32 v250, s29, v239
  ds_write_b128 v250, v[192:195]
  s_add_u32 s27, s24, 1572864
  s_add_u32 s26, s27, s38
  s_add_u32 s26, s26, s28
  s_cmp_eq_u32 s23, 0
  s_cbranch_scc1 XS_158
  buffer_store_dwordx4 v[192:195], v239, s[4:7], s26 offen
XD_159:
  s_add_u32 s75, s24, 1572864
  s_add_u32 s39, s75, 229376
  s_add_u32 s75, s75, s38
  s_lshl_b32 s26, s22, 13
  s_add_u32 s75, s75, s26
  s_lshr_b32 s56, s22, 1
  s_lshl_b32 s56, s56, 12
  s_waitcnt lgkmcnt(0)
  s_add_u32 s74, s68, 5120
  v_lshlrev_b32 v251, 7, v1
  buffer_load_dwordx4 a[156:159], v2, s[4:7], s25 offen offset:3072
  s_add_u32 s25, s25, 4096
  buffer_load_dwordx4 a[160:163], v2, s[4:7], s25 offen offset:0
  s_waitcnt vmcnt(2)
  s_mov_b64 exec, 15
  s_cmp_eq_u32 s23, 0
  s_cbranch_scc1 XS_160
  buffer_store_dword v254, v251, s[4:7], s74 offen
XD_161:
  s_mov_b64 exec, -1
  s_barrier
  s_add_u32 s26, s56, 65536
  v_add_u32 v244, s26, v4
  v_add_u32 v245, s26, v5
  v_add_u32 v246, s26, v6
  v_add_u32 v247, s26, v7
  s_load_dwordx16 s[80:95], s[76:77], 5120
  s_waitcnt lgkmcnt(0)
  s_and_b64 s[80:81], s[80:81], s[82:83]
  s_and_b64 s[84:85], s[84:85], s[86:87]
  s_and_b64 s[88:89], s[88:89], s[90:91]
  s_and_b64 s[92:93], s[92:93], s[94:95]
  s_and_b64 s[80:81], s[80:81], s[84:85]
  s_and_b64 s[88:89], s[88:89], s[92:93]
  s_and_b64 s[80:81], s[80:81], s[88:89]
  s_and_b32 s96, s80, s81
  s_load_dwordx16 s[80:95], s[78:79], 5120
  s_waitcnt lgkmcnt(0)
  s_and_b64 s[80:81], s[80:81], s[82:83]
  s_and_b64 s[84:85], s[84:85], s[86:87]
  s_and_b64 s[88:89], s[88:89], s[90:91]
  s_and_b64 s[92:93], s[92:93], s[94:95]
  s_and_b64 s[80:81], s[80:81], s[84:85]
  s_and_b64 s[88:89], s[88:89], s[92:93]
  s_and_b64 s[80:81], s[80:81], s[88:89]
  s_and_b32 s96, s96, s80
  s_and_b32 s96, s96, s81
  s_cmp_eq_u32 s96, 1
  s_cbranch_scc0 SQ_162
SQok_163:
  s_lshl_b32 s26, s22, 13
  s_sub_u32 s72, s75, s26
  s_lshl_b32 s26, s22, 10
  s_add_u32 s72, s72, s26
  s_add_u32 s72, s72, 28672
  s_cmp_ge_u32 s72, s39
  s_cselect_b32 s27, 229376, 0
  s_sub_u32 s72, s72, s27
  s_add_u32 m0, s26, 94208
  s_nop 0
  buffer_load_dwordx4 v2, s[4:7], s72 offen sc1 lds
  s_add_u32 s72, s75, 32768
  s_cmp_ge_u32 s72, s39
  s_cselect_b32 s27, 229376, 0
  s_sub_u32 s72, s72, s27
  s_lshl_b32 s26, s22, 13
  s_add_u32 m0, s26, 98304
  s_nop 0
  buffer_load_dwordx4 v2, s[4:7], s72 offen offset:0 sc1 lds
  buffer_load_dwordx4 v2, s[4:7], s72 offen offset:1024 sc1 lds
  buffer_load_dwordx4 v2, s[4:7], s72 offen offset:2048 sc1 lds
  buffer_load_dwordx4 v2, s[4:7], s72 offen offset:3072 sc1 lds
  s_add_u32 s72, s75, 36864
  s_cmp_ge_u32 s72, s39
  s_cselect_b32 s27, 229376, 0
  s_sub_u32 s72, s72, s27
  s_lshl_b32 s26, s22, 13
  s_add_u32 m0, s26, 102400
  s_nop 0
  buffer_load_dwordx4 v2, s[4:7], s72 offen offset:0 sc1 lds
  buffer_load_dwordx4 v2, s[4:7], s72 offen offset:1024 sc1 lds
  buffer_load_dwordx4 v2, s[4:7], s72 offen offset:2048 sc1 lds
  buffer_load_dwordx4 v2, s[4:7], s72 offen offset:3072 sc1 lds
  ds_read_b128 v[188:191], v244 offset:0
  ds_read_b128 v[192:195], v245 offset:0
  ds_read_b128 v[196:199], v246 offset:0
  ds_read_b128 v[200:203], v247 offset:0
  ds_read_b128 v[204:207], v244 offset:8192
  ds_read_b128 v[208:211], v245 offset:8192
  ds_read_b128 v[212:215], v246 offset:8192
  ds_read_b128 v[216:219], v247 offset:8192
  s_waitcnt lgkmcnt(4)
  v_mfma_f32_16x16x32_bf16 v[32:35], a[224:227], v[188:191], v[32:35]
  ds_read_b128 v[220:223], v244 offset:16384
  v_mfma_f32_16x16x32_bf16 v[36:39], a[224:227], v[192:195], v[36:39]
  ds_read_b128 v[224:227], v245 offset:16384
  v_mfma_f32_16x16x32_bf16 v[40:43], a[224:227], v[196:199], v[40:43]
  ds_read_b128 v[228:231], v246 offset:16384
  v_mfma_f32_16x16x32_bf16 v[44:47], a[224:227], v[200:203], v[44:47]
  ds_read_b128 v[232:235], v247 offset:16384
  s_add_u32 s72, s75, 65536
  s_cmp_ge_u32 s72, s39
  s_cselect_b32 s27, 229376, 0
  s_sub_u32 s72, s72, s27
  s_lshl_b32 s26, s22, 13
  s_add_u32 m0, s26, 0
  s_nop 0
  buffer_load_dwordx4 v2, s[4:7], s72 offen offset:0 sc1 lds
  v_mfma_f32_16x16x32_bf16 v[104:107], a[228:231], v[188:191], 0
  v_mfma_f32_16x16x32_bf16 v[108:111], a[228:231], v[192:195], 0
  v_mfma_f32_16x16x32_bf16 v[112:115], a[228:231], v[196:199], 0
  v_mfma_f32_16x16x32_bf16 v[116:119], a[228:231], v[200:203], 0
  buffer_load_dwordx4 v2, s[4:7], s72 offen offset:1024 sc1 lds
  s_waitcnt vmcnt(10)
  s_barrier
  s_waitcnt lgkmcnt(4)
  v_mfma_f32_16x16x32_bf16 v[32:35], a[232:235], v[204:207], v[32:35]
  ds_read_b128 v[188:191], v244 offset:24576
  v_mfma_f32_16x16x32_bf16 v[36:39], a[232:235], v[208:211], v[36:39]
  ds_read_b128 v[192:195], v245 offset:24576
  v_mfma_f32_16x16x32_bf16 v[40:43], a[232:235], v[212:215], v[40:43]
  ds_read_b128 v[196:199], v246 offset:24576
  v_mfma_f32_16x16x32_bf16 v[44:47], a[232:235], v[216:219], v[44:47]
  ds_read_b128 v[200:203], v247 offset:24576
  buffer_load_dwordx4 v2, s[4:7], s72 offen offset:2048 sc1 lds
  v_mfma_f32_16x16x32_bf16 v[104:107], a[236:239], v[204:207], v[104:107]
  v_mfma_f32_16x16x32_bf16 v[108:111], a[236:239], v[208:211], v[108:111]
  v_mfma_f32_16x16x32_bf16 v[112:115], a[236:239], v[212:215], v[112:115]
  v_mfma_f32_16x16x32_bf16 v[116:119], a[236:239], v[216:219], v[116:119]
  buffer_load_dwordx4 v2, s[4:7], s72 offen offset:3072 sc1 lds
  s_waitcnt vmcnt(4)
  s_barrier
  s_add_u32 s26, s56, 98304
  v_add_u32 v248, s26, v4
  v_add_u32 v249, s26, v5
  v_add_u32 v252, s26, v6
  v_add_u32 v255, s26, v7
  s_waitcnt lgkmcnt(4)
  v_mfma_f32_16x16x32_bf16 v[32:35], a[240:243], v[220:223], v[32:35]
  ds_read_b128 v[204:207], v248 offset:0
  v_mfma_f32_16x16x32_bf16 v[36:39], a[240:243], v[224:227], v[36:39]
  ds_read_b128 v[208:211], v249 offset:0
  v_mfma_f32_16x16x32_bf16 v[40:43], a[240:243], v[228:231], v[40:43]
  ds_read_b128 v[212:215], v252 offset:0
  v_mfma_f32_16x16x32_bf16 v[44:47], a[240:243], v[232:235], v[44:47]
  ds_read_b128 v[216:219], v255 offset:0
  s_add_u32 s72, s75, 69632
  s_cmp_ge_u32 s72, s39
  s_cselect_b32 s27, 229376, 0
  s_sub_u32 s72, s72, s27
  s_lshl_b32 s26, s22, 13
  s_add_u32 m0, s26, 4096
  s_nop 0
  buffer_load_dwordx4 v2, s[4:7], s72 offen offset:0 sc1 lds
  v_mfma_f32_16x16x32_bf16 v[104:107], a[244:247], v[220:223], v[104:107]
  v_mfma_f32_16x16x32_bf16 v[108:111], a[244:247], v[224:227], v[108:111]
  v_mfma_f32_16x16x32_bf16 v[112:115], a[244:247], v[228:231], v[112:115]
  v_mfma_f32_16x16x32_bf16 v[116:119], a[244:247], v[232:235], v[116:119]
  buffer_load_dwordx4 v2, s[4:7], s72 offen offset:1024 sc1 lds
  s_waitcnt lgkmcnt(4)
  v_mfma_f32_16x16x32_bf16 v[32:35], a[248:251], v[188:191], v[32:35]
  ds_read_b128 v[220:223], v248 offset:8192
  v_mfma_f32_16x16x32_bf16 v[36:39], a[248:251], v[192:195], v[36:39]
  ds_read_b128 v[224:227], v249 offset:8192
  v_mfma_f32_16x16x32_bf16 v[40:43], a[248:251], v[196:199], v[40:43]
  ds_read_b128 v[228:231], v252 offset:8192
  v_mfma_f32_16x16x32_bf16 v[44:47], a[248:251], v[200:203], v[44:47]
  ds_read_b128 v[232:235], v255 offset:8192
  buffer_load_dwordx4 v2, s[4:7], s72 offen offset:2048 sc1 lds
  v_mfma_f32_16x16x32_bf16 v[104:107], a[252:255], v[188:191], v[104:107]
  v_mfma_f32_16x16x32_bf16 v[108:111], a[252:255], v[192:195], v[108:111]
  v_mfma_f32_16x16x32_bf16 v[112:115], a[252:255], v[196:199], v[112:115]
  v_mfma_f32_16x16x32_bf16 v[116:119], a[252:255], v[200:203], v[116:119]
  buffer_load_dwordx4 v2, s[4:7], s72 offen offset:3072 sc1 lds
  s_waitcnt lgkmcnt(4)
  v_mfma_f32_16x16x32_bf16 v[32:35], a[0:3], v[204:207], v[32:35]
  ds_read_b128 v[188:191], v248 offset:16384
  v_mfma_f32_16x16x32_bf16 v[36:39], a[0:3], v[208:211], v[36:39]
  ds_read_b128 v[192:195], v249 offset:16384
  v_mfma_f32_16x16x32_bf16 v[40:43], a[0:3], v[212:215], v[40:43]
  ds_read_b128 v[196:199], v252 offset:16384
  v_mfma_f32_16x16x32_bf16 v[44:47], a[0:3], v[216:219], v[44:47]
  ds_read_b128 v[200:203], v255 offset:16384
  s_add_u32 s72, s75, 98304
  s_cmp_ge_u32 s72, s39
  s_cselect_b32 s27, 229376, 0
  s_sub_u32 s72, s72, s27
  s_lshl_b32 s26, s22, 13
  s_add_u32 m0, s26, 32768
  s_nop 0
  buffer_load_dwordx4 v2, s[4:7], s72 offen offset:0 sc1 lds
  v_mfma_f32_16x16x32_bf16 v[104:107], a[4:7], v[204:207], v[104:107]
  v_mfma_f32_16x16x32_bf16 v[108:111], a[4:7], v[208:211], v[108:111]
  v_mfma_f32_16x16x32_bf16 v[112:115], a[4:7], v[212:215], v[112:115]
  v_mfma_f32_16x16x32_bf16 v[116:119], a[4:7], v[216:219], v[116:119]
  buffer_load_dwordx4 v2, s[4:7], s72 offen offset:1024 sc1 lds
  s_waitcnt lgkmcnt(4)
  v_mfma_f32_16x16x32_bf16 v[32:35], a[8:11], v[220:223], v[32:35]
  ds_read_b128 v[204:207], v248 offset:24576
  v_mfma_f32_16x16x32_bf16 v[36:39], a[8:11], v[224:227], v[36:39]
  ds_read_b128 v[208:211], v249 offset:24576
  v_mfma_f32_16x16x32_bf16 v[40:43], a[8:11], v[228:231], v[40:43]
  ds_read_b128 v[212:215], v252 offset:24576
  v_mfma_f32_16x16x32_bf16 v[44:47], a[8:11], v[232:235], v[44:47]
  ds_read_b128 v[216:219], v255 offset:24576
  buffer_load_dwordx4 v2, s[4:7], s72 offen offset:2048 sc1 lds
  v_mfma_f32_16x16x32_bf16 v[104:107], a[12:15], v[220:223], v[104:107]
  v_mfma_f32_16x16x32_bf16 v[108:111], a[12:15], v[224:227], v[108:111]
  v_mfma_f32_16x16x32_bf16 v[112:115], a[12:15], v[228:231], v[112:115]
  v_mfma_f32_16x16x32_bf16 v[116:119], a[12:15], v[232:235], v[116:119]
  buffer_load_dwordx4 v2, s[4:7], s72 offen offset:3072 sc1 lds
  s_waitcnt vmcnt(4)
  s_barrier
  s_add_u32 s26, s56, 0
  v_add_u32 v244, s26, v4
  v_add_u32 v245, s26, v5
  v_add_u32 v246, s26, v6
  v_add_u32 v247, s26, v7
  s_waitcnt lgkmcnt(4)
  v_mfma_f32_16x16x32_bf16 v[32:35], a[16:19], v[188:191], v[32:35]
  ds_read_b128 v[220:223], v244 offset:0
  v_mfma_f32_16x16x32_bf16 v[36:39], a[16:19], v[192:195], v[36:39]
  ds_read_b128 v[224:227], v245 offset:0
  v_mfma_f32_16x16x32_bf16 v[40:43], a[16:19], v[196:199], v[40:43]
  ds_read_b128 v[228:231], v246 offset:0
  v_mfma_f32_16x16x32_bf16 v[44:47], a[16:19], v[200:203], v[44:47]
  ds_read_b128 v[232:235], v247 offset:0
  s_add_u32 s72, s75, 102400
  s_cmp_ge_u32 s72, s39
  s_cselect_b32 s27, 229376, 0
  s_sub_u32 s72, s72, s27
  s_lshl_b32 s26, s22, 13
  s_add_u32 m0, s26, 36864
  s_nop 0
  buffer_load_dwordx4 v2, s[4:7], s72 offen offset:0 sc1 lds
  v_mfma_f32_16x16x32_bf16 v[104:107], a[20:23], v[188:191], v[104:107]
  v_mfma_f32_16x16x32_bf16 v[108:111], a[20:23], v[192:195], v[108:111]
  v_mfma_f32_16x16x32_bf16 v[112:115], a[20:23], v[196:199], v[112:115]
  v_mfma_f32_16x16x32_bf16 v[116:119], a[20:23], v[200:203], v[116:119]
  buffer_load_dwordx4 v2, s[4:7], s72 offen offset:1024 sc1 lds
  s_waitcnt lgkmcnt(4)
  v_mfma_f32_16x16x32_bf16 v[32:35], a[24:27], v[204:207], v[32:35]
  ds_read_b128 v[188:191], v244 offset:8192
  v_mfma_f32_16x16x32_bf16 v[36:39], a[24:27], v[208:211], v[36:39]
  ds_read_b128 v[192:195], v245 offset:8192
  v_mfma_f32_16x16x32_bf16 v[40:43], a[24:27], v[212:215], v[40:43]
  ds_read_b128 v[196:199], v246 offset:8192
  v_mfma_f32_16x16x32_bf16 v[44:47], a[24:27], v[216:219], v[44:47]
  ds_read_b128 v[200:203], v247 offset:8192
  buffer_load_dwordx4 v2, s[4:7], s72 offen offset:2048 sc1 lds
  v_mfma_f32_16x16x32_bf16 v[104:107], a[28:31], v[204:207], v[104:107]
  v_mfma_f32_16x16x32_bf16 v[108:111], a[28:31], v[208:211], v[108:111]
  v_mfma_f32_16x16x32_bf16 v[112:115], a[28:31], v[212:215], v[112:115]
  v_mfma_f32_16x16x32_bf16 v[116:119], a[28:31], v[216:219], v[116:119]
  buffer_load_dwordx4 v2, s[4:7], s72 offen offset:3072 sc1 lds
  s_waitcnt lgkmcnt(4)
  v_mfma_f32_16x16x32_bf16 v[32:35], a[32:35], v[220:223], v[32:35]
  ds_read_b128 v[204:207], v244 offset:16384
  v_mfma_f32_16x16x32_bf16 v[36:39], a[32:35], v[224:227], v[36:39]
  ds_read_b128 v[208:211], v245 offset:16384
  v_mfma_f32_16x16x32_bf16 v[40:43], a[32:35], v[228:231], v[40:43]
  ds_read_b128 v[212:215], v246 offset:16384
  v_mfma_f32_16x16x32_bf16 v[44:47], a[32:35], v[232:235], v[44:47]
  ds_read_b128 v[216:219], v247 offset:16384
  s_add_u32 s72, s75, 131072
  s_cmp_ge_u32 s72, s39
  s_cselect_b32 s27, 229376, 0
  s_sub_u32 s72, s72, s27
  s_lshl_b32 s26, s22, 13
  s_add_u32 m0, s26, 65536
  s_nop 0
  buffer_load_dwordx4 v2, s[4:7], s72 offen offset:0 sc1 lds
  v_mfma_f32_16x16x32_bf16 v[104:107], a[36:39], v[220:223], v[104:107]
  v_mfma_f32_16x16x32_bf16 v[108:111], a[36:39], v[224:227], v[108:111]
  v_mfma_f32_16x16x32_bf16 v[112:115], a[36:39], v[228:231], v[112:115]
  v_mfma_f32_16x16x32_bf16 v[116:119], a[36:39], v[232:235], v[116:119]
  buffer_load_dwordx4 v2, s[4:7], s72 offen offset:1024 sc1 lds
  s_waitcnt lgkmcnt(4)
  v_mfma_f32_16x16x32_bf16 v[32:35], a[40:43], v[188:191], v[32:35]
  ds_read_b128 v[220:223], v244 offset:24576
  v_mfma_f32_16x16x32_bf16 v[36:39], a[40:43], v[192:195], v[36:39]
  ds_read_b128 v[224:227], v245 offset:24576
  v_mfma_f32_16x16x32_bf16 v[40:43], a[40:43], v[196:199], v[40:43]
  ds_read_b128 v[228:231], v246 offset:24576
  v_mfma_f32_16x16x32_bf16 v[44:47], a[40:43], v[200:203], v[44:47]
  ds_read_b128 v[232:235], v247 offset:24576
  buffer_load_dwordx4 v2, s[4:7], s72 offen offset:2048 sc1 lds
  v_mfma_f32_16x16x32_bf16 v[104:107], a[44:47], v[188:191], v[104:107]
  v_mfma_f32_16x16x32_bf16 v[108:111], a[44:47], v[192:195], v[108:111]
  v_mfma_f32_16x16x32_bf16 v[112:115], a[44:47], v[196:199], v[112:115]
  v_mfma_f32_16x16x32_bf16 v[116:119], a[44:47], v[200:203], v[116:119]
  buffer_load_dwordx4 v2, s[4:7], s72 offen offset:3072 sc1 lds
  s_waitcnt vmcnt(4)
  s_barrier
  s_add_u32 s26, s56, 32768
  v_add_u32 v248, s26, v4
  v_add_u32 v249, s26, v5
  v_add_u32 v252, s26, v6
  v_add_u32 v255, s26, v7
  s_waitcnt lgkmcnt(4)
  v_mfma_f32_16x16x32_bf16 v[32:35], a[48:51], v[204:207], v[32:35]
  ds_read_b128 v[188:191], v248 offset:0
  v_mfma_f32_16x16x32_bf16 v[36:39], a[48:51], v[208:211], v[36:39]
  ds_read_b128 v[192:195], v249 offset:0
  v_mfma_f32_16x16x32_bf16 v[40:43], a[48:51], v[212:215], v[40:43]
  ds_read_b128 v[196:199], v252 offset:0
  v_mfma_f32_16x16x32_bf16 v[44:47], a[48:51], v[216:219], v[44:47]
  ds_read_b128 v[200:203], v255 offset:0
  s_add_u32 s72, s75, 135168
  s_cmp_ge_u32 s72, s39
  s_cselect_b32 s27, 229376, 0
  s_sub_u32 s72, s72, s27
  s_lshl_b32 s26, s22, 13
  s_add_u32 m0, s26, 69632
  s_nop 0
  buffer_load_dwordx4 v2, s[4:7], s72 offen offset:0 sc1 lds
  v_mfma_f32_16x16x32_bf16 v[104:107], a[52:55], v[204:207], v[104:107]
  v_mfma_f32_16x16x32_bf16 v[108:111], a[52:55], v[208:211], v[108:111]
  v_mfma_f32_16x16x32_bf16 v[112:115], a[52:55], v[212:215], v[112:115]
  v_mfma_f32_16x16x32_bf16 v[116:119], a[52:55], v[216:219], v[116:119]
  buffer_load_dwordx4 v2, s[4:7], s72 offen offset:1024 sc1 lds
  s_waitcnt lgkmcnt(4)
  v_mfma_f32_16x16x32_bf16 v[32:35], a[56:59], v[220:223], v[32:35]
  ds_read_b128 v[204:207], v248 offset:8192
  v_mfma_f32_16x16x32_bf16 v[36:39], a[56:59], v[224:227], v[36:39]
  ds_read_b128 v[208:211], v249 offset:8192
  v_mfma_f32_16x16x32_bf16 v[40:43], a[56:59], v[228:231], v[40:43]
  ds_read_b128 v[212:215], v252 offset:8192
  v_mfma_f32_16x16x32_bf16 v[44:47], a[56:59], v[232:235], v[44:47]
  ds_read_b128 v[216:219], v255 offset:8192
  buffer_load_dwordx4 v2, s[4:7], s72 offen offset:2048 sc1 lds
  v_mfma_f32_16x16x32_bf16 v[104:107], a[60:63], v[220:223], v[104:107]
  v_mfma_f32_16x16x32_bf16 v[108:111], a[60:63], v[224:227], v[108:111]
  v_mfma_f32_16x16x32_bf16 v[112:115], a[60:63], v[228:231], v[112:115]
  v_mfma_f32_16x16x32_bf16 v[116:119], a[60:63], v[232:235], v[116:119]
  buffer_load_dwordx4 v2, s[4:7], s72 offen offset:3072 sc1 lds
  s_waitcnt lgkmcnt(4)
  v_mfma_f32_16x16x32_bf16 v[32:35], a[64:67], v[188:191], v[32:35]
  ds_read_b128 v[220:223], v248 offset:16384
  v_mfma_f32_16x16x32_bf16 v[36:39], a[64:67], v[192:195], v[36:39]
  ds_read_b128 v[224:227], v249 offset:16384
  v_mfma_f32_16x16x32_bf16 v[40:43], a[64:67], v[196:199], v[40:43]
  ds_read_b128 v[228:231], v252 offset:16384
  v_mfma_f32_16x16x32_bf16 v[44:47], a[64:67], v[200:203], v[44:47]
  ds_read_b128 v[232:235], v255 offset:16384
  s_add_u32 s72, s75, 163840
  s_cmp_ge_u32 s72, s39
  s_cselect_b32 s27, 229376, 0
  s_sub_u32 s72, s72, s27
  s_lshl_b32 s26, s22, 13
  s_add_u32 m0, s26, 98304
  s_nop 0
  buffer_load_dwordx4 v2, s[4:7], s72 offen offset:0 sc1 lds
  v_mfma_f32_16x16x32_bf16 v[104:107], a[68:71], v[188:191], v[104:107]
  v_mfma_f32_16x16x32_bf16 v[108:111], a[68:71], v[192:195], v[108:111]
  v_mfma_f32_16x16x32_bf16 v[112:115], a[68:71], v[196:199], v[112:115]
  v_mfma_f32_16x16x32_bf16 v[116:119], a[68:71], v[200:203], v[116:119]
  buffer_load_dwordx4 v2, s[4:7], s72 offen offset:1024 sc1 lds
  s_waitcnt lgkmcnt(4)
  v_mfma_f32_16x16x32_bf16 v[32:35], a[72:75], v[204:207], v[32:35]
  ds_read_b128 v[188:191], v248 offset:24576
  v_mfma_f32_16x16x32_bf16 v[36:39], a[72:75], v[208:211], v[36:39]
  ds_read_b128 v[192:195], v249 offset:24576
  v_mfma_f32_16x16x32_bf16 v[40:43], a[72:75], v[212:215], v[40:43]
  ds_read_b128 v[196:199], v252 offset:24576
  v_mfma_f32_16x16x32_bf16 v[44:47], a[72:75], v[216:219], v[44:47]
  ds_read_b128 v[200:203], v255 offset:24576
  buffer_load_dwordx4 v2, s[4:7], s72 offen offset:2048 sc1 lds
  v_mfma_f32_16x16x32_bf16 v[104:107], a[76:79], v[204:207], v[104:107]
  v_mfma_f32_16x16x32_bf16 v[108:111], a[76:79], v[208:211], v[108:111]
  v_mfma_f32_16x16x32_bf16 v[112:115], a[76:79], v[212:215], v[112:115]
  v_mfma_f32_16x16x32_bf16 v[116:119], a[76:79], v[216:219], v[116:119]
  buffer_load_dwordx4 v2, s[4:7], s72 offen offset:3072 sc1 lds
  s_waitcnt vmcnt(4)
  s_barrier
  s_add_u32 s26, s56, 65536
  v_add_u32 v244, s26, v4
  v_add_u32 v245, s26, v5
  v_add_u32 v246, s26, v6
  v_add_u32 v247, s26, v7
  s_waitcnt lgkmcnt(4)
  v_mfma_f32_16x16x32_bf16 v[32:35], a[80:83], v[220:223], v[32:35]
  ds_read_b128 v[204:207], v244 offset:0
  v_mfma_f32_16x16x32_bf16 v[36:39], a[80:83], v[224:227], v[36:39]
  ds_read_b128 v[208:211], v245 offset:0
  v_mfma_f32_16x16x32_bf16 v[40:43], a[80:83], v[228:231], v[40:43]
  ds_read_b128 v[212:215], v246 offset:0
  v_mfma_f32_16x16x32_bf16 v[44:47], a[80:83], v[232:235], v[44:47]
  ds_read_b128 v[216:219], v247 offset:0
  s_add_u32 s72, s75, 167936
  s_cmp_ge_u32 s72, s39
  s_cselect_b32 s27, 229376, 0
  s_sub_u32 s72, s72, s27
  s_lshl_b32 s26, s22, 13
  s_add_u32 m0, s26, 102400
  s_nop 0
  buffer_load_dwordx4 v2, s[4:7], s72 offen offset:0 sc1 lds
  v_mfma_f32_16x16x32_bf16 v[104:107], a[84:87], v[220:223], v[104:107]
  v_mfma_f32_16x16x32_bf16 v[108:111], a[84:87], v[224:227], v[108:111]
  v_mfma_f32_16x16x32_bf16 v[112:115], a[84:87], v[228:231], v[112:115]
  v_mfma_f32_16x16x32_bf16 v[116:119], a[84:87], v[232:235], v[116:119]
  buffer_load_dwordx4 v2, s[4:7], s72 offen offset:1024 sc1 lds
  s_waitcnt lgkmcnt(4)
  v_mfma_f32_16x16x32_bf16 v[32:35], a[88:91], v[188:191], v[32:35]
  ds_read_b128 v[220:223], v244 offset:8192
  v_mfma_f32_16x16x32_bf16 v[36:39], a[88:91], v[192:195], v[36:39]
  ds_read_b128 v[224:227], v245 offset:8192
  v_mfma_f32_16x16x32_bf16 v[40:43], a[88:91], v[196:199], v[40:43]
  ds_read_b128 v[228:231], v246 offset:8192
  v_mfma_f32_16x16x32_bf16 v[44:47], a[88:91], v[200:203], v[44:47]
  ds_read_b128 v[232:235], v247 offset:8192
  buffer_load_dwordx4 v2, s[4:7], s72 offen offset:2048 sc1 lds
  v_mfma_f32_16x16x32_bf16 v[104:107], a[92:95], v[188:191], v[104:107]
  v_mfma_f32_16x16x32_bf16 v[108:111], a[92:95], v[192:195], v[108:111]
  v_mfma_f32_16x16x32_bf16 v[112:115], a[92:95], v[196:199], v[112:115]
  v_mfma_f32_16x16x32_bf16 v[116:119], a[92:95], v[200:203], v[116:119]
  buffer_load_dwordx4 v2, s[4:7], s72 offen offset:3072 sc1 lds
  s_waitcnt lgkmcnt(4)
  v_mfma_f32_16x16x32_bf16 v[32:35], a[96:99], v[204:207], v[32:35]
  ds_read_b128 v[188:191], v244 offset:16384
  v_mfma_f32_16x16x32_bf16 v[36:39], a[96:99], v[208:211], v[36:39]
  ds_read_b128 v[192:195], v245 offset:16384
  v_mfma_f32_16x16x32_bf16 v[40:43], a[96:99], v[212:215], v[40:43]
  ds_read_b128 v[196:199], v246 offset:16384
  v_mfma_f32_16x16x32_bf16 v[44:47], a[96:99], v[216:219], v[44:47]
  ds_read_b128 v[200:203], v247 offset:16384
  s_add_u32 s72, s75, 196608
  s_cmp_ge_u32 s72, s39
  s_cselect_b32 s27, 229376, 0
  s_sub_u32 s72, s72, s27
  s_lshl_b32 s26, s22, 13
  s_add_u32 m0, s26, 0
  s_nop 0
  buffer_load_dwordx4 v2, s[4:7], s72 offen offset:0 sc1 lds
  v_mfma_f32_16x16x32_bf16 v[104:107], a[100:103], v[204:207], v[104:107]
  v_mfma_f32_16x16x32_bf16 v[108:111], a[100:103], v[208:211], v[108:111]
  v_mfma_f32_16x16x32_bf16 v[112:115], a[100:103], v[212:215], v[112:115]
  v_mfma_f32_16x16x32_bf16 v[116:119], a[100:103], v[216:219], v[116:119]
  buffer_load_dwordx4 v2, s[4:7], s72 offen offset:1024 sc1 lds
  s_waitcnt lgkmcnt(4)
  v_mfma_f32_16x16x32_bf16 v[32:35], a[104:107], v[220:223], v[32:35]
  ds_read_b128 v[204:207], v244 offset:24576
  v_mfma_f32_16x16x32_bf16 v[36:39], a[104:107], v[224:227], v[36:39]
  ds_read_b128 v[208:211], v245 offset:24576
  v_mfma_f32_16x16x32_bf16 v[40:43], a[104:107], v[228:231], v[40:43]
  ds_read_b128 v[212:215], v246 offset:24576
  v_mfma_f32_16x16x32_bf16 v[44:47], a[104:107], v[232:235], v[44:47]
  ds_read_b128 v[216:219], v247 offset:24576
  buffer_load_dwordx4 v2, s[4:7], s72 offen offset:2048 sc1 lds
  v_mfma_f32_16x16x32_bf16 v[104:107], a[108:111], v[220:223], v[104:107]
  v_mfma_f32_16x16x32_bf16 v[108:111], a[108:111], v[224:227], v[108:111]
  v_mfma_f32_16x16x32_bf16 v[112:115], a[108:111], v[228:231], v[112:115]
  v_mfma_f32_16x16x32_bf16 v[116:119], a[108:111], v[232:235], v[116:119]
  buffer_load_dwordx4 v2, s[4:7], s72 offen offset:3072 sc1 lds
  s_waitcnt vmcnt(4)
  s_barrier
  s_add_u32 s26, s56, 98304
  v_add_u32 v248, s26, v4
  v_add_u32 v249, s26, v5
  v_add_u32 v252, s26, v6
  v_add_u32 v255, s26, v7
  s_waitcnt lgkmcnt(4)
  v_mfma_f32_16x16x32_bf16 v[32:35], a[112:115], v[188:191], v[32:35]
  ds_read_b128 v[220:223], v248 offset:0
  v_mfma_f32_16x16x32_bf16 v[36:39], a[112:115], v[192:195], v[36:39]
  ds_read_b128 v[224:227], v249 offset:0
  v_mfma_f32_16x16x32_bf16 v[40:43], a[112:115], v[196:199], v[40:43]
  ds_read_b128 v[228:231], v252 offset:0
  v_mfma_f32_16x16x32_bf16 v[44:47], a[112:115], v[200:203], v[44:47]
  ds_read_b128 v[232:235], v255 offset:0
  s_add_u32 s72, s75, 200704
  s_cmp_ge_u32 s72, s39
  s_cselect_b32 s27, 229376, 0
  s_sub_u32 s72, s72, s27
  s_lshl_b32 s26, s22, 13
  s_add_u32 m0, s26, 4096
  s_nop 0
  buffer_load_dwordx4 v2, s[4:7], s72 offen offset:0 sc1 lds
  v_mfma_f32_16x16x32_bf16 v[104:107], a[116:119], v[188:191], v[104:107]
  v_mfma_f32_16x16x32_bf16 v[108:111], a[116:119], v[192:195], v[108:111]
  v_mfma_f32_16x16x32_bf16 v[112:115], a[116:119], v[196:199], v[112:115]
  v_mfma_f32_16x16x32_bf16 v[116:119], a[116:119], v[200:203], v[116:119]
  buffer_load_dwordx4 v2, s[4:7], s72 offen offset:1024 sc1 lds
  s_waitcnt lgkmcnt(4)
  v_mfma_f32_16x16x32_bf16 v[32:35], a[120:123], v[204:207], v[32:35]
  ds_read_b128 v[188:191], v248 offset:8192
  v_mfma_f32_16x16x32_bf16 v[36:39], a[120:123], v[208:211], v[36:39]
  ds_read_b128 v[192:195], v249 offset:8192
  v_mfma_f32_16x16x32_bf16 v[40:43], a[120:123], v[212:215], v[40:43]
  ds_read_b128 v[196:199], v252 offset:8192
  v_mfma_f32_16x16x32_bf16 v[44:47], a[120:123], v[216:219], v[44:47]
  ds_read_b128 v[200:203], v255 offset:8192
  buffer_load_dwordx4 v2, s[4:7], s72 offen offset:2048 sc1 lds
  v_mfma_f32_16x16x32_bf16 v[104:107], a[124:127], v[204:207], v[104:107]
  v_mfma_f32_16x16x32_bf16 v[108:111], a[124:127], v[208:211], v[108:111]
  v_mfma_f32_16x16x32_bf16 v[112:115], a[124:127], v[212:215], v[112:115]
  v_mfma_f32_16x16x32_bf16 v[116:119], a[124:127], v[216:219], v[116:119]
  buffer_load_dwordx4 v2, s[4:7], s72 offen offset:3072 sc1 lds
  s_waitcnt lgkmcnt(4)
  v_mfma_f32_16x16x32_bf16 v[32:35], a[128:131], v[220:223], v[32:35]
  ds_read_b128 v[204:207], v248 offset:16384
  v_mfma_f32_16x16x32_bf16 v[36:39], a[128:131], v[224:227], v[36:39]
  ds_read_b128 v[208:211], v249 offset:16384
  v_mfma_f32_16x16x32_bf16 v[40:43], a[128:131], v[228:231], v[40:43]
  ds_read_b128 v[212:215], v252 offset:16384
  v_mfma_f32_16x16x32_bf16 v[44:47], a[128:131], v[232:235], v[44:47]
  ds_read_b128 v[216:219], v255 offset:16384
  buffer_load_dwordx4 a[164:167], v2, s[4:7], s25 offen offset:1024
  v_mfma_f32_16x16x32_bf16 v[104:107], a[132:135], v[220:223], v[104:107]
  v_mfma_f32_16x16x32_bf16 v[108:111], a[132:135], v[224:227], v[108:111]
  v_mfma_f32_16x16x32_bf16 v[112:115], a[132:135], v[228:231], v[112:115]
  v_mfma_f32_16x16x32_bf16 v[116:119], a[132:135], v[232:235], v[116:119]
  buffer_load_dwordx4 a[168:171], v2, s[4:7], s25 offen offset:2048
  s_waitcnt lgkmcnt(4)
  v_mfma_f32_16x16x32_bf16 v[32:35], a[136:139], v[188:191], v[32:35]
  ds_read_b128 v[220:223], v248 offset:24576
  v_mfma_f32_16x16x32_bf16 v[36:39], a[136:139], v[192:195], v[36:39]
  ds_read_b128 v[224:227], v249 offset:24576
  v_mfma_f32_16x16x32_bf16 v[40:43], a[136:139], v[196:199], v[40:43]
  ds_read_b128 v[228:231], v252 offset:24576
  v_mfma_f32_16x16x32_bf16 v[44:47], a[136:139], v[200:203], v[44:47]
  ds_read_b128 v[232:235], v255 offset:24576
  buffer_load_dwordx4 a[172:175], v2, s[4:7], s25 offen offset:3072
  v_mfma_f32_16x16x32_bf16 v[104:107], a[140:143], v[188:191], v[104:107]
  v_mfma_f32_16x16x32_bf16 v[108:111], a[140:143], v[192:195], v[108:111]
  v_mfma_f32_16x16x32_bf16 v[112:115], a[140:143], v[196:199], v[112:115]
  v_mfma_f32_16x16x32_bf16 v[116:119], a[140:143], v[200:203], v[116:119]
  s_add_u32 s25, s25, 4096
  buffer_load_dwordx4 a[176:179], v2, s[4:7], s25 offen offset:0
  s_waitcnt vmcnt(4)
  s_barrier
  s_add_u32 s26, s56, 0
  v_add_u32 v244, s26, v4
  v_add_u32 v245, s26, v5
  v_add_u32 v246, s26, v6
  v_add_u32 v247, s26, v7
  s_waitcnt lgkmcnt(4)
  v_mfma_f32_16x16x32_bf16 v[32:35], a[144:147], v[204:207], v[32:35]
  ds_read_b128 v[188:191], v244 offset:0
  v_mfma_f32_16x16x32_bf16 v[36:39], a[144:147], v[208:211], v[36:39]
  ds_read_b128 v[192:195], v245 offset:0
  v_mfma_f32_16x16x32_bf16 v[40:43], a[144:147], v[212:215], v[40:43]
  ds_read_b128 v[196:199], v246 offset:0
  v_mfma_f32_16x16x32_bf16 v[44:47], a[144:147], v[216:219], v[44:47]
  ds_read_b128 v[200:203], v247 offset:0
  buffer_load_dwordx4 a[180:183], v2, s[4:7], s25 offen offset:1024
  v_mfma_f32_16x16x32_bf16 v[104:107], a[148:151], v[204:207], v[104:107]
  v_mfma_f32_16x16x32_bf16 v[108:111], a[148:151], v[208:211], v[108:111]
  v_mfma_f32_16x16x32_bf16 v[112:115], a[148:151], v[212:215], v[112:115]
  v_mfma_f32_16x16x32_bf16 v[116:119], a[148:151], v[216:219], v[116:119]
  buffer_load_dwordx4 a[184:187], v2, s[4:7], s25 offen offset:2048
  s_waitcnt lgkmcnt(4)
  v_mfma_f32_16x16x32_bf16 v[32:35], a[152:155], v[220:223], v[32:35]
  ds_read_b128 v[204:207], v244 offset:8192
  v_mfma_f32_16x16x32_bf16 v[36:39], a[152:155], v[224:227], v[36:39]
  ds_read_b128 v[208:211], v245 offset:8192
  v_mfma_f32_16x16x32_bf16 v[40:43], a[152:155], v[228:231], v[40:43]
  ds_read_b128 v[212:215], v246 offset:8192
  v_mfma_f32_16x16x32_bf16 v[44:47], a[152:155], v[232:235], v[44:47]
  ds_read_b128 v[216:219], v247 offset:8192
  buffer_load_dwordx4 a[188:191], v2, s[4:7], s25 offen offset:3072
  v_mfma_f32_16x16x32_bf16 v[104:107], a[156:159], v[220:223], v[104:107]
  v_mfma_f32_16x16x32_bf16 v[108:111], a[156:159], v[224:227], v[108:111]
  v_mfma_f32_16x16x32_bf16 v[112:115], a[156:159], v[228:231], v[112:115]
  v_mfma_f32_16x16x32_bf16 v[116:119], a[156:159], v[232:235], v[116:119]
  s_waitcnt vmcnt(6) lgkmcnt(4)
  v_mfma_f32_16x16x32_bf16 v[32:35], a[160:163], v[188:191], v[32:35]
  ds_read_b128 v[220:223], v244 offset:16384
  v_mfma_f32_16x16x32_bf16 v[36:39], a[160:163], v[192:195], v[36:39]
  ds_read_b128 v[224:227], v245 offset:16384
  v_mfma_f32_16x16x32_bf16 v[40:43], a[160:163], v[196:199], v[40:43]
  ds_read_b128 v[228:231], v246 offset:16384
  v_mfma_f32_16x16x32_bf16 v[44:47], a[160:163], v[200:203], v[44:47]
  ds_read_b128 v[232:235], v247 offset:16384
  v_mfma_f32_16x16x32_bf16 v[104:107], a[164:167], v[188:191], v[104:107]
  v_mfma_f32_16x16x32_bf16 v[108:111], a[164:167], v[192:195], v[108:111]
  v_mfma_f32_16x16x32_bf16 v[112:115], a[164:167], v[196:199], v[112:115]
  v_mfma_f32_16x16x32_bf16 v[116:119], a[164:167], v[200:203], v[116:119]
  s_waitcnt vmcnt(4) lgkmcnt(4)
  v_mfma_f32_16x16x32_bf16 v[32:35], a[168:171], v[204:207], v[32:35]
  ds_read_b128 v[188:191], v244 offset:24576
  v_mfma_f32_16x16x32_bf16 v[36:39], a[168:171], v[208:211], v[36:39]
  ds_read_b128 v[192:195], v245 offset:24576
  v_mfma_f32_16x16x32_bf16 v[40:43], a[168:171], v[212:215], v[40:43]
  ds_read_b128 v[196:199], v246 offset:24576
  v_mfma_f32_16x16x32_bf16 v[44:47], a[168:171], v[216:219], v[44:47]
  ds_read_b128 v[200:203], v247 offset:24576
  v_mfma_f32_16x16x32_bf16 v[104:107], a[172:175], v[204:207], v[104:107]
  v_mfma_f32_16x16x32_bf16 v[108:111], a[172:175], v[208:211], v[108:111]
  v_mfma_f32_16x16x32_bf16 v[112:115], a[172:175], v[212:215], v[112:115]
  v_mfma_f32_16x16x32_bf16 v[116:119], a[172:175], v[216:219], v[116:119]
  s_waitcnt vmcnt(2) lgkmcnt(4)
  v_mfma_f32_16x16x32_bf16 v[32:35], a[176:179], v[220:223], v[32:35]
  v_mfma_f32_16x16x32_bf16 v[36:39], a[176:179], v[224:227], v[36:39]
  v_mfma_f32_16x16x32_bf16 v[40:43], a[176:179], v[228:231], v[40:43]
  v_mfma_f32_16x16x32_bf16 v[44:47], a[176:179], v[232:235], v[44:47]
  v_mfma_f32_16x16x32_bf16 v[104:107], a[180:183], v[220:223], v[104:107]
  v_mfma_f32_16x16x32_bf16 v[108:111], a[180:183], v[224:227], v[108:111]
  v_mfma_f32_16x16x32_bf16 v[112:115], a[180:183], v[228:231], v[112:115]
  v_mfma_f32_16x16x32_bf16 v[116:119], a[180:183], v[232:235], v[116:119]
  s_waitcnt vmcnt(0) lgkmcnt(0)
  v_mfma_f32_16x16x32_bf16 v[32:35], a[184:187], v[188:191], v[32:35]
  v_mfma_f32_16x16x32_bf16 v[36:39], a[184:187], v[192:195], v[36:39]
  v_mfma_f32_16x16x32_bf16 v[40:43], a[184:187], v[196:199], v[40:43]
  v_mfma_f32_16x16x32_bf16 v[44:47], a[184:187], v[200:203], v[44:47]
  v_mfma_f32_16x16x32_bf16 v[104:107], a[188:191], v[188:191], v[104:107]
  v_mfma_f32_16x16x32_bf16 v[108:111], a[188:191], v[192:195], v[108:111]
  v_mfma_f32_16x16x32_bf16 v[112:115], a[188:191], v[196:199], v[112:115]
  v_mfma_f32_16x16x32_bf16 v[116:119], a[188:191], v[200:203], v[116:119]
  s_lshl_b32 s26, s22, 12
  s_add_u32 s27, s26, 98304
  v_add_u32 v250, s27, v2
  s_xor_b32 s26, s26, 8192
  s_add_u32 s27, s26, 98304
  v_add_u32 v251, s27, v2
  ds_write_b128 v250, v[104:107] offset:0
  ds_write_b128 v250, v[108:111] offset:1024
  ds_write_b128 v250, v[112:115] offset:2048
  ds_write_b128 v250, v[116:119] offset:3072
  s_waitcnt lgkmcnt(0)
  s_barrier
  ds_read_b128 v[120:123], v251 offset:2048
  ds_read_b128 v[124:127], v251 offset:3072
  ds_read_b128 v[128:131], v251 offset:0
  ds_read_b128 v[132:135], v251 offset:1024
  s_waitcnt lgkmcnt(3)
  v_pk_add_f32 v[32:33], v[32:33], v[120:121]
  v_pk_add_f32 v[34:35], v[34:35], v[122:123]
  s_waitcnt lgkmcnt(2)
  v_pk_add_f32 v[36:37], v[36:37], v[124:125]
  v_pk_add_f32 v[38:39], v[38:39], v[126:127]
  s_waitcnt lgkmcnt(1)
  v_pk_add_f32 v[40:41], v[40:41], v[128:129]
  v_pk_add_f32 v[42:43], v[42:43], v[130:131]
  s_waitcnt lgkmcnt(0)
  v_pk_add_f32 v[44:45], v[44:45], v[132:133]
  v_pk_add_f32 v[46:47], v[46:47], v[134:135]
  v_cvt_pk_bf16_f32 v176, v32, v33
  v_cvt_pk_bf16_f32 v177, v34, v35
  v_cvt_pk_bf16_f32 v178, v36, v37
  v_cvt_pk_bf16_f32 v179, v38, v39
  v_cvt_pk_bf16_f32 v180, v40, v41
  v_cvt_pk_bf16_f32 v181, v42, v43
  v_cvt_pk_bf16_f32 v182, v44, v45
  v_cvt_pk_bf16_f32 v183, v46, v47
  v_permlane16_swap_b32 v176, v178
  v_permlane16_swap_b32 v177, v179
  v_permlane16_swap_b32 v180, v182
  v_permlane16_swap_b32 v181, v183
  s_lshl_b32 s26, s20, 16
  s_lshl_b32 s27, s21, 7
  s_add_u32 s26, s26, s27
  s_lshl_b32 s27, s22, 5
  s_add_u32 s26, s26, s27
  v_and_b32 v184, 1023, v12
  v_lshlrev_b32 v184, 6, v184
  v_lshrrev_b32 v185, 10, v12
  v_lshlrev_b32 v185, 4, v185
  v_add_u32 v186, v184, v185
  buffer_store_dwordx4 v[176:179], v186, s[16:19], s26 offen
  v_and_b32 v184, 1023, v13
  v_lshlrev_b32 v184, 6, v184
  v_lshrrev_b32 v185, 10, v13
  v_lshlrev_b32 v185, 4, v185
  v_add_u32 v187, v184, v185
  buffer_store_dwordx4 v[180:183], v187, s[16:19], s26 offen
  s_waitcnt vmcnt(0) lgkmcnt(0)
M_done:
  s_endpgm
M_end:
XS_8:
  buffer_store_dwordx4 v[192:195], v2, s[4:7], s26 offen sc1
  buffer_store_dword v196, v3, s[4:7], s26 offen offset:1024 sc1
  s_nop 7
  s_nop 7
  s_branch XD_9
SP_13:
  s_mov_b32 s32, 0
SPl_15:
  s_add_u32 s26, s64, 0
  buffer_load_dwordx4 v[104:107], v2, s[4:7], s26 offen sc1
  buffer_load_dword v120, v3, s[4:7], s26 offen offset:1024 sc1
  s_add_u32 s26, s26, 1280
  buffer_load_dwordx4 v[108:111], v2, s[4:7], s26 offen sc1
  buffer_load_dword v121, v3, s[4:7], s26 offen offset:1024 sc1
  s_add_u32 s26, s26, 1280
  buffer_load_dwordx4 v[112:115], v2, s[4:7], s26 offen sc1
  buffer_load_dword v122, v3, s[4:7], s26 offen offset:1024 sc1
  s_add_u32 s26, s26, 1280
  buffer_load_dwordx4 v[116:119], v2, s[4:7], s26 offen sc1
  buffer_load_dword v123, v3, s[4:7], s26 offen offset:1024 sc1
  s_waitcnt vmcnt(0)
  v_max_u32 v250, v104, v105
  v_max3_u32 v250, v250, v106, v107
  v_max3_u32 v250, v250, v108, v109
  v_max3_u32 v250, v250, v110, v111
  v_max3_u32 v250, v250, v112, v113
  v_max3_u32 v250, v250, v114, v115
  v_max3_u32 v250, v250, v116, v117
  v_max3_u32 v250, v250, v118, v119
  v_max3_u32 v250, v250, v120, v121
  v_max3_u32 v250, v250, v122, v123
  v_cmp_eq_u32 vcc, -1, v250
  s_cbranch_vccz SPd_16
  s_add_u32 s32, s32, 1
  s_cmp_lt_u32 s32, 200000
  s_cbranch_scc1 SPl_15
SPd_16:
  s_nop 7
  s_nop 7
  s_branch SPok_14
SP_17:
  s_mov_b32 s32, 0
SPl_19:
  s_add_u32 s26, s66, 0
  buffer_load_dwordx4 v[176:179], v2, s[4:7], s26 offen offset:0 sc1
  buffer_load_dwordx4 v[180:183], v2, s[4:7], s26 offen offset:1024 sc1
  buffer_load_dwordx4 v[184:187], v2, s[4:7], s26 offen offset:2048 sc1
  buffer_load_dwordx4 v[188:191], v2, s[4:7], s26 offen offset:3072 sc1
  s_add_u32 s26, s26, 4096
  buffer_load_dwordx4 v[192:195], v2, s[4:7], s26 offen offset:0 sc1
  buffer_load_dwordx4 v[196:199], v2, s[4:7], s26 offen offset:1024 sc1
  buffer_load_dwordx4 v[200:203], v2, s[4:7], s26 offen offset:2048 sc1
  buffer_load_dwordx4 v[204:207], v2, s[4:7], s26 offen offset:3072 sc1
  s_waitcnt vmcnt(0)
  v_max_u32 v250, v176, v177
  v_max3_u32 v250, v250, v178, v180
  v_max3_u32 v250, v250, v181, v182
  v_max3_u32 v250, v250, v184, v185
  v_max3_u32 v250, v250, v186, v188
  v_max3_u32 v250, v250, v189, v190
  v_max3_u32 v250, v250, v192, v193
  v_max3_u32 v250, v250, v194, v196
  v_max3_u32 v250, v250, v197, v198
  v_max3_u32 v250, v250, v200, v201
  v_max3_u32 v250, v250, v202, v204
  v_max3_u32 v250, v250, v205, v206
  v_cmp_eq_u32 vcc, -1, v250
  s_cbranch_vccz SPd_20
  s_add_u32 s32, s32, 1
  s_cmp_lt_u32 s32, 200000
  s_cbranch_scc1 SPl_19
SPd_20:
  s_nop 7
  s_nop 7
  s_branch SPok_18
XS_21:
  buffer_store_dwordx4 v[216:219], v2, s[4:7], s26 offen sc1
  buffer_store_dword v216, v3, s[4:7], s26 offen offset:1024 sc1
  s_nop 7
  s_nop 7
  s_branch XD_22
XS_23:
  buffer_store_dwordx4 v[176:179], v12, s[4:7], s26 offen sc1
  buffer_store_dwordx4 v[180:183], v13, s[4:7], s26 offen sc1
  s_nop 7
  s_nop 7
  s_branch XD_24
XS_25:
  buffer_store_dword v254, v251, s[4:7], s74 offen sc1
  s_nop 7
  s_nop 7
  s_branch XD_26
SQ_27:
  s_sleep 3
  s_load_dwordx16 s[80:95], s[76:77], 128
  s_waitcnt lgkmcnt(0)
  s_and_b64 s[80:81], s[80:81], s[82:83]
  s_and_b64 s[84:85], s[84:85], s[86:87]
  s_and_b64 s[88:89], s[88:89], s[90:91]
  s_and_b64 s[92:93], s[92:93], s[94:95]
  s_and_b64 s[80:81], s[80:81], s[84:85]
  s_and_b64 s[88:89], s[88:89], s[92:93]
  s_and_b64 s[80:81], s[80:81], s[88:89]
  s_and_b32 s96, s80, s81
  s_cmp_eq_u32 s96, 1
  s_cbranch_scc1 SQd_29
  s_sleep 3
  s_load_dwordx16 s[80:95], s[76:77], 256
  s_waitcnt lgkmcnt(0)
  s_and_b64 s[80:81], s[80:81], s[82:83]
  s_and_b64 s[84:85], s[84:85], s[86:87]
  s_and_b64 s[88:89], s[88:89], s[90:91]
  s_and_b64 s[92:93], s[92:93], s[94:95]
  s_and_b64 s[80:81], s[80:81], s[84:85]
  s_and_b64 s[88:89], s[88:89], s[92:93]
  s_and_b64 s[80:81], s[80:81], s[88:89]
  s_and_b32 s96, s80, s81
  s_cmp_eq_u32 s96, 1
  s_cbranch_scc1 SQd_29
  s_sleep 3
  s_load_dwordx16 s[80:95], s[76:77], 384
  s_waitcnt lgkmcnt(0)
  s_and_b64 s[80:81], s[80:81], s[82:83]
  s_and_b64 s[84:85], s[84:85], s[86:87]
  s_and_b64 s[88:89], s[88:89], s[90:91]
  s_and_b64 s[92:93], s[92:93], s[94:95]
  s_and_b64 s[80:81], s[80:81], s[84:85]
  s_and_b64 s[88:89], s[88:89], s[92:93]
  s_and_b64 s[80:81], s[80:81], s[88:89]
  s_and_b32 s96, s80, s81
  s_cmp_eq_u32 s96, 1
  s_cbranch_scc1 SQd_29
  s_add_u32 s74, s33, 0
  s_mov_b32 exec_hi, 0
  s_mov_b32 s32, 0
SQl_30:
  buffer_load_dword v250, v3, s[4:7], s74 offen sc1
  s_waitcnt vmcnt(0)
  v_cmp_eq_u32 vcc, 0, v250
  s_cbranch_vccz SQl_30_d
  s_add_u32 s32, s32, 1
  s_cmp_lt_u32 s32, 200000
  s_cbranch_scc1 SQl_30
SQl_30_d:
  s_mov_b32 exec_hi, -1
SQd_29:
  s_nop 7
  s_nop 7
  s_branch SQok_28
XS_31:
  buffer_store_dwordx4 v[176:179], v12, s[4:7], s26 offen sc1
  buffer_store_dwordx4 v[180:183], v13, s[4:7], s26 offen sc1
  s_nop 7
  s_nop 7
  s_branch XD_32
XS_33:
  buffer_store_dword v254, v251, s[4:7], s74 offen sc1
  s_nop 7
  s_nop 7
  s_branch XD_34
SQ_35:
  s_sleep 3
  s_load_dwordx16 s[80:95], s[76:77], 640
  s_waitcnt lgkmcnt(0)
  s_and_b64 s[80:81], s[80:81], s[82:83]
  s_and_b64 s[84:85], s[84:85], s[86:87]
  s_and_b64 s[88:89], s[88:89], s[90:91]
  s_and_b64 s[92:93], s[92:93], s[94:95]
  s_and_b64 s[80:81], s[80:81], s[84:85]
  s_and_b64 s[88:89], s[88:89], s[92:93]
  s_and_b64 s[80:81], s[80:81], s[88:89]
  s_and_b32 s96, s80, s81
  s_cmp_eq_u32 s96, 1
  s_cbranch_scc1 SQd_37
  s_sleep 3
  s_load_dwordx16 s[80:95], s[76:77], 768
  s_waitcnt lgkmcnt(0)
  s_and_b64 s[80:81], s[80:81], s[82:83]
  s_and_b64 s[84:85], s[84:85], s[86:87]
  s_and_b64 s[88:89], s[88:89], s[90:91]
  s_and_b64 s[92:93], s[92:93], s[94:95]
  s_and_b64 s[80:81], s[80:81], s[84:85]
  s_and_b64 s[88:89], s[88:89], s[92:93]
  s_and_b64 s[80:81], s[80:81], s[88:89]
  s_and_b32 s96, s80, s81
  s_cmp_eq_u32 s96, 1
  s_cbranch_scc1 SQd_37
  s_sleep 3
  s_load_dwordx16 s[80:95], s[76:77], 896
  s_waitcnt lgkmcnt(0)
  s_and_b64 s[80:81], s[80:81], s[82:83]
  s_and_b64 s[84:85], s[84:85], s[86:87]
  s_and_b64 s[88:89], s[88:89], s[90:91]
  s_and_b64 s[92:93], s[92:93], s[94:95]
  s_and_b64 s[80:81], s[80:81], s[84:85]
  s_and_b64 s[88:89], s[88:89], s[92:93]
  s_and_b64 s[80:81], s[80:81], s[88:89]
  s_and_b32 s96, s80, s81
  s_cmp_eq_u32 s96, 1
  s_cbranch_scc1 SQd_37
  s_add_u32 s74, s33, 512
  s_mov_b32 exec_hi, 0
  s_mov_b32 s32, 0
SQl_38:
  buffer_load_dword v250, v3, s[4:7], s74 offen sc1
  s_waitcnt vmcnt(0)
  v_cmp_eq_u32 vcc, 0, v250
  s_cbranch_vccz SQl_38_d
  s_add_u32 s32, s32, 1
  s_cmp_lt_u32 s32, 200000
  s_cbranch_scc1 SQl_38
SQl_38_d:
  s_mov_b32 exec_hi, -1
SQd_37:
  s_nop 7
  s_nop 7
  s_branch SQok_36
XS_39:
  buffer_store_dwordx4 v[176:179], v12, s[4:7], s97 offen sc1
  s_nop 7
  s_nop 7
  s_branch XD_40
XS_41:
  buffer_store_dwordx4 v[180:183], v13, s[4:7], s97 offen sc1
  s_nop 7
  s_nop 7
  s_branch XD_42
XS_43:
  buffer_store_dword v254, v251, s[4:7], s74 offen sc1
  s_nop 7
  s_nop 7
  s_branch XD_44
SQ_47:
  s_sleep 3
  s_load_dwordx16 s[80:95], s[76:77], 1152
  s_waitcnt lgkmcnt(0)
  s_and_b64 s[80:81], s[80:81], s[82:83]
  s_and_b64 s[84:85], s[84:85], s[86:87]
  s_and_b64 s[88:89], s[88:89], s[90:91]
  s_and_b64 s[92:93], s[92:93], s[94:95]
  s_and_b64 s[80:81], s[80:81], s[84:85]
  s_and_b64 s[88:89], s[88:89], s[92:93]
  s_and_b64 s[80:81], s[80:81], s[88:89]
  s_and_b32 s96, s80, s81
  s_cmp_eq_u32 s96, 1
  s_cbranch_scc1 SQd_49
  s_sleep 3
  s_load_dwordx16 s[80:95], s[76:77], 1280
  s_waitcnt lgkmcnt(0)
  s_and_b64 s[80:81], s[80:81], s[82:83]
  s_and_b64 s[84:85], s[84:85], s[86:87]
  s_and_b64 s[88:89], s[88:89], s[90:91]
  s_and_b64 s[92:93], s[92:93], s[94:95]
  s_and_b64 s[80:81], s[80:81], s[84:85]
  s_and_b64 s[88:89], s[88:89], s[92:93]
  s_and_b64 s[80:81], s[80:81], s[88:89]
  s_and_b32 s96, s80, s81
  s_cmp_eq_u32 s96, 1
  s_cbranch_scc1 SQd_49
  s_sleep 3
  s_load_dwordx16 s[80:95], s[76:77], 1408
  s_waitcnt lgkmcnt(0)
  s_and_b64 s[80:81], s[80:81], s[82:83]
  s_and_b64 s[84:85], s[84:85], s[86:87]
  s_and_b64 s[88:89], s[88:89], s[90:91]
  s_and_b64 s[92:93], s[92:93], s[94:95]
  s_and_b64 s[80:81], s[80:81], s[84:85]
  s_and_b64 s[88:89], s[88:89], s[92:93]
  s_and_b64 s[80:81], s[80:81], s[88:89]
  s_and_b32 s96, s80, s81
  s_cmp_eq_u32 s96, 1
  s_cbranch_scc1 SQd_49
  s_add_u32 s74, s33, 1024
  s_mov_b32 exec_hi, 0
  s_mov_b32 s32, 0
SQl_50:
  buffer_load_dword v250, v3, s[4:7], s74 offen sc1
  s_waitcnt vmcnt(0)
  v_cmp_eq_u32 vcc, 0, v250
  s_cbranch_vccz SQl_50_d
  s_add_u32 s32, s32, 1
  s_cmp_lt_u32 s32, 200000
  s_cbranch_scc1 SQl_50
SQl_50_d:
  s_mov_b32 exec_hi, -1
SQd_49:
  s_nop 7
  s_nop 7
  s_branch SQok_48
SP_52:
  s_mov_b32 s32, 0
SPl_54:
  s_add_u32 s26, s63, 0
  buffer_load_dwordx4 v[176:179], v184, s[4:7], s26 offen sc1
  buffer_load_dwordx4 v[180:183], v184, s[4:7], s26 offen offset:16 sc1
  s_waitcnt vmcnt(0)
  v_max_u32 v250, v176, v177
  v_max3_u32 v250, v250, v178, v179
  v_max3_u32 v250, v250, v180, v181
  v_max3_u32 v250, v250, v182, v183
  v_cmp_eq_u32 vcc, -1, v250
  s_cbranch_vccz SPd_55
  s_add_u32 s32, s32, 1
  s_cmp_lt_u32 s32, 200000
  s_cbranch_scc1 SPl_54
SPd_55:
  s_nop 7
  s_nop 7
  s_branch SPok_53
XS_56:
  buffer_store_dwordx4 v[176:179], v12, s[4:7], s26 offen sc1
  buffer_store_dwordx4 v[180:183], v13, s[4:7], s26 offen sc1
  s_nop 7
  s_nop 7
  s_branch XD_57
XS_58:
  buffer_store_dword v254, v251, s[4:7], s74 offen sc1
  s_nop 7
  s_nop 7
  s_branch XD_59
SQ_60:
  s_sleep 3
  s_load_dwordx16 s[80:95], s[76:77], 1664
  s_waitcnt lgkmcnt(0)
  s_and_b64 s[80:81], s[80:81], s[82:83]
  s_and_b64 s[84:85], s[84:85], s[86:87]
  s_and_b64 s[88:89], s[88:89], s[90:91]
  s_and_b64 s[92:93], s[92:93], s[94:95]
  s_and_b64 s[80:81], s[80:81], s[84:85]
  s_and_b64 s[88:89], s[88:89], s[92:93]
  s_and_b64 s[80:81], s[80:81], s[88:89]
  s_and_b32 s96, s80, s81
  s_cmp_eq_u32 s96, 1
  s_cbranch_scc1 SQd_62
  s_sleep 3
  s_load_dwordx16 s[80:95], s[76:77], 1792
  s_waitcnt lgkmcnt(0)
  s_and_b64 s[80:81], s[80:81], s[82:83]
  s_and_b64 s[84:85], s[84:85], s[86:87]
  s_and_b64 s[88:89], s[88:89], s[90:91]
  s_and_b64 s[92:93], s[92:93], s[94:95]
  s_and_b64 s[80:81], s[80:81], s[84:85]
  s_and_b64 s[88:89], s[88:89], s[92:93]
  s_and_b64 s[80:81], s[80:81], s[88:89]
  s_and_b32 s96, s80, s81
  s_cmp_eq_u32 s96, 1
  s_cbranch_scc1 SQd_62
  s_sleep 3
  s_load_dwordx16 s[80:95], s[76:77], 1920
  s_waitcnt lgkmcnt(0)
  s_and_b64 s[80:81], s[80:81], s[82:83]
  s_and_b64 s[84:85], s[84:85], s[86:87]
  s_and_b64 s[88:89], s[88:89], s[90:91]
  s_and_b64 s[92:93], s[92:93], s[94:95]
  s_and_b64 s[80:81], s[80:81], s[84:85]
  s_and_b64 s[88:89], s[88:89], s[92:93]
  s_and_b64 s[80:81], s[80:81], s[88:89]
  s_and_b32 s96, s80, s81
  s_cmp_eq_u32 s96, 1
  s_cbranch_scc1 SQd_62
  s_add_u32 s74, s33, 1536
  s_mov_b32 exec_hi, 0
  s_mov_b32 s32, 0
SQl_63:
  buffer_load_dword v250, v3, s[4:7], s74 offen sc1
  s_waitcnt vmcnt(0)
  v_cmp_eq_u32 vcc, 0, v250
  s_cbranch_vccz SQl_63_d
  s_add_u32 s32, s32, 1
  s_cmp_lt_u32 s32, 200000
  s_cbranch_scc1 SQl_63
SQl_63_d:
  s_mov_b32 exec_hi, -1
SQd_62:
  s_nop 7
  s_nop 7
  s_branch SQok_61
XS_64:
  buffer_store_dwordx4 v[176:179], v12, s[4:7], s97 offen sc1
  s_nop 7
  s_nop 7
  s_branch XD_65
XS_66:
  buffer_store_dwordx4 v[180:183], v13, s[4:7], s97 offen sc1
  s_nop 7
  s_nop 7
  s_branch XD_67
XS_68:
  buffer_store_dwordx4 v[168:171], v12, s[4:7], s57 offen sc1
  s_nop 7
  s_nop 7
  s_branch XD_69
XS_70:
  buffer_store_dwordx4 v[172:175], v13, s[4:7], s57 offen sc1
  s_nop 7
  s_nop 7
  s_branch XD_71
XS_72:
  buffer_store_dwordx4 v[216:219], v12, s[4:7], s97 offen sc1
  s_nop 7
  s_nop 7
  s_branch XD_73
XS_74:
  buffer_store_dwordx4 v[220:223], v13, s[4:7], s97 offen sc1
  s_nop 7
  s_nop 7
  s_branch XD_75
XS_76:
  buffer_store_dwordx4 v[192:195], v239, s[4:7], s26 offen sc1
  s_nop 7
  s_nop 7
  s_branch XD_77
XS_78:
  buffer_store_dword v254, v251, s[4:7], s74 offen sc1
  s_nop 7
  s_nop 7
  s_branch XD_79
SQ_80:
  s_sleep 3
  s_load_dwordx16 s[80:95], s[76:77], 2176
  s_waitcnt lgkmcnt(0)
  s_and_b64 s[80:81], s[80:81], s[82:83]
  s_and_b64 s[84:85], s[84:85], s[86:87]
  s_and_b64 s[88:89], s[88:89], s[90:91]
  s_and_b64 s[92:93], s[92:93], s[94:95]
  s_and_b64 s[80:81], s[80:81], s[84:85]
  s_and_b64 s[88:89], s[88:89], s[92:93]
  s_and_b64 s[80:81], s[80:81], s[88:89]
  s_and_b32 s96, s80, s81
  s_load_dwordx16 s[80:95], s[78:79], 2176
  s_waitcnt lgkmcnt(0)
  s_and_b64 s[80:81], s[80:81], s[82:83]
  s_and_b64 s[84:85], s[84:85], s[86:87]
  s_and_b64 s[88:89], s[88:89], s[90:91]
  s_and_b64 s[92:93], s[92:93], s[94:95]
  s_and_b64 s[80:81], s[80:81], s[84:85]
  s_and_b64 s[88:89], s[88:89], s[92:93]
  s_and_b64 s[80:81], s[80:81], s[88:89]
  s_and_b32 s96, s96, s80
  s_and_b32 s96, s96, s81
  s_cmp_eq_u32 s96, 1
  s_cbranch_scc1 SQd_82
  s_sleep 3
  s_load_dwordx16 s[80:95], s[76:77], 2304
  s_waitcnt lgkmcnt(0)
  s_and_b64 s[80:81], s[80:81], s[82:83]
  s_and_b64 s[84:85], s[84:85], s[86:87]
  s_and_b64 s[88:89], s[88:89], s[90:91]
  s_and_b64 s[92:93], s[92:93], s[94:95]
  s_and_b64 s[80:81], s[80:81], s[84:85]
  s_and_b64 s[88:89], s[88:89], s[92:93]
  s_and_b64 s[80:81], s[80:81], s[88:89]
  s_and_b32 s96, s80, s81
  s_load_dwordx16 s[80:95], s[78:79], 2304
  s_waitcnt lgkmcnt(0)
  s_and_b64 s[80:81], s[80:81], s[82:83]
  s_and_b64 s[84:85], s[84:85], s[86:87]
  s_and_b64 s[88:89], s[88:89], s[90:91]
  s_and_b64 s[92:93], s[92:93], s[94:95]
  s_and_b64 s[80:81], s[80:81], s[84:85]
  s_and_b64 s[88:89], s[88:89], s[92:93]
  s_and_b64 s[80:81], s[80:81], s[88:89]
  s_and_b32 s96, s96, s80
  s_and_b32 s96, s96, s81
  s_cmp_eq_u32 s96, 1
  s_cbranch_scc1 SQd_82
  s_sleep 3
  s_load_dwordx16 s[80:95], s[76:77], 2432
  s_waitcnt lgkmcnt(0)
  s_and_b64 s[80:81], s[80:81], s[82:83]
  s_and_b64 s[84:85], s[84:85], s[86:87]
  s_and_b64 s[88:89], s[88:89], s[90:91]
  s_and_b64 s[92:93], s[92:93], s[94:95]
  s_and_b64 s[80:81], s[80:81], s[84:85]
  s_and_b64 s[88:89], s[88:89], s[92:93]
  s_and_b64 s[80:81], s[80:81], s[88:89]
  s_and_b32 s96, s80, s81
  s_load_dwordx16 s[80:95], s[78:79], 2432
  s_waitcnt lgkmcnt(0)
  s_and_b64 s[80:81], s[80:81], s[82:83]
  s_and_b64 s[84:85], s[84:85], s[86:87]
  s_and_b64 s[88:89], s[88:89], s[90:91]
  s_and_b64 s[92:93], s[92:93], s[94:95]
  s_and_b64 s[80:81], s[80:81], s[84:85]
  s_and_b64 s[88:89], s[88:89], s[92:93]
  s_and_b64 s[80:81], s[80:81], s[88:89]
  s_and_b32 s96, s96, s80
  s_and_b32 s96, s96, s81
  s_cmp_eq_u32 s96, 1
  s_cbranch_scc1 SQd_82
  s_add_u32 s74, s33, 2048
  s_mov_b32 exec_hi, 0
  s_mov_b32 s32, 0
SQl_83:
  buffer_load_dword v250, v3, s[4:7], s74 offen sc1
  s_waitcnt vmcnt(0)
  v_cmp_eq_u32 vcc, 0, v250
  s_cbranch_vccz SQl_83_d
  s_add_u32 s32, s32, 1
  s_cmp_lt_u32 s32, 200000
  s_cbranch_scc1 SQl_83
SQl_83_d:
  s_mov_b32 exec_hi, -1
SQd_82:
  s_nop 7
  s_nop 7
  s_branch SQok_81
XS_84:
  buffer_store_dwordx4 v[176:179], v12, s[4:7], s26 offen sc1
  buffer_store_dwordx4 v[180:183], v13, s[4:7], s26 offen sc1
  s_nop 7
  s_nop 7
  s_branch XD_85
XS_86:
  buffer_store_dword v254, v251, s[4:7], s74 offen sc1
  s_nop 7
  s_nop 7
  s_branch XD_87
SQ_88:
  s_sleep 3
  s_load_dwordx16 s[80:95], s[76:77], 2688
  s_waitcnt lgkmcnt(0)
  s_and_b64 s[80:81], s[80:81], s[82:83]
  s_and_b64 s[84:85], s[84:85], s[86:87]
  s_and_b64 s[88:89], s[88:89], s[90:91]
  s_and_b64 s[92:93], s[92:93], s[94:95]
  s_and_b64 s[80:81], s[80:81], s[84:85]
  s_and_b64 s[88:89], s[88:89], s[92:93]
  s_and_b64 s[80:81], s[80:81], s[88:89]
  s_and_b32 s96, s80, s81
  s_cmp_eq_u32 s96, 1
  s_cbranch_scc1 SQd_90
  s_sleep 3
  s_load_dwordx16 s[80:95], s[76:77], 2816
  s_waitcnt lgkmcnt(0)
  s_and_b64 s[80:81], s[80:81], s[82:83]
  s_and_b64 s[84:85], s[84:85], s[86:87]
  s_and_b64 s[88:89], s[88:89], s[90:91]
  s_and_b64 s[92:93], s[92:93], s[94:95]
  s_and_b64 s[80:81], s[80:81], s[84:85]
  s_and_b64 s[88:89], s[88:89], s[92:93]
  s_and_b64 s[80:81], s[80:81], s[88:89]
  s_and_b32 s96, s80, s81
  s_cmp_eq_u32 s96, 1
  s_cbranch_scc1 SQd_90
  s_sleep 3
  s_load_dwordx16 s[80:95], s[76:77], 2944
  s_waitcnt lgkmcnt(0)
  s_and_b64 s[80:81], s[80:81], s[82:83]
  s_and_b64 s[84:85], s[84:85], s[86:87]
  s_and_b64 s[88:89], s[88:89], s[90:91]
  s_and_b64 s[92:93], s[92:93], s[94:95]
  s_and_b64 s[80:81], s[80:81], s[84:85]
  s_and_b64 s[88:89], s[88:89], s[92:93]
  s_and_b64 s[80:81], s[80:81], s[88:89]
  s_and_b32 s96, s80, s81
  s_cmp_eq_u32 s96, 1
  s_cbranch_scc1 SQd_90
  s_add_u32 s74, s33, 2560
  s_mov_b32 exec_hi, 0
  s_mov_b32 s32, 0
SQl_91:
  buffer_load_dword v250, v3, s[4:7], s74 offen sc1
  s_waitcnt vmcnt(0)
  v_cmp_eq_u32 vcc, 0, v250
  s_cbranch_vccz SQl_91_d
  s_add_u32 s32, s32, 1
  s_cmp_lt_u32 s32, 200000
  s_cbranch_scc1 SQl_91
SQl_91_d:
  s_mov_b32 exec_hi, -1
SQd_90:
  s_nop 7
  s_nop 7
  s_branch SQok_89
XS_92:
  buffer_store_dwordx4 v[192:195], v2, s[4:7], s26 offen sc1
  buffer_store_dword v196, v3, s[4:7], s26 offen offset:1024 sc1
  s_nop 7
  s_nop 7
  s_branch XD_93
SP_97:
  s_mov_b32 s32, 0
SPl_99:
  s_add_u32 s26, s64, 0
  buffer_load_dwordx4 v[104:107], v2, s[4:7], s26 offen sc1
  buffer_load_dword v120, v3, s[4:7], s26 offen offset:1024 sc1
  s_add_u32 s26, s26, 1280
  buffer_load_dwordx4 v[108:111], v2, s[4:7], s26 offen sc1
  buffer_load_dword v121, v3, s[4:7], s26 offen offset:1024 sc1
  s_add_u32 s26, s26, 1280
  buffer_load_dwordx4 v[112:115], v2, s[4:7], s26 offen sc1
  buffer_load_dword v122, v3, s[4:7], s26 offen offset:1024 sc1
  s_add_u32 s26, s26, 1280
  buffer_load_dwordx4 v[116:119], v2, s[4:7], s26 offen sc1
  buffer_load_dword v123, v3, s[4:7], s26 offen offset:1024 sc1
  s_waitcnt vmcnt(0)
  v_max_u32 v250, v104, v105
  v_max3_u32 v250, v250, v106, v107
  v_max3_u32 v250, v250, v108, v109
  v_max3_u32 v250, v250, v110, v111
  v_max3_u32 v250, v250, v112, v113
  v_max3_u32 v250, v250, v114, v115
  v_max3_u32 v250, v250, v116, v117
  v_max3_u32 v250, v250, v118, v119
  v_max3_u32 v250, v250, v120, v121
  v_max3_u32 v250, v250, v122, v123
  v_cmp_eq_u32 vcc, -1, v250
  s_cbranch_vccz SPd_100
  s_add_u32 s32, s32, 1
  s_cmp_lt_u32 s32, 200000
  s_cbranch_scc1 SPl_99
SPd_100:
  s_nop 7
  s_nop 7
  s_branch SPok_98
SP_101:
  s_mov_b32 s32, 0
SPl_103:
  s_add_u32 s26, s66, 262144
  buffer_load_dwordx4 v[176:179], v2, s[4:7], s26 offen offset:0 sc1
  buffer_load_dwordx4 v[180:183], v2, s[4:7], s26 offen offset:1024 sc1
  buffer_load_dwordx4 v[184:187], v2, s[4:7], s26 offen offset:2048 sc1
  buffer_load_dwordx4 v[188:191], v2, s[4:7], s26 offen offset:3072 sc1
  s_add_u32 s26, s26, 4096
  buffer_load_dwordx4 v[192:195], v2, s[4:7], s26 offen offset:0 sc1
  buffer_load_dwordx4 v[196:199], v2, s[4:7], s26 offen offset:1024 sc1
  buffer_load_dwordx4 v[200:203], v2, s[4:7], s26 offen offset:2048 sc1
  buffer_load_dwordx4 v[204:207], v2, s[4:7], s26 offen offset:3072 sc1
  s_waitcnt vmcnt(0)
  v_max_u32 v250, v176, v177
  v_max3_u32 v250, v250, v178, v180
  v_max3_u32 v250, v250, v181, v182
  v_max3_u32 v250, v250, v184, v185
  v_max3_u32 v250, v250, v186, v188
  v_max3_u32 v250, v250, v189, v190
  v_max3_u32 v250, v250, v192, v193
  v_max3_u32 v250, v250, v194, v196
  v_max3_u32 v250, v250, v197, v198
  v_max3_u32 v250, v250, v200, v201
  v_max3_u32 v250, v250, v202, v204
  v_max3_u32 v250, v250, v205, v206
  v_cmp_eq_u32 vcc, -1, v250
  s_cbranch_vccz SPd_104
  s_add_u32 s32, s32, 1
  s_cmp_lt_u32 s32, 200000
  s_cbranch_scc1 SPl_103
SPd_104:
  s_nop 7
  s_nop 7
  s_branch SPok_102
XS_105:
  buffer_store_dwordx4 v[176:179], v12, s[4:7], s26 offen sc1
  buffer_store_dwordx4 v[180:183], v13, s[4:7], s26 offen sc1
  s_nop 7
  s_nop 7
  s_branch XD_106
XS_107:
  buffer_store_dword v254, v251, s[4:7], s74 offen sc1
  s_nop 7
  s_nop 7
  s_branch XD_108
SQ_109:
  s_sleep 3
  s_load_dwordx16 s[80:95], s[76:77], 3200
  s_waitcnt lgkmcnt(0)
  s_and_b64 s[80:81], s[80:81], s[82:83]
  s_and_b64 s[84:85], s[84:85], s[86:87]
  s_and_b64 s[88:89], s[88:89], s[90:91]
  s_and_b64 s[92:93], s[92:93], s[94:95]
  s_and_b64 s[80:81], s[80:81], s[84:85]
  s_and_b64 s[88:89], s[88:89], s[92:93]
  s_and_b64 s[80:81], s[80:81], s[88:89]
  s_and_b32 s96, s80, s81
  s_cmp_eq_u32 s96, 1
  s_cbranch_scc1 SQd_111
  s_sleep 3
  s_load_dwordx16 s[80:95], s[76:77], 3328
  s_waitcnt lgkmcnt(0)
  s_and_b64 s[80:81], s[80:81], s[82:83]
  s_and_b64 s[84:85], s[84:85], s[86:87]
  s_and_b64 s[88:89], s[88:89], s[90:91]
  s_and_b64 s[92:93], s[92:93], s[94:95]
  s_and_b64 s[80:81], s[80:81], s[84:85]
  s_and_b64 s[88:89], s[88:89], s[92:93]
  s_and_b64 s[80:81], s[80:81], s[88:89]
  s_and_b32 s96, s80, s81
  s_cmp_eq_u32 s96, 1
  s_cbranch_scc1 SQd_111
  s_sleep 3
  s_load_dwordx16 s[80:95], s[76:77], 3456
  s_waitcnt lgkmcnt(0)
  s_and_b64 s[80:81], s[80:81], s[82:83]
  s_and_b64 s[84:85], s[84:85], s[86:87]
  s_and_b64 s[88:89], s[88:89], s[90:91]
  s_and_b64 s[92:93], s[92:93], s[94:95]
  s_and_b64 s[80:81], s[80:81], s[84:85]
  s_and_b64 s[88:89], s[88:89], s[92:93]
  s_and_b64 s[80:81], s[80:81], s[88:89]
  s_and_b32 s96, s80, s81
  s_cmp_eq_u32 s96, 1
  s_cbranch_scc1 SQd_111
  s_add_u32 s74, s33, 3072
  s_mov_b32 exec_hi, 0
  s_mov_b32 s32, 0
SQl_112:
  buffer_load_dword v250, v3, s[4:7], s74 offen sc1
  s_waitcnt vmcnt(0)
  v_cmp_eq_u32 vcc, 0, v250
  s_cbranch_vccz SQl_112_d
  s_add_u32 s32, s32, 1
  s_cmp_lt_u32 s32, 200000
  s_cbranch_scc1 SQl_112
SQl_112_d:
  s_mov_b32 exec_hi, -1
SQd_111:
  s_nop 7
  s_nop 7
  s_branch SQok_110
XS_113:
  buffer_store_dwordx4 v[176:179], v12, s[4:7], s26 offen sc1
  buffer_store_dwordx4 v[180:183], v13, s[4:7], s26 offen sc1
  s_nop 7
  s_nop 7
  s_branch XD_114
XS_115:
  buffer_store_dword v254, v251, s[4:7], s74 offen sc1
  s_nop 7
  s_nop 7
  s_branch XD_116
SQ_117:
  s_sleep 3
  s_load_dwordx16 s[80:95], s[76:77], 3712
  s_waitcnt lgkmcnt(0)
  s_and_b64 s[80:81], s[80:81], s[82:83]
  s_and_b64 s[84:85], s[84:85], s[86:87]
  s_and_b64 s[88:89], s[88:89], s[90:91]
  s_and_b64 s[92:93], s[92:93], s[94:95]
  s_and_b64 s[80:81], s[80:81], s[84:85]
  s_and_b64 s[88:89], s[88:89], s[92:93]
  s_and_b64 s[80:81], s[80:81], s[88:89]
  s_and_b32 s96, s80, s81
  s_cmp_eq_u32 s96, 1
  s_cbranch_scc1 SQd_119
  s_sleep 3
  s_load_dwordx16 s[80:95], s[76:77], 3840
  s_waitcnt lgkmcnt(0)
  s_and_b64 s[80:81], s[80:81], s[82:83]
  s_and_b64 s[84:85], s[84:85], s[86:87]
  s_and_b64 s[88:89], s[88:89], s[90:91]
  s_and_b64 s[92:93], s[92:93], s[94:95]
  s_and_b64 s[80:81], s[80:81], s[84:85]
  s_and_b64 s[88:89], s[88:89], s[92:93]
  s_and_b64 s[80:81], s[80:81], s[88:89]
  s_and_b32 s96, s80, s81
  s_cmp_eq_u32 s96, 1
  s_cbranch_scc1 SQd_119
  s_sleep 3
  s_load_dwordx16 s[80:95], s[76:77], 3968
  s_waitcnt lgkmcnt(0)
  s_and_b64 s[80:81], s[80:81], s[82:83]
  s_and_b64 s[84:85], s[84:85], s[86:87]
  s_and_b64 s[88:89], s[88:89], s[90:91]
  s_and_b64 s[92:93], s[92:93], s[94:95]
  s_and_b64 s[80:81], s[80:81], s[84:85]
  s_and_b64 s[88:89], s[88:89], s[92:93]
  s_and_b64 s[80:81], s[80:81], s[88:89]
  s_and_b32 s96, s80, s81
  s_cmp_eq_u32 s96, 1
  s_cbranch_scc1 SQd_119
  s_add_u32 s74, s33, 3584
  s_mov_b32 exec_hi, 0
  s_mov_b32 s32, 0
SQl_120:
  buffer_load_dword v250, v3, s[4:7], s74 offen sc1
  s_waitcnt vmcnt(0)
  v_cmp_eq_u32 vcc, 0, v250
  s_cbranch_vccz SQl_120_d
  s_add_u32 s32, s32, 1
  s_cmp_lt_u32 s32, 200000
  s_cbranch_scc1 SQl_120
SQl_120_d:
  s_mov_b32 exec_hi, -1
SQd_119:
  s_nop 7
  s_nop 7
  s_branch SQok_118
XS_121:
  buffer_store_dwordx4 v[176:179], v12, s[4:7], s97 offen sc1
  s_nop 7
  s_nop 7
  s_branch XD_122
XS_123:
  buffer_store_dwordx4 v[180:183], v13, s[4:7], s97 offen sc1
  s_nop 7
  s_nop 7
  s_branch XD_124
XS_125:
  buffer_store_dword v254, v251, s[4:7], s74 offen sc1
  s_nop 7
  s_nop 7
  s_branch XD_126
SQ_129:
  s_sleep 3
  s_load_dwordx16 s[80:95], s[76:77], 4224
  s_waitcnt lgkmcnt(0)
  s_and_b64 s[80:81], s[80:81], s[82:83]
  s_and_b64 s[84:85], s[84:85], s[86:87]
  s_and_b64 s[88:89], s[88:89], s[90:91]
  s_and_b64 s[92:93], s[92:93], s[94:95]
  s_and_b64 s[80:81], s[80:81], s[84:85]
  s_and_b64 s[88:89], s[88:89], s[92:93]
  s_and_b64 s[80:81], s[80:81], s[88:89]
  s_and_b32 s96, s80, s81
  s_cmp_eq_u32 s96, 1
  s_cbranch_scc1 SQd_131
  s_sleep 3
  s_load_dwordx16 s[80:95], s[76:77], 4352
  s_waitcnt lgkmcnt(0)
  s_and_b64 s[80:81], s[80:81], s[82:83]
  s_and_b64 s[84:85], s[84:85], s[86:87]
  s_and_b64 s[88:89], s[88:89], s[90:91]
  s_and_b64 s[92:93], s[92:93], s[94:95]
  s_and_b64 s[80:81], s[80:81], s[84:85]
  s_and_b64 s[88:89], s[88:89], s[92:93]
  s_and_b64 s[80:81], s[80:81], s[88:89]
  s_and_b32 s96, s80, s81
  s_cmp_eq_u32 s96, 1
  s_cbranch_scc1 SQd_131
  s_sleep 3
  s_load_dwordx16 s[80:95], s[76:77], 4480
  s_waitcnt lgkmcnt(0)
  s_and_b64 s[80:81], s[80:81], s[82:83]
  s_and_b64 s[84:85], s[84:85], s[86:87]
  s_and_b64 s[88:89], s[88:89], s[90:91]
  s_and_b64 s[92:93], s[92:93], s[94:95]
  s_and_b64 s[80:81], s[80:81], s[84:85]
  s_and_b64 s[88:89], s[88:89], s[92:93]
  s_and_b64 s[80:81], s[80:81], s[88:89]
  s_and_b32 s96, s80, s81
  s_cmp_eq_u32 s96, 1
  s_cbranch_scc1 SQd_131
  s_add_u32 s74, s33, 4096
  s_mov_b32 exec_hi, 0
  s_mov_b32 s32, 0
SQl_132:
  buffer_load_dword v250, v3, s[4:7], s74 offen sc1
  s_waitcnt vmcnt(0)
  v_cmp_eq_u32 vcc, 0, v250
  s_cbranch_vccz SQl_132_d
  s_add_u32 s32, s32, 1
  s_cmp_lt_u32 s32, 200000
  s_cbranch_scc1 SQl_132
SQl_132_d:
  s_mov_b32 exec_hi, -1
SQd_131:
  s_nop 7
  s_nop 7
  s_branch SQok_130
SP_134:
  s_mov_b32 s32, 0
SPl_136:
  s_add_u32 s26, s63, 69632
  buffer_load_dwordx4 v[176:179], v184, s[4:7], s26 offen sc1
  buffer_load_dwordx4 v[180:183], v184, s[4:7], s26 offen offset:16 sc1
  s_waitcnt vmcnt(0)
  v_max_u32 v250, v176, v177
  v_max3_u32 v250, v250, v178, v179
  v_max3_u32 v250, v250, v180, v181
  v_max3_u32 v250, v250, v182, v183
  v_cmp_eq_u32 vcc, -1, v250
  s_cbranch_vccz SPd_137
  s_add_u32 s32, s32, 1
  s_cmp_lt_u32 s32, 200000
  s_cbranch_scc1 SPl_136
SPd_137:
  s_nop 7
  s_nop 7
  s_branch SPok_135
XS_138:
  buffer_store_dwordx4 v[176:179], v12, s[4:7], s26 offen sc1
  buffer_store_dwordx4 v[180:183], v13, s[4:7], s26 offen sc1
  s_nop 7
  s_nop 7
  s_branch XD_139
XS_140:
  buffer_store_dword v254, v251, s[4:7], s74 offen sc1
  s_nop 7
  s_nop 7
  s_branch XD_141
SQ_142:
  s_sleep 3
  s_load_dwordx16 s[80:95], s[76:77], 4736
  s_waitcnt lgkmcnt(0)
  s_and_b64 s[80:81], s[80:81], s[82:83]
  s_and_b64 s[84:85], s[84:85], s[86:87]
  s_and_b64 s[88:89], s[88:89], s[90:91]
  s_and_b64 s[92:93], s[92:93], s[94:95]
  s_and_b64 s[80:81], s[80:81], s[84:85]
  s_and_b64 s[88:89], s[88:89], s[92:93]
  s_and_b64 s[80:81], s[80:81], s[88:89]
  s_and_b32 s96, s80, s81
  s_cmp_eq_u32 s96, 1
  s_cbranch_scc1 SQd_144
  s_sleep 3
  s_load_dwordx16 s[80:95], s[76:77], 4864
  s_waitcnt lgkmcnt(0)
  s_and_b64 s[80:81], s[80:81], s[82:83]
  s_and_b64 s[84:85], s[84:85], s[86:87]
  s_and_b64 s[88:89], s[88:89], s[90:91]
  s_and_b64 s[92:93], s[92:93], s[94:95]
  s_and_b64 s[80:81], s[80:81], s[84:85]
  s_and_b64 s[88:89], s[88:89], s[92:93]
  s_and_b64 s[80:81], s[80:81], s[88:89]
  s_and_b32 s96, s80, s81
  s_cmp_eq_u32 s96, 1
  s_cbranch_scc1 SQd_144
  s_sleep 3
  s_load_dwordx16 s[80:95], s[76:77], 4992
  s_waitcnt lgkmcnt(0)
  s_and_b64 s[80:81], s[80:81], s[82:83]
  s_and_b64 s[84:85], s[84:85], s[86:87]
  s_and_b64 s[88:89], s[88:89], s[90:91]
  s_and_b64 s[92:93], s[92:93], s[94:95]
  s_and_b64 s[80:81], s[80:81], s[84:85]
  s_and_b64 s[88:89], s[88:89], s[92:93]
  s_and_b64 s[80:81], s[80:81], s[88:89]
  s_and_b32 s96, s80, s81
  s_cmp_eq_u32 s96, 1
  s_cbranch_scc1 SQd_144
  s_add_u32 s74, s33, 4608
  s_mov_b32 exec_hi, 0
  s_mov_b32 s32, 0
SQl_145:
  buffer_load_dword v250, v3, s[4:7], s74 offen sc1
  s_waitcnt vmcnt(0)
  v_cmp_eq_u32 vcc, 0, v250
  s_cbranch_vccz SQl_145_d
  s_add_u32 s32, s32, 1
  s_cmp_lt_u32 s32, 200000
  s_cbranch_scc1 SQl_145
SQl_145_d:
  s_mov_b32 exec_hi, -1
SQd_144:
  s_nop 7
  s_nop 7
  s_branch SQok_143
XS_146:
  buffer_store_dwordx4 v[176:179], v12, s[4:7], s97 offen sc1
  s_nop 7
  s_nop 7
  s_branch XD_147
XS_148:
  buffer_store_dwordx4 v[180:183], v13, s[4:7], s97 offen sc1
  s_nop 7
  s_nop 7
  s_branch XD_149
XS_150:
  buffer_store_dwordx4 v[168:171], v12, s[4:7], s57 offen sc1
  s_nop 7
  s_nop 7
  s_branch XD_151
XS_152:
  buffer_store_dwordx4 v[172:175], v13, s[4:7], s57 offen sc1
  s_nop 7
  s_nop 7
  s_branch XD_153
XS_154:
  buffer_store_dwordx4 v[216:219], v12, s[4:7], s97 offen sc1
  s_nop 7
  s_nop 7
  s_branch XD_155
XS_156:
  buffer_store_dwordx4 v[220:223], v13, s[4:7], s97 offen sc1
  s_nop 7
  s_nop 7
  s_branch XD_157
XS_158:
  buffer_store_dwordx4 v[192:195], v239, s[4:7], s26 offen sc1
  s_nop 7
  s_nop 7
  s_branch XD_159
XS_160:
  buffer_store_dword v254, v251, s[4:7], s74 offen sc1
  s_nop 7
  s_nop 7
  s_branch XD_161
SQ_162:
  s_sleep 3
  s_load_dwordx16 s[80:95], s[76:77], 5248
  s_waitcnt lgkmcnt(0)
  s_and_b64 s[80:81], s[80:81], s[82:83]
  s_and_b64 s[84:85], s[84:85], s[86:87]
  s_and_b64 s[88:89], s[88:89], s[90:91]
  s_and_b64 s[92:93], s[92:93], s[94:95]
  s_and_b64 s[80:81], s[80:81], s[84:85]
  s_and_b64 s[88:89], s[88:89], s[92:93]
  s_and_b64 s[80:81], s[80:81], s[88:89]
  s_and_b32 s96, s80, s81
  s_load_dwordx16 s[80:95], s[78:79], 5248
  s_waitcnt lgkmcnt(0)
  s_and_b64 s[80:81], s[80:81], s[82:83]
  s_and_b64 s[84:85], s[84:85], s[86:87]
  s_and_b64 s[88:89], s[88:89], s[90:91]
  s_and_b64 s[92:93], s[92:93], s[94:95]
  s_and_b64 s[80:81], s[80:81], s[84:85]
  s_and_b64 s[88:89], s[88:89], s[92:93]
  s_and_b64 s[80:81], s[80:81], s[88:89]
  s_and_b32 s96, s96, s80
  s_and_b32 s96, s96, s81
  s_cmp_eq_u32 s96, 1
  s_cbranch_scc1 SQd_164
  s_sleep 3
  s_load_dwordx16 s[80:95], s[76:77], 5376
  s_waitcnt lgkmcnt(0)
  s_and_b64 s[80:81], s[80:81], s[82:83]
  s_and_b64 s[84:85], s[84:85], s[86:87]
  s_and_b64 s[88:89], s[88:89], s[90:91]
  s_and_b64 s[92:93], s[92:93], s[94:95]
  s_and_b64 s[80:81], s[80:81], s[84:85]
  s_and_b64 s[88:89], s[88:89], s[92:93]
  s_and_b64 s[80:81], s[80:81], s[88:89]
  s_and_b32 s96, s80, s81
  s_load_dwordx16 s[80:95], s[78:79], 5376
  s_waitcnt lgkmcnt(0)
  s_and_b64 s[80:81], s[80:81], s[82:83]
  s_and_b64 s[84:85], s[84:85], s[86:87]
  s_and_b64 s[88:89], s[88:89], s[90:91]
  s_and_b64 s[92:93], s[92:93], s[94:95]
  s_and_b64 s[80:81], s[80:81], s[84:85]
  s_and_b64 s[88:89], s[88:89], s[92:93]
  s_and_b64 s[80:81], s[80:81], s[88:89]
  s_and_b32 s96, s96, s80
  s_and_b32 s96, s96, s81
  s_cmp_eq_u32 s96, 1
  s_cbranch_scc1 SQd_164
  s_sleep 3
  s_load_dwordx16 s[80:95], s[76:77], 5504
  s_waitcnt lgkmcnt(0)
  s_and_b64 s[80:81], s[80:81], s[82:83]
  s_and_b64 s[84:85], s[84:85], s[86:87]
  s_and_b64 s[88:89], s[88:89], s[90:91]
  s_and_b64 s[92:93], s[92:93], s[94:95]
  s_and_b64 s[80:81], s[80:81], s[84:85]
  s_and_b64 s[88:89], s[88:89], s[92:93]
  s_and_b64 s[80:81], s[80:81], s[88:89]
  s_and_b32 s96, s80, s81
  s_load_dwordx16 s[80:95], s[78:79], 5504
  s_waitcnt lgkmcnt(0)
  s_and_b64 s[80:81], s[80:81], s[82:83]
  s_and_b64 s[84:85], s[84:85], s[86:87]
  s_and_b64 s[88:89], s[88:89], s[90:91]
  s_and_b64 s[92:93], s[92:93], s[94:95]
  s_and_b64 s[80:81], s[80:81], s[84:85]
  s_and_b64 s[88:89], s[88:89], s[92:93]
  s_and_b64 s[80:81], s[80:81], s[88:89]
  s_and_b32 s96, s96, s80
  s_and_b32 s96, s96, s81
  s_cmp_eq_u32 s96, 1
  s_cbranch_scc1 SQd_164
  s_add_u32 s74, s33, 5120
  s_mov_b32 exec_hi, 0
  s_mov_b32 s32, 0
SQl_165:
  buffer_load_dword v250, v3, s[4:7], s74 offen sc1
  s_waitcnt vmcnt(0)
  v_cmp_eq_u32 vcc, 0, v250
  s_cbranch_vccz SQl_165_d
  s_add_u32 s32, s32, 1
  s_cmp_lt_u32 s32, 200000
  s_cbranch_scc1 SQl_165
SQl_165_d:
  s_mov_b32 exec_hi, -1
SQd_164:
  s_nop 7
  s_nop 7
  s_branch SQok_163
  s_endpgm
.section .rodata,"a"
.p2align 6
.amdhsa_kernel prep_kernel
  .amdhsa_next_free_vgpr 64
  .amdhsa_next_free_sgpr 102
  .amdhsa_accum_offset 64
  .amdhsa_group_segment_fixed_size 0
  .amdhsa_kernarg_size 88
  .amdhsa_user_sgpr_count 2
  .amdhsa_user_sgpr_kernarg_segment_ptr 1
  .amdhsa_system_sgpr_workgroup_id_x 1
  .amdhsa_float_denorm_mode_32 3
  .amdhsa_float_denorm_mode_16_64 3
.end_amdhsa_kernel
.p2align 6
.amdhsa_kernel main_kernel
  .amdhsa_next_free_vgpr 512
  .amdhsa_next_free_sgpr 102
  .amdhsa_accum_offset 256
  .amdhsa_group_segment_fixed_size 0
  .amdhsa_kernarg_size 88
  .amdhsa_user_sgpr_count 2
  .amdhsa_user_sgpr_kernarg_segment_ptr 1
  .amdhsa_system_sgpr_workgroup_id_x 1
  .amdhsa_float_denorm_mode_32 3
  .amdhsa_float_denorm_mode_16_64 3
.end_amdhsa_kernel
```
